```python
import torch

def _softmax(x, axis=-1):
    return torch.softmax(x, dim=axis)
def _gelu(x):
    return torch.nn.functional.gelu(x, approximate="tanh")
def _silu(x):
    return torch.nn.functional.silu(x)
def _sigmoid(x):
    return torch.sigmoid(x)
def _layernorm(x, axis=-1, eps=1e-5):
    m = x.mean(dim=axis, keepdim=True)
    v = x.var(dim=axis, keepdim=True, unbiased=False)
    return (x - m) / torch.sqrt(v + eps)
def _scatter_add(tgt, idx, src, axis=0):
    return tgt.clone().index_add_(axis, idx, src)
def _segment_sum(src, seg, n):
    out = torch.zeros((n,) + src.shape[1:], dtype=src.dtype)
    return out.index_add_(0, seg, src)
def _pad(x, pw):
    flat = tuple(v for pair in reversed(pw) for v in pair)
    return torch.nn.functional.pad(x, flat)

kernel_name = 'parallel_sum__ssm_conv_h3__dense_activation_relu__prompt'

def setup_inputs():

    _w = (lambda a: (lambda t: t.to(torch.bfloat16) if t.is_floating_point() else t)(torch.as_tensor(a)))
    def _A_setup():
        B, S, D = 1, 2048, 576
        ks = 4
        return {
            "q": _w((lambda *s: torch.randn(*s, dtype=torch.bfloat16) * 0.05)(B, S, D)),
            "k": _w((lambda *s: torch.randn(*s, dtype=torch.bfloat16) * 0.8)(B, S, D)),
            "v": _w((lambda *s: torch.randn(*s, dtype=torch.bfloat16) * 0.8)(B, S, D)),
            "shift_k": _w((lambda *s: torch.randn(*s, dtype=torch.bfloat16) * 0.8)(D, ks) * 0.5),
            "ssm_k": _w((lambda *s: torch.randn(*s, dtype=torch.bfloat16) * 0.8)(D, S) * (1.0 / S ** 0.5)),
            "ssm_D": _w((lambda *s: torch.randn(*s, dtype=torch.bfloat16) * 0.8)(D)),
        }
    _A_in = _A_setup()

    def _B_setup():
        B, S, D, Dff = 1, 2048, 576, 4608
        return {
            "x": _w((lambda *s: torch.randn(*s, dtype=torch.bfloat16) * 0.05)(B, S, D)),
            "w1": _w((lambda *s: torch.randn(*s, dtype=torch.bfloat16) * 0.05)(D, Dff)),
            "w2": _w((lambda *s: torch.randn(*s, dtype=torch.bfloat16) * 0.05)(Dff, D)),
        }
    _B_in = _B_setup()

    return {
        "A_q": _A_in["q"],
        "A_k": _A_in["k"],
        "A_v": _A_in["v"],
        "A_shift_k": _A_in["shift_k"],
        "A_ssm_k": _A_in["ssm_k"],
        "A_ssm_D": _A_in["ssm_D"],
        "B_x": _B_in["x"],
        "B_w1": _B_in["w1"],
        "B_w2": _B_in["w2"],
    }

def reference(A_q, A_k, A_v, A_shift_k, A_ssm_k, A_ssm_D, B_x, B_w1, B_w2):
    def _A_ref(q, k, v, shift_k, ssm_k, ssm_D):
        B, S, D = q.shape
        ks = shift_k.shape[-1]
        k_pad = _pad(k, ((0, 0), (ks - 1, 0), (0, 0)))
        k_shift = torch.zeros_like(k)
        for t in range(ks):
            k_shift = k_shift + k_pad[:, t:t + S, :] * shift_k[:, ks - 1 - t][None, None, :]
        kv = k_shift * v
        L = 2 * S
        kv_pad = _pad(kv, ((0, 0), (0, S), (0, 0)))
        kf_pad = _pad(ssm_k, ((0, 0), (0, S)))
        kv_f = (lambda x, axes=(-2,-1): torch.fft.rfft2(x.float(), dim=axes))(kv_pad[:, None, :, :], axes=(1, 2))
        kf_f = (lambda x, axes=(-2,-1): torch.fft.rfft2(x.float(), dim=axes))(kf_pad[:, None, :], axes=(1, 2))
        kf_f = (lambda x, *d: x.permute(*d))(kf_f, 1, 2, 0)
        y_f = kv_f * kf_f[None, :, :, :]
        y = (lambda x, s, axes=(-2,-1): torch.fft.irfft2(x, s=s, dim=axes).to(torch.bfloat16))(y_f, (1, L), axes=(1, 2))[:, 0, :S, :]
        y = y + kv * ssm_D[None, None, :]
        return q * y

    def _B_ref(x, w1, w2):
        h = torch.einsum("bsd,df->bsf", x, w1)
        zero = torch.zeros_like(h)
        h = torch.maximum(h, zero)
        return torch.einsum("bsf,fd->bsd", h, w2)

    x = A_q
    xn = _layernorm(x, axis=-1)
    return x + _A_ref(xn, A_k, A_v, A_shift_k, A_ssm_k, A_ssm_D) + _B_ref(xn, B_w1, B_w2)
```

```asm
; @launch grid=(256,1,1) block=(256,1,1) lds=163840
.amdgcn_target "amdgcn-amd-amdhsa--gfx950"
.text
.globl parallel_sum__ssm_conv_h3__dense_activation_relu__prompt_kernel
.p2align 8
.type parallel_sum__ssm_conv_h3__dense_activation_relu__prompt_kernel,@function
parallel_sum__ssm_conv_h3__dense_activation_relu__prompt_kernel:
  s_getpc_b64 s[68:69]
  s_cmp_ge_u32 s2, 256
  s_cbranch_scc1 L_end
  s_load_dwordx8 s[36:43], s[0:1], 0
  s_load_dwordx4 s[48:51], s[0:1], 56
  s_load_dwordx2 s[44:45], s[0:1], 88
  s_load_dwordx4 s[56:59], s[0:1], 72
  v_lshrrev_b32 v2, 6, v0
  v_and_b32 v1, 63, v0
  s_lshr_b32 s3, s2, 3
  v_readfirstlane_b32 s20, v2
  s_and_b32 s24, s2, 7
  s_cmp_ge_u32 s3, 26
  v_lshl_add_u32 v3, s3, 2, v2
  v_min_u32 v4, 2, v1
  v_mad_u32_u24 v3, v3, 3, v4
  v_lshlrev_b32 v3, 7, v3
  v_add_u32 v3, L_ffn_main - parallel_sum__ssm_conv_h3__dense_activation_relu__prompt_kernel, v3
  v_min_u32 v3, L_end - parallel_sum__ssm_conv_h3__dense_activation_relu__prompt_kernel - 8, v3
  v_mov_b32 v5, s69
  v_add_co_u32 v4, vcc, s68, v3
  s_nop 1
  v_addc_co_u32 v5, vcc, 0, v5, vcc
  global_load_dword v253, v[4:5], off
  s_cbranch_scc1 L_conv
L_ffn:
  s_lshr_b32 s64, s24, 2
  s_mul_i32 s64, s64, 26
  s_add_u32 s64, s64, s3
  s_lshr_b32 s52, s64, 1
  s_and_b32 s65, s64, 1
  s_and_b32 s66, s24, 3
  s_lshl_b32 s67, s66, 1
  s_add_u32 s64, s65, s67
  s_mul_i32 s55, s52, 91008
  s_mul_hi_u32 s65, s52, 0x2aaaaaab
  s_mul_i32 s65, s65, 6
  s_sub_u32 s65, s52, s65
  s_add_u32 s65, s65, s67
  s_add_u32 s65, s65, 2
  s_and_b32 s65, s65, 7
  s_mov_b32 s54, s65
  s_lshl_b32 s23, s65, 7
  v_lshrrev_b32 v22, 3, v1
  v_and_b32 v23, 7, v1
  s_lshl_b32 s67, s20, 3
  v_add_u32 v24, s67, v22
  v_xor_b32 v25, v23, v22
  v_lshlrev_b32 v25, 4, v25
  v_mul_u32_u24 v26, 1152, v24
  v_add_u32 v13, v26, v25
  s_and_b32 s67, s20, 1
  s_lshl_b32 s67, s67, 2
  v_and_b32 v25, 2, v22
  v_or_b32 v25, s67, v25
  v_xor_b32 v25, v23, v25
  v_lshlrev_b32 v12, 4, v25
  v_mul_u32_u24 v26, 9216, v24
  v_add_u32 v11, v26, v12
  v_add_u32 v25, s67, v22
  v_xor_b32 v25, v23, v25
  v_and_b32 v25, 7, v25
  v_lshlrev_b32 v25, 4, v25
  s_lshl_b32 s67, s20, 2
  s_add_u32 s68, s67, 64
  v_add_u32 v24, s68, v22
  v_mul_u32_u24 v24, 1152, v24
  v_add_u32 v14, v24, v25
  s_mul_i32 s21, s20, 3072
  s_cmp_eq_u32 s20, 3
  s_cselect_b32 s62, 0xffffff, -1
  s_mov_b32 s63, 0
  s_lshl_b32 s60, s20, 10
  s_lshl_b32 s61, s20, 9
  s_sub_u32 s6, 2359296, s55
  s_mov_b32 s7, 0x20000
  s_mul_i32 s69, s64, 1152
  s_sub_u32 s10, 5310464, s69
  s_mov_b32 s11, 0x20000
  s_waitcnt lgkmcnt(0)
  s_add_u32 s4, s36, s55
  s_addc_u32 s5, s37, 0
  s_add_u32 s8, s48, s69
  s_addc_u32 s9, s49, 0
  s_sub_u32 s8, s8, 2048
  s_subb_u32 s9, s9, 0
  s_add_u32 m0, s60, 153600
  s_add_u32 s70, s23, 36864
  buffer_load_dwordx4 v13, s[4:7], s23 offen lds
  s_add_u32 m0, s60, 157696
  s_mul_i32 s71, s23, 4608
  buffer_load_dwordx4 v13, s[4:7], s70 offen lds
  s_add_u32 m0, s61, 161792
  s_mov_b64 exec, s[62:63]
  buffer_load_dwordx4 v14, s[4:7], s23 offen lds
  s_mov_b64 exec, -1
  s_add_u32 m0, s21, 81920
  s_add_u32 s26, s71, 2048
  buffer_load_dwordx4 v11, s[8:11], s26 offen offset:0 lds
  s_add_u32 s27, s71, 295936
  buffer_load_dwordx4 v11, s[8:11], s27 offen offset:1024 lds
  s_add_u32 s23, s23, 128
  s_cmp_eq_u32 s23, 1152
  s_cselect_b32 s23, 0, s23
  s_add_u32 m0, s60, 0
  s_add_u32 s70, s23, 36864
  buffer_load_dwordx4 v13, s[4:7], s23 offen lds
  s_add_u32 m0, s60, 4096
  s_mul_i32 s71, s23, 4608
  buffer_load_dwordx4 v13, s[4:7], s70 offen lds
  s_add_u32 m0, s61, 8192
  s_mov_b64 exec, s[62:63]
  buffer_load_dwordx4 v14, s[4:7], s23 offen lds
  s_mov_b64 exec, -1
  s_add_u32 m0, s21, 81920
  s_add_u32 s28, s71, 0
  buffer_load_dwordx4 v11, s[8:11], s28 offen offset:2048 lds
  s_add_u32 m0, s21, 94208
  s_add_u32 s29, s71, 296960
  buffer_load_dwordx4 v11, s[8:11], s29 offen offset:0 lds
  s_add_u32 s23, s23, 128
  s_cmp_eq_u32 s23, 1152
  s_cselect_b32 s23, 0, s23
  v_mov_b32 v112, 0x3f803f80
  v_mov_b32 v113, 0x3f803f80
  v_mov_b32 v114, 0x3f803f80
  v_mov_b32 v115, 0x3f803f80
  v_lshrrev_b32 v28, 3, v1
  v_and_b32 v29, 7, v1
  s_cmp_eq_u32 s20, 0
  s_cselect_b32 s70, 0, 10240
  s_cselect_b32 s71, 153600, 0
  v_mul_u32_u24 v28, s70, v28
  v_lshl_add_u32 v28, v29, 4, v28
  v_add_u32 v28, s71, v28
  ds_write_b128 v28, v[112:115] offset:10112
  s_lshr_b32 s69, s64, 1
  s_cmp_eq_u32 s64, 1
  s_cselect_b32 s68, 4, 7
  s_bitcmp0_b32 s64, 0
  s_cselect_b32 s53, s69, s68
  s_and_b32 s90, s52, 0
  s_lshl_b32 s90, s90, 7
  v_lshrrev_b32 v22, 4, v1
  v_and_b32 v23, 15, v1
  v_bfe_u32 v24, v1, 2, 2
  v_and_b32 v25, 3, v1
  v_mul_u32_u24 v2, 3072, v22
  v_lshl_add_u32 v2, v24, 7, v2
  v_and_b32 v26, 1, v25
  v_lshl_add_u32 v2, v26, 3, v2
  v_lshrrev_b32 v25, 1, v25
  s_lshl_b32 s67, s20, 1
  v_add_u32 v25, s67, v25
  v_and_b32 v24, 2, v24
  v_and_b32 v26, 1, v22
  v_lshl_or_b32 v24, v26, 2, v24
  v_xor_b32 v25, v25, v24
  v_lshl_add_u32 v2, v25, 4, v2
  v_add_u32 v3, 94208, v2
  v_add_u32 v2, 32768, v2
  v_lshlrev_b32 v24, 7, v23
  v_and_b32 v25, 7, v23
  v_xor_b32 v26, v22, v25
  v_lshl_add_u32 v4, v26, 4, v24
  v_xor_b32 v5, 64, v4
  v_add_u32 v6, 40960, v4
  v_add_u32 v7, 40960, v5
  v_add_u32 v8, 153600, v4
  v_add_u32 v9, 153600, v5
  v_lshrrev_b32 v26, 1, v22
  v_add_u32 v26, s67, v26
  v_xor_b32 v26, v26, v25
  v_lshl_add_u32 v24, v26, 4, v24
  v_and_b32 v26, 1, v22
  v_lshl_add_u32 v24, v26, 3, v24
  s_sub_u32 s69, s64, s54
  s_cselect_b32 s68, 9, 0
  s_add_u32 s69, s69, s68
  s_sub_u32 s69, s69, 1
  s_mul_i32 s69, s69, 10240
  v_add_u32 v250, s69, v24
  s_sub_u32 s69, 7, s54
  s_mul_i32 s69, s69, 10240
  s_min_u32 s68, s53, 4
  s_lshl_b32 s68, s68, 11
  s_add_u32 s69, s69, s68
  v_add_u32 v251, s69, v24
  s_lshl_b32 s69, s20, 11
  v_add_u32 v240, s69, v4
  v_add_u32 v241, s69, v5
  v_add_u32 v242, s69, v6
  v_add_u32 v243, s69, v7
  v_add_u32 v244, s69, v8
  v_add_u32 v245, s69, v9
  s_add_u32 s66, s60, 61440
  v_lshl_add_u32 v10, v1, 4, s66
  s_lshr_b32 s66, s20, 1
  s_lshl_b32 s66, s66, 10
  s_and_b32 s68, s20, 1
  s_lshl_b32 s68, s68, 3
  s_add_u32 s66, s66, s68
  s_add_u32 s66, s66, 20480
  v_lshl_add_u32 v26, v1, 4, s66
  s_lshl_b32 s67, s20, 2
  v_bfe_u32 v24, v1, 3, 2
  v_add_u32 v24, s67, v24
  v_mul_u32_u24 v24, 1152, v24
  v_add_u32 v24, v24, v12
  v_lshrrev_b32 v25, 5, v1
  s_and_b32 s67, s52, 0
  v_and_b32 v16, 15, v1
  v_lshlrev_b32 v16, 2, v16
  v_add_u32 v16, 160000, v16
  v_cmp_le_u32 vcc, 48, v1
  v_mov_b32 v23, s20
  s_nop 0
  v_cndmask_b32 v23, v23, 4, vcc
  v_lshl_add_u32 v15, v23, 6, v16
  s_mov_b32 s68, 73728
  v_add3_u32 v23, v25, s67, 7
  v_and_b32 v23, 7, v23
  v_add_u32 v23, 1, v23
  v_mul_u32_u24 v23, v23, v25
  v_mad_u32_u24 v90, v23, s68, v24
  v_add3_u32 v23, v25, s67, 9
  v_and_b32 v23, 7, v23
  v_add_u32 v23, 1, v23
  v_mad_u32_u24 v91, v23, s68, v24
  v_add3_u32 v23, v25, s67, 11
  v_and_b32 v23, 7, v23
  v_add_u32 v23, 1, v23
  v_mad_u32_u24 v27, v23, s68, v24
  v_add3_u32 v23, v25, s67, 13
  v_and_b32 v23, 7, v23
  v_add_u32 v23, 1, v23
  v_mad_u32_u24 v254, v23, s68, v24
  s_add_u32 s67, s67, 7
  s_and_b32 s67, s67, 7
  s_add_u32 s67, s67, 1
  s_mul_i32 s67, s67, s68
  v_mul_u32_u24 v25, 18432, v25
  v_add3_u32 v12, v25, s67, v24
  s_add_u32 m0, s60, 10240
  s_add_u32 s70, s23, 36864
  buffer_load_dwordx4 v13, s[4:7], s23 offen lds
  s_add_u32 m0, s60, 14336
  s_mul_i32 s71, s23, 4608
  buffer_load_dwordx4 v13, s[4:7], s70 offen lds
  s_add_u32 m0, s61, 18432
  s_mov_b64 exec, s[62:63]
  buffer_load_dwordx4 v14, s[4:7], s23 offen lds
  s_mov_b64 exec, -1
  s_add_u32 m0, s21, 94208
  s_add_u32 s30, s71, 1024
  buffer_load_dwordx4 v11, s[8:11], s30 offen offset:1024 lds
  s_add_u32 s31, s71, 294912
  buffer_load_dwordx4 v11, s[8:11], s31 offen offset:2048 lds
  s_add_u32 s23, s23, 128
  s_cmp_eq_u32 s23, 1152
  s_cselect_b32 s23, 0, s23
  s_mov_b64 exec, 0
  s_cmp_eq_u32 s20, 0
  s_cbranch_scc1 L_fw0
  s_cmp_eq_u32 s20, 1
  s_cbranch_scc1 L_fw1
  s_cmp_eq_u32 s20, 2
  s_cbranch_scc1 L_fw2
  s_branch L_fw3
L_conv:
  s_load_dwordx4 s[52:55], s[0:1], 32
  s_sub_u32 s63, s3, 26
  s_mul_i32 s65, s24, 6
  s_add_u32 s64, s63, s65
  s_mov_b32 s46, 24182784
  s_mov_b32 s47, 0x20000
  s_mov_b32 s34, 256
  s_mov_b32 s35, 0x20000
  s_mov_b32 s18, 5308416
  s_mov_b32 s19, 0x20000
  s_mov_b32 s60, 0xffff0000
  s_cmp_eq_u32 s20, 3
  s_cbranch_scc1 L_c_help
  s_mul_i32 s65, s64, 3
  s_add_u32 s65, s65, s20
  s_lshr_b32 s66, s65, 4
  s_and_b32 s67, s65, 15
  v_lshrrev_b32 v2, 3, v1
  v_and_b32 v3, 7, v1
  s_lshl_b32 s68, s67, 7
  v_lshl_add_u32 v4, v2, 4, s68
  v_mul_u32_u24 v5, 1152, v4
  s_lshl_b32 s68, s66, 7
  v_lshl_add_u32 v6, v3, 4, s68
  v_add_u32 v5, v5, v6
  v_subrev_u32 v7, 3456, v5
  v_cmp_eq_u32 vcc, 0, v4
  v_mov_b32 v8, 2147483647
  v_lshlrev_b32 v6, 2, v6
  v_cndmask_b32 v7, v7, v8, vcc
  s_mov_b32 s6, 2359296
  s_mov_b32 s7, 0x20000
  s_mov_b32 s10, 2359296
  s_mov_b32 s11, 0x20000
  s_mov_b32 s14, 4608
  s_mov_b32 s15, 0x20000
  s_mov_b32 s26, 4608
  s_mov_b32 s27, 9216
  s_mov_b32 s28, 13824
  s_waitcnt lgkmcnt(0)
  s_mov_b32 s4, s38
  s_mov_b32 s5, s39
  s_mov_b32 s8, s40
  s_mov_b32 s9, s41
  s_mov_b32 s12, s42
  s_mov_b32 s13, s43
  s_mov_b32 s32, s58
  s_mov_b32 s33, s59
  buffer_load_dwordx4 v[208:211], v6, s[12:15], 0 offen offset:0
  buffer_load_dwordx4 v[212:215], v6, s[12:15], 0 offen offset:16
  buffer_load_dwordx4 v[216:219], v6, s[12:15], 0 offen offset:32
  buffer_load_dwordx4 v[220:223], v6, s[12:15], 0 offen offset:48
  buffer_load_dwordx4 v[16:19], v7, s[4:7], 0 offen offset:0
  buffer_load_dwordx4 v[20:23], v7, s[4:7], 0 offen offset:1152
  buffer_load_dwordx4 v[24:27], v7, s[4:7], 0 offen offset:2304
  buffer_load_dwordx4 v[28:31], v5, s[4:7], 0 offen offset:0
  buffer_load_dwordx4 v[48:51], v5, s[8:11], 0 offen offset:0
  buffer_load_dwordx4 v[32:35], v5, s[4:7], 0 offen offset:1152
  buffer_load_dwordx4 v[52:55], v5, s[8:11], 0 offen offset:1152
  buffer_load_dwordx4 v[36:39], v5, s[4:7], 0 offen offset:2304
  buffer_load_dwordx4 v[56:59], v5, s[8:11], 0 offen offset:2304
  buffer_load_dwordx4 v[40:43], v5, s[4:7], 0 offen offset:3456
  buffer_load_dwordx4 v[60:63], v5, s[8:11], 0 offen offset:3456
  buffer_load_dwordx4 v[44:47], v5, s[4:7], s26 offen offset:0
  buffer_load_dwordx4 v[64:67], v5, s[8:11], s26 offen offset:0
  s_branch L_c_s1
L_c_help:
  v_lshrrev_b32 v2, 1, v1
  v_and_b32 v3, 1, v1
  s_mul_i32 s65, s63, 96
  s_lshr_b32 s66, s24, 2
  s_mul_i32 s66, s66, 0
  s_add_u32 s65, s65, s66
  v_min_u32 v20, 31, v2
  v_add_u32 v20, s65, v20
  s_and_b32 s65, s24, 3
  s_lshl_b32 s65, s65, 1
  v_add_u32 v21, s65, v3
  v_mul_u32_u24 v22, 9216, v20
  v_mul_u32_u24 v23, 1152, v21
  v_add_u32 v22, v22, v23
  v_lshlrev_b32 v6, 4, v1
  s_mov_b32 s26, 294912
  s_mov_b32 s27, 589824
  v_mov_b32 v16, 0
  v_mov_b32 v17, 0
  v_mov_b32 v18, 0
  v_mov_b32 v19, 0
  v_mov_b32 v14, 1
  s_waitcnt lgkmcnt(0)
  s_mov_b32 s16, s48
  s_mov_b32 s17, s49
  s_mov_b32 s32, s58
  s_mov_b32 s33, s59
  s_cmp_ge_u32 s64, 28
  s_cbranch_scc1 L_c_nz
  s_lshl_b32 s65, s64, 10
  s_add_u32 s65, s65, 23941120
  buffer_store_dwordx4 v[16:19], v6, s[44:47], s65 offen sc1
L_c_nz:
  v_lshrrev_b32 v8, 4, v1
  v_and_b32 v9, 15, v1
  v_mul_u32_u24 v10, 4352, v8
  v_lshl_add_u32 v10, v9, 4, v10
  ds_write_b128 v10, v[16:19] offset:0
  ds_write_b128 v10, v[16:19] offset:17408
  ds_write_b128 v10, v[16:19] offset:34816
  v_min_u32 v8, 11, v2
  v_mul_u32_u24 v10, 4128, v8
  v_lshl_add_u32 v10, v3, 4, v10
  ds_write_b128 v10, v[16:19] offset:52224
  buffer_load_dword v253, v22, s[16:19], 0 offen offset:128
  buffer_load_dword v253, v22, s[16:19], s26 offen offset:128
  buffer_load_dword v253, v22, s[16:19], s27 offen offset:128
  buffer_load_dword v253, v22, s[16:19], 0 offen offset:256
  buffer_load_dword v253, v22, s[16:19], s26 offen offset:256
  buffer_load_dword v253, v22, s[16:19], s27 offen offset:256
  s_mov_b64 exec, 0
  s_branch L_cw0
L_cw_ret:
  s_mov_b64 exec, -1
  s_waitcnt vmcnt(0)
  s_cmp_ge_u32 s64, 28
  s_cbranch_scc1 L_c_nr
  s_lshl_b32 s65, s64, 2
  s_mov_b64 exec, 1
  buffer_store_dword v14, off, s[32:35], s65 sc1
  s_mov_b64 exec, -1
L_c_nr:
  buffer_load_dword v253, v22, s[16:19], 0 offen offset:384
  buffer_load_dword v253, v22, s[16:19], s26 offen offset:384
  buffer_load_dword v253, v22, s[16:19], s27 offen offset:384
  s_barrier
  buffer_load_dword v253, v22, s[16:19], 0 offen offset:512
  buffer_load_dword v253, v22, s[16:19], s26 offen offset:512
  buffer_load_dword v253, v22, s[16:19], s27 offen offset:512
  buffer_load_dword v253, v22, s[16:19], 0 offen offset:640
  buffer_load_dword v253, v22, s[16:19], s26 offen offset:640
  buffer_load_dword v253, v22, s[16:19], s27 offen offset:640
  s_barrier
  buffer_load_dword v253, v22, s[16:19], 0 offen offset:768
  buffer_load_dword v253, v22, s[16:19], s26 offen offset:768
  buffer_load_dword v253, v22, s[16:19], s27 offen offset:768
  buffer_load_dword v253, v22, s[16:19], 0 offen offset:896
  buffer_load_dword v253, v22, s[16:19], s26 offen offset:896
  buffer_load_dword v253, v22, s[16:19], s27 offen offset:896
  s_branch L_c_join
.p2align 12
L_ffn_main:
L_ffn_ret:
  s_mov_b64 exec, -1
  s_waitcnt vmcnt(10) lgkmcnt(0)
  s_barrier
  ds_read_b64_tr_b16 v[28:29], v2 offset:49152
  ds_read_b64_tr_b16 v[30:31], v2 offset:49664
  ds_read_b128 v[220:223], v244 offset:0
  ds_read_b128 v[116:119], v8 offset:0
  ds_read_b128 v[120:123], v8 offset:2048
  ds_read_b128 v[124:127], v8 offset:4096
  ds_read_b128 v[128:131], v8 offset:6144
  ds_read_b128 v[132:135], v8 offset:8192
  ds_read_b64_tr_b16 v[32:33], v2 offset:50176
  ds_read_b64_tr_b16 v[34:35], v2 offset:50688
  ds_read_b128 v[224:227], v245 offset:0
  ds_read_b128 v[136:139], v9 offset:0
  ds_read_b128 v[140:143], v9 offset:2048
  ds_read_b128 v[144:147], v9 offset:4096
  ds_read_b128 v[148:151], v9 offset:6144
  ds_read_b128 v[152:155], v9 offset:8192
  s_add_u32 m0, s60, 20480
  s_add_u32 s70, s23, 36864
  buffer_load_dwordx4 v13, s[4:7], s23 offen lds
  s_add_u32 m0, s60, 24576
  s_mul_i32 s71, s23, 4608
  buffer_load_dwordx4 v13, s[4:7], s70 offen lds
  s_add_u32 m0, s61, 28672
  s_mov_b64 exec, s[62:63]
  buffer_load_dwordx4 v14, s[4:7], s23 offen lds
  s_mov_b64 exec, -1
  s_add_u32 m0, s21, 106496
  s_add_u32 s32, s71, 2048
  buffer_load_dwordx4 v11, s[8:11], s32 offen offset:0 lds
  s_add_u32 s33, s71, 295936
  buffer_load_dwordx4 v11, s[8:11], s33 offen offset:1024 lds
  s_add_u32 s23, s23, 128
  s_cmp_eq_u32 s23, 1152
  s_cselect_b32 s23, 0, s23
  s_waitcnt lgkmcnt(8)
  v_mfma_f32_16x16x32_bf16 v[104:107], v[112:115], v[220:223], 0
  s_waitcnt vmcnt(10) lgkmcnt(6)
  v_mfma_f32_16x16x32_bf16 v[246:249], v[220:223], v[220:223], 0
  s_barrier
  v_mfma_f32_16x16x32_bf16 v[108:111], v[132:135], v[132:135], 0
  s_add_u32 m0, s60, 30720
  ds_read_b64_tr_b16 v[36:37], v2 offset:51200
  ds_read_b64_tr_b16 v[38:39], v2 offset:51712
  v_mfma_f32_16x16x32_bf16 v[40:43], v[28:31], v[116:119], 0
  s_add_u32 s70, s23, 36864
  buffer_load_dwordx4 v13, s[4:7], s23 offen lds
  v_mfma_f32_16x16x32_bf16 v[44:47], v[28:31], v[120:123], 0
  s_add_u32 m0, s60, 34816
  ds_read_b128 v[228:231], v240 offset:0
  ds_read_b128 v[172:175], v4 offset:8192
  v_mfma_f32_16x16x32_bf16 v[48:51], v[28:31], v[124:127], 0
  s_mul_i32 s71, s23, 4608
  buffer_load_dwordx4 v13, s[4:7], s70 offen lds
  v_mfma_f32_16x16x32_bf16 v[52:55], v[28:31], v[128:131], 0
  s_add_u32 m0, s61, 38912
  ds_read_b128 v[156:159], v4 offset:0
  ds_read_b128 v[160:163], v4 offset:2048
  v_mfma_f32_16x16x32_bf16 v[56:59], v[28:31], v[132:135], 0
  s_waitcnt lgkmcnt(6)
  ds_read_b128 v[164:167], v4 offset:4096
  ds_read_b128 v[168:171], v4 offset:6144
  v_mfma_f32_16x16x32_bf16 v[104:107], v[112:115], v[224:227], v[104:107]
  ds_read_b64_tr_b16 v[28:29], v3 offset:0
  ds_read_b64_tr_b16 v[30:31], v3 offset:512
  v_mfma_f32_16x16x32_bf16 v[246:249], v[224:227], v[224:227], v[246:249]
  s_mov_b64 exec, s[62:63]
  buffer_load_dwordx4 v14, s[4:7], s23 offen lds
  s_mov_b64 exec, -1
  v_mfma_f32_16x16x32_bf16 v[108:111], v[152:155], v[152:155], v[108:111]
  s_add_u32 m0, s21, 106496
  ds_read_b128 v[220:223], v241 offset:0
  ds_read_b128 v[192:195], v5 offset:8192
  v_mfma_f32_16x16x32_bf16 v[56:59], v[32:35], v[152:155], v[56:59]
  s_add_u32 s34, s71, 0
  buffer_load_dwordx4 v11, s[8:11], s34 offen offset:2048 lds
  v_mfma_f32_16x16x32_bf16 v[52:55], v[32:35], v[148:151], v[52:55]
  s_add_u32 m0, s21, 118784
  ds_read_b128 v[176:179], v5 offset:0
  v_mfma_f32_16x16x32_bf16 v[48:51], v[32:35], v[144:147], v[48:51]
  s_add_u32 s35, s71, 296960
  buffer_load_dwordx4 v11, s[8:11], s35 offen offset:0 lds
  v_mfma_f32_16x16x32_bf16 v[44:47], v[32:35], v[140:143], v[44:47]
  s_add_u32 s23, s23, 128
  s_cmp_eq_u32 s23, 1152
  s_cselect_b32 s23, 0, s23
  ds_read_b128 v[180:183], v5 offset:2048
  ds_read_b128 v[184:187], v5 offset:4096
  v_mfma_f32_16x16x32_bf16 v[40:43], v[32:35], v[136:139], v[40:43]
  s_waitcnt lgkmcnt(7)
  ds_read_b128 v[188:191], v5 offset:6144
  v_mfma_f32_16x16x32_bf16 v[104:107], v[112:115], v[228:231], v[104:107]
  s_waitcnt vmcnt(10) lgkmcnt(6)
  v_mfma_f32_16x16x32_bf16 v[246:249], v[228:231], v[228:231], v[246:249]
  s_barrier
  v_mfma_f32_16x16x32_bf16 v[108:111], v[172:175], v[172:175], v[108:111]
  s_add_u32 m0, s60, 40960
  ds_read_b64_tr_b16 v[32:33], v3 offset:1024
  ds_read_b64_tr_b16 v[34:35], v3 offset:1536
  v_mfma_f32_16x16x32_bf16 v[40:43], v[36:39], v[156:159], v[40:43]
  s_add_u32 s70, s23, 36864
  buffer_load_dwordx4 v13, s[4:7], s23 offen lds
  v_mfma_f32_16x16x32_bf16 v[44:47], v[36:39], v[160:163], v[44:47]
  s_add_u32 m0, s60, 45056
  ds_read_b128 v[224:227], v240 offset:10240
  ds_read_b128 v[212:215], v4 offset:18432
  v_mfma_f32_16x16x32_bf16 v[48:51], v[36:39], v[164:167], v[48:51]
  s_mul_i32 s71, s23, 4608
  buffer_load_dwordx4 v13, s[4:7], s70 offen lds
  v_mfma_f32_16x16x32_bf16 v[52:55], v[36:39], v[168:171], v[52:55]
  s_add_u32 m0, s61, 49152
  ds_read_b128 v[196:199], v4 offset:10240
  ds_read_b128 v[200:203], v4 offset:12288
  v_mfma_f32_16x16x32_bf16 v[56:59], v[36:39], v[172:175], v[56:59]
  s_waitcnt lgkmcnt(6)
  ds_read_b128 v[204:207], v4 offset:14336
  ds_read_b128 v[208:211], v4 offset:16384
  v_mfma_f32_16x16x32_bf16 v[104:107], v[112:115], v[220:223], v[104:107]
  ds_read_b64_tr_b16 v[36:37], v3 offset:2048
  ds_read_b64_tr_b16 v[38:39], v3 offset:2560
  v_mfma_f32_16x16x32_bf16 v[246:249], v[220:223], v[220:223], v[246:249]
  s_mov_b64 exec, s[62:63]
  buffer_load_dwordx4 v14, s[4:7], s23 offen lds
  s_mov_b64 exec, -1
  v_mfma_f32_16x16x32_bf16 v[108:111], v[192:195], v[192:195], v[108:111]
  s_add_u32 m0, s21, 118784
  ds_read_b128 v[228:231], v241 offset:10240
  ds_read_b128 a[12:15], v5 offset:18432
  v_mfma_f32_16x16x32_bf16 v[56:59], v[28:31], v[192:195], v[56:59]
  s_add_u32 s36, s71, 1024
  buffer_load_dwordx4 v11, s[8:11], s36 offen offset:1024 lds
  v_mfma_f32_16x16x32_bf16 v[52:55], v[28:31], v[188:191], v[52:55]
  s_add_u32 s37, s71, 294912
  buffer_load_dwordx4 v11, s[8:11], s37 offen offset:2048 lds
  v_mfma_f32_16x16x32_bf16 v[48:51], v[28:31], v[184:187], v[48:51]
  s_add_u32 s23, s23, 128
  s_cmp_eq_u32 s23, 1152
  s_cselect_b32 s23, 0, s23
  ds_read_b128 v[216:219], v5 offset:10240
  v_mfma_f32_16x16x32_bf16 v[44:47], v[28:31], v[180:183], v[44:47]
  ds_read_b128 a[0:3], v5 offset:12288
  ds_read_b128 a[4:7], v5 offset:14336
  v_mfma_f32_16x16x32_bf16 v[40:43], v[28:31], v[176:179], v[40:43]
  s_waitcnt lgkmcnt(7)
  ds_read_b128 a[8:11], v5 offset:16384
  v_mfma_f32_16x16x32_bf16 v[104:107], v[112:115], v[224:227], v[104:107]
  s_waitcnt vmcnt(10) lgkmcnt(6)
  v_mfma_f32_16x16x32_bf16 v[246:249], v[224:227], v[224:227], v[246:249]
  s_barrier
  v_mfma_f32_16x16x32_bf16 v[108:111], v[212:215], v[212:215], v[108:111]
  s_add_u32 m0, s60, 51200
  ds_read_b64_tr_b16 v[28:29], v3 offset:12288
  ds_read_b64_tr_b16 v[30:31], v3 offset:12800
  v_mfma_f32_16x16x32_bf16 v[40:43], v[32:35], v[196:199], v[40:43]
  s_add_u32 s70, s23, 36864
  buffer_load_dwordx4 v13, s[4:7], s23 offen lds
  v_mfma_f32_16x16x32_bf16 v[44:47], v[32:35], v[200:203], v[44:47]
  s_add_u32 m0, s60, 55296
  ds_read_b128 v[220:223], v240 offset:20480
  ds_read_b128 a[32:35], v4 offset:28672
  v_mfma_f32_16x16x32_bf16 v[48:51], v[32:35], v[204:207], v[48:51]
  s_mul_i32 s71, s23, 4608
  buffer_load_dwordx4 v13, s[4:7], s70 offen lds
  v_mfma_f32_16x16x32_bf16 v[52:55], v[32:35], v[208:211], v[52:55]
  s_add_u32 m0, s61, 59392
  ds_read_b128 a[16:19], v4 offset:20480
  ds_read_b128 a[20:23], v4 offset:22528
  v_mfma_f32_16x16x32_bf16 v[56:59], v[32:35], v[212:215], v[56:59]
  s_waitcnt lgkmcnt(6)
  ds_read_b128 a[24:27], v4 offset:24576
  ds_read_b128 a[28:31], v4 offset:26624
  v_mfma_f32_16x16x32_bf16 v[104:107], v[112:115], v[228:231], v[104:107]
  ds_read_b64_tr_b16 v[32:33], v3 offset:13312
  ds_read_b64_tr_b16 v[34:35], v3 offset:13824
  v_mfma_f32_16x16x32_bf16 v[246:249], v[228:231], v[228:231], v[246:249]
  s_mov_b64 exec, s[62:63]
  buffer_load_dwordx4 v14, s[4:7], s23 offen lds
  s_mov_b64 exec, -1
  v_mfma_f32_16x16x32_bf16 v[108:111], a[12:15], a[12:15], v[108:111]
  s_add_u32 m0, s21, 131072
  ds_read_b128 v[224:227], v241 offset:20480
  ds_read_b128 a[52:55], v5 offset:28672
  v_mfma_f32_16x16x32_bf16 v[56:59], v[36:39], a[12:15], v[56:59]
  s_add_u32 s38, s71, 2048
  buffer_load_dwordx4 v11, s[8:11], s38 offen offset:0 lds
  v_mfma_f32_16x16x32_bf16 v[52:55], v[36:39], a[8:11], v[52:55]
  s_add_u32 s39, s71, 295936
  buffer_load_dwordx4 v11, s[8:11], s39 offen offset:1024 lds
  v_mfma_f32_16x16x32_bf16 v[48:51], v[36:39], a[4:7], v[48:51]
  s_add_u32 s23, s23, 128
  s_cmp_eq_u32 s23, 1152
  s_cselect_b32 s23, 0, s23
  ds_read_b128 a[36:39], v5 offset:20480
  v_mfma_f32_16x16x32_bf16 v[44:47], v[36:39], a[0:3], v[44:47]
  ds_read_b128 a[40:43], v5 offset:22528
  ds_read_b128 a[44:47], v5 offset:24576
  v_mfma_f32_16x16x32_bf16 v[40:43], v[36:39], v[216:219], v[40:43]
  s_waitcnt lgkmcnt(7)
  ds_read_b128 a[48:51], v5 offset:26624
  v_mfma_f32_16x16x32_bf16 v[104:107], v[112:115], v[220:223], v[104:107]
  s_waitcnt vmcnt(10) lgkmcnt(6)
  v_mfma_f32_16x16x32_bf16 v[246:249], v[220:223], v[220:223], v[246:249]
  s_barrier
  v_mfma_f32_16x16x32_bf16 v[108:111], a[32:35], a[32:35], v[108:111]
  s_add_u32 m0, s60, 61440
  ds_read_b64_tr_b16 v[36:37], v3 offset:14336
  ds_read_b64_tr_b16 v[38:39], v3 offset:14848
  v_mfma_f32_16x16x32_bf16 v[40:43], v[28:31], a[16:19], v[40:43]
  s_add_u32 s70, s23, 36864
  buffer_load_dwordx4 v13, s[4:7], s23 offen lds
  v_mfma_f32_16x16x32_bf16 v[44:47], v[28:31], a[20:23], v[44:47]
  s_add_u32 m0, s60, 65536
  ds_read_b128 v[228:231], v240 offset:30720
  ds_read_b128 a[72:75], v4 offset:38912
  v_mfma_f32_16x16x32_bf16 v[48:51], v[28:31], a[24:27], v[48:51]
  s_mul_i32 s71, s23, 4608
  buffer_load_dwordx4 v13, s[4:7], s70 offen lds
  v_mfma_f32_16x16x32_bf16 v[52:55], v[28:31], a[28:31], v[52:55]
  s_add_u32 m0, s61, 69632
  ds_read_b128 a[56:59], v4 offset:30720
  ds_read_b128 a[60:63], v4 offset:32768
  v_mfma_f32_16x16x32_bf16 v[56:59], v[28:31], a[32:35], v[56:59]
  s_waitcnt lgkmcnt(6)
  ds_read_b128 a[64:67], v4 offset:34816
  ds_read_b128 a[68:71], v4 offset:36864
  v_mfma_f32_16x16x32_bf16 v[104:107], v[112:115], v[224:227], v[104:107]
  ds_read_b64_tr_b16 v[28:29], v3 offset:24576
  ds_read_b64_tr_b16 v[30:31], v3 offset:25088
  v_mfma_f32_16x16x32_bf16 v[246:249], v[224:227], v[224:227], v[246:249]
  s_mov_b64 exec, s[62:63]
  buffer_load_dwordx4 v14, s[4:7], s23 offen lds
  s_mov_b64 exec, -1
  v_mfma_f32_16x16x32_bf16 v[108:111], a[52:55], a[52:55], v[108:111]
  s_add_u32 m0, s21, 131072
  ds_read_b128 v[220:223], v241 offset:30720
  ds_read_b128 a[92:95], v5 offset:38912
  v_mfma_f32_16x16x32_bf16 v[56:59], v[32:35], a[52:55], v[56:59]
  s_add_u32 s40, s71, 0
  buffer_load_dwordx4 v11, s[8:11], s40 offen offset:2048 lds
  v_mfma_f32_16x16x32_bf16 v[52:55], v[32:35], a[48:51], v[52:55]
  s_add_u32 m0, s21, 143360
  ds_read_b128 a[76:79], v5 offset:30720
  v_mfma_f32_16x16x32_bf16 v[48:51], v[32:35], a[44:47], v[48:51]
  s_add_u32 s41, s71, 296960
  buffer_load_dwordx4 v11, s[8:11], s41 offen offset:0 lds
  v_mfma_f32_16x16x32_bf16 v[44:47], v[32:35], a[40:43], v[44:47]
  s_add_u32 s23, s23, 128
  s_cmp_eq_u32 s23, 1152
  s_cselect_b32 s23, 0, s23
  ds_read_b128 a[80:83], v5 offset:32768
  ds_read_b128 a[84:87], v5 offset:34816
  v_mfma_f32_16x16x32_bf16 v[40:43], v[32:35], a[36:39], v[40:43]
  s_waitcnt lgkmcnt(7)
  ds_read_b128 a[88:91], v5 offset:36864
  v_mfma_f32_16x16x32_bf16 v[104:107], v[112:115], v[228:231], v[104:107]
  s_waitcnt vmcnt(10) lgkmcnt(6)
  v_mfma_f32_16x16x32_bf16 v[246:249], v[228:231], v[228:231], v[246:249]
  s_barrier
  v_mfma_f32_16x16x32_bf16 v[108:111], a[72:75], a[72:75], v[108:111]
  s_add_u32 m0, s60, 71680
  ds_read_b64_tr_b16 v[32:33], v3 offset:25600
  ds_read_b64_tr_b16 v[34:35], v3 offset:26112
  v_mfma_f32_16x16x32_bf16 v[40:43], v[36:39], a[56:59], v[40:43]
  s_add_u32 s70, s23, 36864
  buffer_load_dwordx4 v13, s[4:7], s23 offen lds
  v_mfma_f32_16x16x32_bf16 v[44:47], v[36:39], a[60:63], v[44:47]
  s_add_u32 m0, s60, 75776
  ds_read_b128 v[224:227], v242 offset:0
  ds_read_b128 a[112:115], v6 offset:8192
  v_mfma_f32_16x16x32_bf16 v[48:51], v[36:39], a[64:67], v[48:51]
  s_mul_i32 s71, s23, 4608
  buffer_load_dwordx4 v13, s[4:7], s70 offen lds
  v_mfma_f32_16x16x32_bf16 v[52:55], v[36:39], a[68:71], v[52:55]
  s_add_u32 m0, s61, 79872
  ds_read_b128 a[96:99], v6 offset:0
  ds_read_b128 a[100:103], v6 offset:2048
  v_mfma_f32_16x16x32_bf16 v[56:59], v[36:39], a[72:75], v[56:59]
  s_waitcnt lgkmcnt(6)
  ds_read_b128 a[104:107], v6 offset:4096
  ds_read_b128 a[108:111], v6 offset:6144
  v_mfma_f32_16x16x32_bf16 v[104:107], v[112:115], v[220:223], v[104:107]
  ds_read_b64_tr_b16 v[36:37], v3 offset:26624
  ds_read_b64_tr_b16 v[38:39], v3 offset:27136
  v_mfma_f32_16x16x32_bf16 v[246:249], v[220:223], v[220:223], v[246:249]
  s_mov_b64 exec, s[62:63]
  buffer_load_dwordx4 v14, s[4:7], s23 offen lds
  s_mov_b64 exec, -1
  v_mfma_f32_16x16x32_bf16 v[108:111], a[92:95], a[92:95], v[108:111]
  s_add_u32 m0, s21, 143360
  ds_read_b128 v[228:231], v243 offset:0
  ds_read_b128 a[132:135], v7 offset:8192
  v_mfma_f32_16x16x32_bf16 v[56:59], v[28:31], a[92:95], v[56:59]
  s_add_u32 s42, s71, 1024
  buffer_load_dwordx4 v11, s[8:11], s42 offen offset:1024 lds
  v_mfma_f32_16x16x32_bf16 v[52:55], v[28:31], a[88:91], v[52:55]
  s_add_u32 s43, s71, 294912
  buffer_load_dwordx4 v11, s[8:11], s43 offen offset:2048 lds
  v_mfma_f32_16x16x32_bf16 v[48:51], v[28:31], a[84:87], v[48:51]
  ds_read_b128 a[116:119], v7 offset:0
  v_mfma_f32_16x16x32_bf16 v[44:47], v[28:31], a[80:83], v[44:47]
  ds_read_b128 a[120:123], v7 offset:2048
  ds_read_b128 a[124:127], v7 offset:4096
  v_mfma_f32_16x16x32_bf16 v[40:43], v[28:31], a[76:79], v[40:43]
  s_waitcnt lgkmcnt(7)
  ds_read_b128 a[128:131], v7 offset:6144
  v_mfma_f32_16x16x32_bf16 v[104:107], v[112:115], v[224:227], v[104:107]
  s_waitcnt vmcnt(10) lgkmcnt(6)
  v_add_u32 v14, 128, v11
  v_add_u32 v11, s90, v14
  v_mfma_f32_16x16x32_bf16 v[246:249], v[224:227], v[224:227], v[246:249]
  s_barrier
  v_mfma_f32_16x16x32_bf16 v[108:111], a[112:115], a[112:115], v[108:111]
  ds_read_b64_tr_b16 v[28:29], v3 offset:36864
  ds_read_b64_tr_b16 v[30:31], v3 offset:37376
  v_mfma_f32_16x16x32_bf16 v[40:43], v[32:35], a[96:99], v[40:43]
  s_add_u32 m0, s21, 81920
  ds_read_b128 v[220:223], v242 offset:10240
  ds_read_b128 a[152:155], v6 offset:18432
  v_mfma_f32_16x16x32_bf16 v[44:47], v[32:35], a[100:103], v[44:47]
  buffer_load_dwordx4 v11, s[8:11], s26 offen offset:0 lds
  v_mfma_f32_16x16x32_bf16 v[48:51], v[32:35], a[104:107], v[48:51]
  buffer_load_dwordx4 v11, s[8:11], s27 offen offset:1024 lds
  v_mfma_f32_16x16x32_bf16 v[52:55], v[32:35], a[108:111], v[52:55]
  ds_read_b128 a[136:139], v6 offset:10240
  ds_read_b128 a[140:143], v6 offset:12288
  v_mfma_f32_16x16x32_bf16 v[56:59], v[32:35], a[112:115], v[56:59]
  s_waitcnt lgkmcnt(6)
  ds_read_b128 a[144:147], v6 offset:14336
  ds_read_b128 a[148:151], v6 offset:16384
  v_mfma_f32_16x16x32_bf16 v[104:107], v[112:115], v[228:231], v[104:107]
  ds_read_b64_tr_b16 v[32:33], v3 offset:37888
  ds_read_b64_tr_b16 v[34:35], v3 offset:38400
  v_mfma_f32_16x16x32_bf16 v[246:249], v[228:231], v[228:231], v[246:249]
  buffer_load_dwordx4 v11, s[8:11], s28 offen offset:2048 lds
  v_mfma_f32_16x16x32_bf16 v[108:111], a[132:135], a[132:135], v[108:111]
  s_add_u32 m0, s21, 94208
  ds_read_b128 v[224:227], v243 offset:10240
  ds_read_b128 a[172:175], v7 offset:18432
  v_mfma_f32_16x16x32_bf16 v[56:59], v[36:39], a[132:135], v[56:59]
  buffer_load_dwordx4 v11, s[8:11], s29 offen offset:0 lds
  v_mfma_f32_16x16x32_bf16 v[52:55], v[36:39], a[128:131], v[52:55]
  ds_read_b128 a[156:159], v7 offset:10240
  v_mfma_f32_16x16x32_bf16 v[48:51], v[36:39], a[124:127], v[48:51]
  ds_read_b128 a[160:163], v7 offset:12288
  v_mfma_f32_16x16x32_bf16 v[44:47], v[36:39], a[120:123], v[44:47]
  ds_read_b128 a[164:167], v7 offset:14336
  v_mfma_f32_16x16x32_bf16 v[40:43], v[36:39], a[116:119], v[40:43]
  s_waitcnt lgkmcnt(7)
  ds_read_b128 a[168:171], v7 offset:16384
  v_mfma_f32_16x16x32_bf16 v[104:107], v[112:115], v[220:223], v[104:107]
  s_waitcnt vmcnt(9) lgkmcnt(6)
  v_mfma_f32_16x16x32_bf16 v[246:249], v[220:223], v[220:223], v[246:249]
  s_barrier
  v_mfma_f32_16x16x32_bf16 v[108:111], a[152:155], a[152:155], v[108:111]
  ds_read_b64_tr_b16 v[36:37], v3 offset:38912
  ds_read_b64_tr_b16 v[38:39], v3 offset:39424
  v_mfma_f32_16x16x32_bf16 v[40:43], v[28:31], a[136:139], v[40:43]
  buffer_load_dwordx4 v11, s[8:11], s30 offen offset:1024 lds
  v_mfma_f32_16x16x32_bf16 v[44:47], v[28:31], a[140:143], v[44:47]
  buffer_load_dwordx4 v11, s[8:11], s31 offen offset:2048 lds
  v_mfma_f32_16x16x32_bf16 v[48:51], v[28:31], a[144:147], v[48:51]
  ds_read_b128 v[228:231], v242 offset:20480
  ds_read_b128 a[192:195], v6 offset:28672
  v_mfma_f32_16x16x32_bf16 v[52:55], v[28:31], a[148:151], v[52:55]
  ds_read_b128 a[176:179], v6 offset:20480
  ds_read_b128 a[180:183], v6 offset:22528
  v_mfma_f32_16x16x32_bf16 v[56:59], v[28:31], a[152:155], v[56:59]
  s_waitcnt lgkmcnt(6)
  ds_read_b128 a[184:187], v6 offset:24576
  ds_read_b128 a[188:191], v6 offset:26624
  v_mfma_f32_16x16x32_bf16 v[104:107], v[112:115], v[224:227], v[104:107]
  ds_read_b64_tr_b16 v[28:29], v3 offset:49152
  ds_read_b64_tr_b16 v[30:31], v3 offset:49664
  v_mfma_f32_16x16x32_bf16 v[246:249], v[224:227], v[224:227], v[246:249]
  s_add_u32 m0, s21, 106496
  ds_read_b128 v[220:223], v243 offset:20480
  ds_read_b128 a[212:215], v7 offset:28672
  v_mfma_f32_16x16x32_bf16 v[108:111], a[172:175], a[172:175], v[108:111]
  buffer_load_dwordx4 v11, s[8:11], s32 offen offset:0 lds
  v_mfma_f32_16x16x32_bf16 v[56:59], v[32:35], a[172:175], v[56:59]
  buffer_load_dwordx4 v11, s[8:11], s33 offen offset:1024 lds
  v_mfma_f32_16x16x32_bf16 v[52:55], v[32:35], a[168:171], v[52:55]
  ds_read_b128 a[196:199], v7 offset:20480
  v_mfma_f32_16x16x32_bf16 v[48:51], v[32:35], a[164:167], v[48:51]
  ds_read_b128 a[200:203], v7 offset:22528
  v_mfma_f32_16x16x32_bf16 v[44:47], v[32:35], a[160:163], v[44:47]
  ds_read_b128 a[204:207], v7 offset:24576
  v_mfma_f32_16x16x32_bf16 v[40:43], v[32:35], a[156:159], v[40:43]
  s_waitcnt lgkmcnt(7)
  ds_read_b128 a[208:211], v7 offset:26624
  v_mfma_f32_16x16x32_bf16 v[104:107], v[112:115], v[228:231], v[104:107]
  s_waitcnt vmcnt(8) lgkmcnt(6)
  v_mfma_f32_16x16x32_bf16 v[246:249], v[228:231], v[228:231], v[246:249]
  s_barrier
  v_mfma_f32_16x16x32_bf16 v[108:111], a[192:195], a[192:195], v[108:111]
  ds_read_b64_tr_b16 v[32:33], v3 offset:50176
  ds_read_b64_tr_b16 v[34:35], v3 offset:50688
  v_mfma_f32_16x16x32_bf16 v[40:43], v[36:39], a[176:179], v[40:43]
  buffer_load_dwordx4 v11, s[8:11], s34 offen offset:2048 lds
  v_mfma_f32_16x16x32_bf16 v[44:47], v[36:39], a[180:183], v[44:47]
  s_add_u32 m0, s21, 118784
  ds_read_b128 v[224:227], v242 offset:30720
  ds_read_b128 a[232:235], v6 offset:38912
  v_mfma_f32_16x16x32_bf16 v[48:51], v[36:39], a[184:187], v[48:51]
  buffer_load_dwordx4 v11, s[8:11], s35 offen offset:0 lds
  v_mfma_f32_16x16x32_bf16 v[52:55], v[36:39], a[188:191], v[52:55]
  ds_read_b128 a[216:219], v6 offset:30720
  ds_read_b128 a[220:223], v6 offset:32768
  v_mfma_f32_16x16x32_bf16 v[56:59], v[36:39], a[192:195], v[56:59]
  s_waitcnt lgkmcnt(6)
  ds_read_b128 a[224:227], v6 offset:34816
  ds_read_b128 a[228:231], v6 offset:36864
  v_mfma_f32_16x16x32_bf16 v[104:107], v[112:115], v[220:223], v[104:107]
  ds_read_b64_tr_b16 v[36:37], v3 offset:51200
  ds_read_b64_tr_b16 v[38:39], v3 offset:51712
  v_mfma_f32_16x16x32_bf16 v[246:249], v[220:223], v[220:223], v[246:249]
  buffer_load_dwordx4 v11, s[8:11], s36 offen offset:1024 lds
  v_mfma_f32_16x16x32_bf16 v[108:111], a[212:215], a[212:215], v[108:111]
  buffer_load_dwordx4 v11, s[8:11], s37 offen offset:2048 lds
  v_mfma_f32_16x16x32_bf16 v[56:59], v[28:31], a[212:215], v[56:59]
  ds_read_b128 v[228:231], v243 offset:30720
  ds_read_b128 a[252:255], v7 offset:38912
  v_mfma_f32_16x16x32_bf16 v[52:55], v[28:31], a[208:211], v[52:55]
  ds_read_b128 a[236:239], v7 offset:30720
  v_mfma_f32_16x16x32_bf16 v[48:51], v[28:31], a[204:207], v[48:51]
  ds_read_b128 a[240:243], v7 offset:32768
  v_mfma_f32_16x16x32_bf16 v[44:47], v[28:31], a[200:203], v[44:47]
  ds_read_b128 a[244:247], v7 offset:34816
  v_mfma_f32_16x16x32_bf16 v[40:43], v[28:31], a[196:199], v[40:43]
  s_waitcnt lgkmcnt(7)
  ds_read_b128 a[248:251], v7 offset:36864
  v_mfma_f32_16x16x32_bf16 v[104:107], v[112:115], v[224:227], v[104:107]
  s_waitcnt vmcnt(6) lgkmcnt(6)
  v_mfma_f32_16x16x32_bf16 v[246:249], v[224:227], v[224:227], v[246:249]
  s_barrier
  v_mfma_f32_16x16x32_bf16 v[108:111], a[232:235], a[232:235], v[108:111]
  ds_read_b64_tr_b16 v[28:29], v2 offset:49152
  ds_read_b64_tr_b16 v[30:31], v2 offset:49664
  v_mfma_f32_16x16x32_bf16 v[40:43], v[32:35], a[216:219], v[40:43]
  s_add_u32 m0, s21, 131072
  ds_read_b64 v[92:93], v250 offset:0
  v_mfma_f32_16x16x32_bf16 v[44:47], v[32:35], a[220:223], v[44:47]
  buffer_load_dwordx4 v11, s[8:11], s38 offen offset:0 lds
  v_mfma_f32_16x16x32_bf16 v[48:51], v[32:35], a[224:227], v[48:51]
  ds_read_b64 v[94:95], v250 offset:2048
  v_mfma_f32_16x16x32_bf16 v[52:55], v[32:35], a[228:231], v[52:55]
  v_mfma_f32_16x16x32_bf16 v[56:59], v[32:35], a[232:235], v[56:59]
  s_waitcnt lgkmcnt(4)
  ds_read_b64 v[96:97], v250 offset:4096
  v_mfma_f32_16x16x32_bf16 v[104:107], v[112:115], v[228:231], v[104:107]
  ds_read_b64_tr_b16 v[32:33], v2 offset:50176
  ds_read_b64_tr_b16 v[34:35], v2 offset:50688
  v_mfma_f32_16x16x32_bf16 v[246:249], v[228:231], v[228:231], v[246:249]
  buffer_load_dwordx4 v11, s[8:11], s39 offen offset:1024 lds
  v_mfma_f32_16x16x32_bf16 v[108:111], a[252:255], a[252:255], v[108:111]
  ds_read_b64 v[98:99], v250 offset:6144
  v_mfma_f32_16x16x32_bf16 v[76:79], v[36:39], a[252:255], v[56:59]
  v_mfma_f32_16x16x32_bf16 v[72:75], v[36:39], a[248:251], v[52:55]
  ds_read_b64 v[100:101], v250 offset:8192
  v_mfma_f32_16x16x32_bf16 v[68:71], v[36:39], a[244:247], v[48:51]
  ds_read_b64 v[102:103], v251 offset:0
  v_mfma_f32_16x16x32_bf16 v[64:67], v[36:39], a[240:243], v[44:47]
  v_mfma_f32_16x16x32_bf16 v[60:63], v[36:39], a[236:239], v[40:43]
  s_waitcnt lgkmcnt(8)
  s_mov_b32 s22, 3
  v_mfma_f32_16x16x32_bf16 v[40:43], v[28:31], v[116:119], 0
  s_mul_i32 s69, s64, 663552
  ds_read_b64_tr_b16 v[36:37], v2 offset:51200
  ds_read_b64_tr_b16 v[38:39], v2 offset:51712
  v_mfma_f32_16x16x32_bf16 v[44:47], v[28:31], v[120:123], 0
  s_mov_b32 s62, 0
  s_mov_b32 s63, 0xffff0000
  buffer_load_dwordx4 v11, s[8:11], s40 offen offset:2048 lds
  v_mfma_f32_16x16x32_bf16 v[48:51], v[28:31], v[124:127], 0
  s_add_u32 s23, s50, s69
  s_addc_u32 s54, s51, 0
  v_cndmask_b32 v104, v104, v111, s[62:63]
  v_mfma_f32_16x16x32_bf16 v[52:55], v[28:31], v[128:131], 0
  s_sub_u32 s23, s23, 2048
  s_subb_u32 s54, s54, 0
  ds_write_b32 v15, v104
  v_mfma_f32_16x16x32_bf16 v[56:59], v[28:31], v[132:135], 0
  s_waitcnt lgkmcnt(6)
  v_mfma_f32_16x16x32_bf16 v[56:59], v[32:35], v[152:155], v[56:59]
  s_add_u32 m0, s21, 143360
  ds_read_b64_tr_b16 v[28:29], v3 offset:0
  ds_read_b64_tr_b16 v[30:31], v3 offset:512
  v_mfma_f32_16x16x32_bf16 v[52:55], v[32:35], v[148:151], v[52:55]
  s_add_u32 s16, s23, 1024
  s_addc_u32 s17, s54, 0
  buffer_load_dwordx4 v11, s[8:11], s41 offen offset:0 lds
  v_mfma_f32_16x16x32_bf16 v[48:51], v[32:35], v[144:147], v[48:51]
  s_mov_b32 s62, 0xaaaaaaaa
  s_mov_b32 s63, 0xaaaaaaaa
  v_cndmask_b32 v246, v246, v247, s[62:63]
  v_cndmask_b32 v248, v248, v249, s[62:63]
  v_mfma_f32_16x16x32_bf16 v[44:47], v[32:35], v[140:143], v[44:47]
  s_lshl_b32 s91, s64, 7
  v_cndmask_b32 v108, v108, v109, s[62:63]
  v_cndmask_b32 v110, v110, v111, s[62:63]
  v_mfma_f32_16x16x32_bf16 v[40:43], v[32:35], v[136:139], v[40:43]
  s_waitcnt lgkmcnt(3)
  v_mfma_f32_16x16x32_bf16 v[40:43], v[36:39], v[156:159], v[40:43]
  s_add_u32 s90, s90, 128
  ds_read_b64_tr_b16 v[32:33], v3 offset:1024
  ds_read_b64_tr_b16 v[34:35], v3 offset:1536
  v_mfma_f32_16x16x32_bf16 v[44:47], v[36:39], v[160:163], v[44:47]
  s_and_b32 s90, s90, 1023
  buffer_load_dwordx4 v11, s[8:11], s42 offen offset:1024 lds
  v_mfma_f32_16x16x32_bf16 v[48:51], v[36:39], v[164:167], v[48:51]
  s_mov_b32 s62, 0xcccccccc
  s_mov_b32 s63, 0xcccccccc
  v_cndmask_b32 v252, v246, v248, s[62:63]
  v_cndmask_b32 v253, v108, v110, s[62:63]
  v_mfma_f32_16x16x32_bf16 v[52:55], v[36:39], v[168:171], v[52:55]
  s_sub_u32 s18, 5310464, s69
  v_mfma_f32_16x16x32_bf16 v[56:59], v[36:39], v[172:175], v[56:59]
  s_waitcnt lgkmcnt(2)
  v_mfma_f32_16x16x32_bf16 v[56:59], v[28:31], v[192:195], v[56:59]
  s_mov_b32 s19, 0x20000
  ds_read_b64_tr_b16 v[36:37], v3 offset:2048
  ds_read_b64_tr_b16 v[38:39], v3 offset:2560
  v_mfma_f32_16x16x32_bf16 v[52:55], v[28:31], v[188:191], v[52:55]
  s_lshl_b32 s69, s52, 3
  buffer_load_dwordx4 v11, s[8:11], s43 offen offset:2048 lds
  v_mfma_f32_16x16x32_bf16 v[48:51], v[28:31], v[184:187], v[48:51]
  s_add_u32 s69, s69, s64
  v_mfma_f32_16x16x32_bf16 v[44:47], v[28:31], v[180:183], v[44:47]
  s_mul_i32 s69, s69, 92160
  v_mfma_f32_16x16x32_bf16 v[40:43], v[28:31], v[176:179], v[40:43]
  s_waitcnt lgkmcnt(2)
  v_add_u32 v11, s90, v14
  v_mfma_f32_16x16x32_bf16 v[40:43], v[32:35], v[196:199], v[40:43]
  s_waitcnt vmcnt(6) lgkmcnt(0)
  v_mfma_f32_16x16x32_bf16 v[44:47], v[32:35], v[200:203], v[44:47]
  s_barrier
  v_mfma_f32_16x16x32_bf16 v[48:51], v[32:35], v[204:207], v[48:51]
  s_add_u32 m0, s21, 81920
  ds_read_b64_tr_b16 v[28:29], v3 offset:12288
  ds_read_b64_tr_b16 v[30:31], v3 offset:12800
  v_mfma_f32_16x16x32_bf16 v[52:55], v[32:35], v[208:211], v[52:55]
  s_add_u32 s12, s44, s69
  s_addc_u32 s13, s45, 0
  buffer_load_dwordx4 v11, s[8:11], s26 offen offset:0 lds
  v_mfma_f32_16x16x32_bf16 v[56:59], v[32:35], v[212:215], v[56:59]
  ds_read_b32 v17, v16 offset:0
  ds_read_b32 v18, v16 offset:64
  v_mfma_f32_16x16x32_bf16 v[56:59], v[36:39], a[12:15], v[56:59]
  s_mov_b32 s14, 92160
  ds_read_b64_tr_b16 v[32:33], v3 offset:13312
  ds_read_b64_tr_b16 v[34:35], v3 offset:13824
  v_mfma_f32_16x16x32_bf16 v[52:55], v[36:39], a[8:11], v[52:55]
L_fw0:
  s_cbranch_execz L_fw4
  s_mov_b32 s15, 0x20000
  buffer_load_dwordx4 v11, s[8:11], s27 offen offset:1024 lds
  v_mfma_f32_16x16x32_bf16 v[48:51], v[36:39], a[4:7], v[48:51]
  s_mov_b32 s46, 24182784
  ds_read_b32 v19, v16 offset:128
  v_mfma_f32_16x16x32_bf16 v[44:47], v[36:39], a[0:3], v[44:47]
  s_mov_b32 s47, 0x20000
  ds_read_b32 v20, v16 offset:192
  v_mfma_f32_16x16x32_bf16 v[40:43], v[36:39], v[216:219], v[40:43]
  s_waitcnt lgkmcnt(6)
  ds_read_b32 v21, v16 offset:256
  v_mfma_f32_16x16x32_bf16 v[40:43], v[28:31], a[16:19], v[40:43]
  s_lshl_b32 s69, s52, 2
  ds_read_b64_tr_b16 v[36:37], v3 offset:14336
  ds_read_b64_tr_b16 v[38:39], v3 offset:14848
  v_mfma_f32_16x16x32_bf16 v[44:47], v[28:31], a[20:23], v[44:47]
  s_add_u32 s48, s58, s69
  s_addc_u32 s49, s59, 0
  buffer_load_dwordx4 v11, s[8:11], s28 offen offset:2048 lds
  v_mfma_f32_16x16x32_bf16 v[48:51], v[28:31], a[24:27], v[48:51]
  s_mov_b32 s50, 4
  v_mfma_f32_16x16x32_bf16 v[52:55], v[28:31], a[28:31], v[52:55]
  s_mov_b32 s51, 0x20000
  v_mfma_f32_16x16x32_bf16 v[56:59], v[28:31], a[32:35], v[56:59]
  s_waitcnt lgkmcnt(2)
  v_mul_f32 v17, 0xbae38e39, v17
  v_mul_f32 v18, 0xbae38e39, v18
  v_mfma_f32_16x16x32_bf16 v[56:59], v[32:35], a[52:55], v[56:59]
  s_add_u32 m0, s21, 94208
  ds_read_b64_tr_b16 v[28:29], v3 offset:24576
  ds_read_b64_tr_b16 v[30:31], v3 offset:25088
  v_mfma_f32_16x16x32_bf16 v[52:55], v[32:35], a[48:51], v[52:55]
  s_mov_b32 s72, 2048
  buffer_load_dwordx4 v11, s[8:11], s29 offen offset:0 lds
  v_mfma_f32_16x16x32_bf16 v[48:51], v[32:35], a[44:47], v[48:51]
  s_mov_b32 s73, 19456
  v_mul_f32 v19, 0xbae38e39, v19
  v_mul_f32 v20, 0xbae38e39, v20
  v_mfma_f32_16x16x32_bf16 v[44:47], v[32:35], a[40:43], v[44:47]
  s_mov_b32 s74, 36864
  v_mul_f32 v21, 0xbae38e39, v21
  v_cvt_pk_bf16_f32 v17, v17, v17
  v_mfma_f32_16x16x32_bf16 v[40:43], v[32:35], a[36:39], v[40:43]
  s_waitcnt lgkmcnt(2)
  v_cvt_pk_bf16_f32 v18, v18, v18
  v_cvt_pk_bf16_f32 v19, v19, v19
  v_mfma_f32_16x16x32_bf16 v[40:43], v[36:39], a[56:59], v[40:43]
  s_mov_b32 s75, 57344
  ds_read_b64_tr_b16 v[32:33], v3 offset:25600
  ds_read_b64_tr_b16 v[34:35], v3 offset:26112
  v_mfma_f32_16x16x32_bf16 v[44:47], v[36:39], a[60:63], v[44:47]
  s_mov_b32 s76, 1024
  buffer_load_dwordx4 v11, s[8:11], s30 offen offset:1024 lds
  v_mfma_f32_16x16x32_bf16 v[48:51], v[36:39], a[64:67], v[48:51]
  s_mov_b32 s77, 18432
  v_cvt_pk_bf16_f32 v20, v20, v20
  v_cvt_pk_bf16_f32 v21, v21, v21
  v_mfma_f32_16x16x32_bf16 v[52:55], v[36:39], a[68:71], v[52:55]
  s_mov_b32 s78, 38912
  v_lshlrev_b32 v17, 16, v17
  v_lshlrev_b32 v18, 16, v18
  v_mfma_f32_16x16x32_bf16 v[56:59], v[36:39], a[72:75], v[56:59]
  s_waitcnt lgkmcnt(2)
  v_lshlrev_b32 v19, 16, v19
  v_lshlrev_b32 v20, 16, v20
  v_mfma_f32_16x16x32_bf16 v[56:59], v[28:31], a[92:95], v[56:59]
  s_mov_b32 s79, 56320
  ds_read_b64_tr_b16 v[36:37], v3 offset:26624
  ds_read_b64_tr_b16 v[38:39], v3 offset:27136
  v_mfma_f32_16x16x32_bf16 v[52:55], v[28:31], a[88:91], v[52:55]
  s_mov_b32 s80, 0
  buffer_load_dwordx4 v11, s[8:11], s31 offen offset:2048 lds
  v_mfma_f32_16x16x32_bf16 v[48:51], v[28:31], a[84:87], v[48:51]
  s_mov_b32 s81, 20480
  v_lshlrev_b32 v21, 16, v21
  v_fmac_f32_dpp v60, v76, v17 row_newbcast:15 row_mask:0xf bank_mask:0xf
  v_mfma_f32_16x16x32_bf16 v[44:47], v[28:31], a[80:83], v[44:47]
  s_mov_b32 s82, 37888
  v_fmac_f32_dpp v61, v77, v17 row_newbcast:15 row_mask:0xf bank_mask:0xf
  v_fmac_f32_dpp v62, v78, v17 row_newbcast:15 row_mask:0xf bank_mask:0xf
  v_mfma_f32_16x16x32_bf16 v[40:43], v[28:31], a[76:79], v[40:43]
  s_waitcnt lgkmcnt(2)
  v_fmac_f32_dpp v63, v79, v17 row_newbcast:15 row_mask:0xf bank_mask:0xf
  v_cvt_pk_bf16_f32 v60, v60, v61
  v_mfma_f32_16x16x32_bf16 v[40:43], v[32:35], a[96:99], v[40:43]
  s_waitcnt vmcnt(6) lgkmcnt(0)
  v_cvt_pk_bf16_f32 v61, v62, v63
  v_pk_max_i16 v220, v60, 0
  v_mfma_f32_16x16x32_bf16 v[44:47], v[32:35], a[100:103], v[44:47]
  s_barrier
  v_mfma_f32_16x16x32_bf16 v[48:51], v[32:35], a[104:107], v[48:51]
  s_add_u32 m0, s21, 106496
  ds_read_b64_tr_b16 v[28:29], v3 offset:36864
  ds_read_b64_tr_b16 v[30:31], v3 offset:37376
  v_mfma_f32_16x16x32_bf16 v[52:55], v[32:35], a[108:111], v[52:55]
  s_mov_b32 s83, 55296
  buffer_load_dwordx4 v11, s[8:11], s32 offen offset:0 lds
  v_mfma_f32_16x16x32_bf16 v[56:59], v[32:35], a[112:115], v[56:59]
  v_pk_max_i16 v221, v61, 0
  v_fmac_f32_dpp v64, v76, v18 row_newbcast:15 row_mask:0xf bank_mask:0xf
  v_mfma_f32_16x16x32_bf16 v[56:59], v[36:39], a[132:135], v[56:59]
  s_mov_b32 s84, 2048
  ds_read_b64_tr_b16 v[32:33], v3 offset:37888
  ds_read_b64_tr_b16 v[34:35], v3 offset:38400
  v_mfma_f32_16x16x32_bf16 v[52:55], v[36:39], a[128:131], v[52:55]
  s_mov_b32 s85, 19456
  buffer_load_dwordx4 v11, s[8:11], s33 offen offset:1024 lds
  v_mfma_f32_16x16x32_bf16 v[48:51], v[36:39], a[124:127], v[48:51]
  s_mov_b32 s86, 36864
  v_fmac_f32_dpp v65, v77, v18 row_newbcast:15 row_mask:0xf bank_mask:0xf
  v_fmac_f32_dpp v66, v78, v18 row_newbcast:15 row_mask:0xf bank_mask:0xf
  v_mfma_f32_16x16x32_bf16 v[44:47], v[36:39], a[120:123], v[44:47]
  s_mov_b32 s87, 57344
  v_fmac_f32_dpp v67, v79, v18 row_newbcast:15 row_mask:0xf bank_mask:0xf
  v_cvt_pk_bf16_f32 v64, v64, v65
  v_mfma_f32_16x16x32_bf16 v[40:43], v[36:39], a[116:119], v[40:43]
  s_waitcnt lgkmcnt(2)
  v_cvt_pk_bf16_f32 v65, v66, v67
  v_pk_max_i16 v224, v64, 0
  v_mfma_f32_16x16x32_bf16 v[40:43], v[28:31], a[136:139], v[40:43]
  s_mov_b32 s88, 1024
  ds_read_b64_tr_b16 v[36:37], v3 offset:38912
  ds_read_b64_tr_b16 v[38:39], v3 offset:39424
  v_mfma_f32_16x16x32_bf16 v[44:47], v[28:31], a[140:143], v[44:47]
  s_mov_b32 s89, 36864
  buffer_load_dwordx4 v11, s[8:11], s34 offen offset:2048 lds
  v_mfma_f32_16x16x32_bf16 v[48:51], v[28:31], a[144:147], v[48:51]
  v_pk_max_i16 v225, v65, 0
  v_fmac_f32_dpp v68, v76, v19 row_newbcast:15 row_mask:0xf bank_mask:0xf
  v_mfma_f32_16x16x32_bf16 v[52:55], v[28:31], a[148:151], v[52:55]
  v_fmac_f32_dpp v69, v77, v19 row_newbcast:15 row_mask:0xf bank_mask:0xf
  v_fmac_f32_dpp v70, v78, v19 row_newbcast:15 row_mask:0xf bank_mask:0xf
  v_mfma_f32_16x16x32_bf16 v[56:59], v[28:31], a[152:155], v[56:59]
  s_waitcnt lgkmcnt(2)
  v_fmac_f32_dpp v71, v79, v19 row_newbcast:15 row_mask:0xf bank_mask:0xf
  v_cvt_pk_bf16_f32 v68, v68, v69
  v_mfma_f32_16x16x32_bf16 v[56:59], v[32:35], a[172:175], v[56:59]
  s_add_u32 m0, s21, 118784
  ds_read_b64_tr_b16 v[28:29], v3 offset:49152
  ds_read_b64_tr_b16 v[30:31], v3 offset:49664
  v_mfma_f32_16x16x32_bf16 v[52:55], v[32:35], a[168:171], v[52:55]
  buffer_load_dwordx4 v11, s[8:11], s35 offen offset:0 lds
  v_mfma_f32_16x16x32_bf16 v[48:51], v[32:35], a[164:167], v[48:51]
  v_cvt_pk_bf16_f32 v69, v70, v71
  v_pk_max_i16 v228, v68, 0
  v_mfma_f32_16x16x32_bf16 v[44:47], v[32:35], a[160:163], v[44:47]
  v_pk_max_i16 v229, v69, 0
  v_fmac_f32_dpp v72, v76, v20 row_newbcast:15 row_mask:0xf bank_mask:0xf
  v_mfma_f32_16x16x32_bf16 v[40:43], v[32:35], a[156:159], v[40:43]
  s_waitcnt lgkmcnt(2)
  v_fmac_f32_dpp v73, v77, v20 row_newbcast:15 row_mask:0xf bank_mask:0xf
  v_fmac_f32_dpp v74, v78, v20 row_newbcast:15 row_mask:0xf bank_mask:0xf
  v_mfma_f32_16x16x32_bf16 v[40:43], v[36:39], a[176:179], v[40:43]
  ds_read_b64_tr_b16 v[32:33], v3 offset:50176
  ds_read_b64_tr_b16 v[34:35], v3 offset:50688
  v_mfma_f32_16x16x32_bf16 v[44:47], v[36:39], a[180:183], v[44:47]
  buffer_load_dwordx4 v11, s[8:11], s36 offen offset:1024 lds
  v_mfma_f32_16x16x32_bf16 v[48:51], v[36:39], a[184:187], v[48:51]
  v_fmac_f32_dpp v75, v79, v20 row_newbcast:15 row_mask:0xf bank_mask:0xf
  v_cvt_pk_bf16_f32 v72, v72, v73
  v_mfma_f32_16x16x32_bf16 v[52:55], v[36:39], a[188:191], v[52:55]
  v_cvt_pk_bf16_f32 v73, v74, v75
  v_pk_max_i16 v232, v72, 0
  v_mfma_f32_16x16x32_bf16 v[56:59], v[36:39], a[192:195], v[56:59]
  s_waitcnt lgkmcnt(2)
  v_pk_max_i16 v233, v73, 0
  v_fmac_f32_dpp v76, v76, v21 row_newbcast:15 row_mask:0xf bank_mask:0xf
  v_mfma_f32_16x16x32_bf16 v[56:59], v[28:31], a[212:215], v[56:59]
  ds_read_b64_tr_b16 v[36:37], v3 offset:51200
  ds_read_b64_tr_b16 v[38:39], v3 offset:51712
  v_mfma_f32_16x16x32_bf16 v[52:55], v[28:31], a[208:211], v[52:55]
  buffer_load_dwordx4 v11, s[8:11], s37 offen offset:2048 lds
  v_mfma_f32_16x16x32_bf16 v[48:51], v[28:31], a[204:207], v[48:51]
  v_fmac_f32_dpp v77, v77, v21 row_newbcast:15 row_mask:0xf bank_mask:0xf
  v_fmac_f32_dpp v78, v78, v21 row_newbcast:15 row_mask:0xf bank_mask:0xf
  v_mfma_f32_16x16x32_bf16 v[44:47], v[28:31], a[200:203], v[44:47]
  v_fmac_f32_dpp v79, v79, v21 row_newbcast:15 row_mask:0xf bank_mask:0xf
  v_cvt_pk_bf16_f32 v76, v76, v77
  v_mfma_f32_16x16x32_bf16 v[40:43], v[28:31], a[196:199], v[40:43]
  s_waitcnt lgkmcnt(2)
  v_cvt_pk_bf16_f32 v77, v78, v79
  v_pk_max_i16 v236, v76, 0
  v_mfma_f32_16x16x32_bf16 v[40:43], v[32:35], a[216:219], v[40:43]
  s_waitcnt vmcnt(6) lgkmcnt(0)
  v_pk_max_i16 v237, v77, 0
  v_mfma_f32_16x16x32_bf16 v[44:47], v[32:35], a[220:223], v[44:47]
  s_barrier
  v_mfma_f32_16x16x32_bf16 v[48:51], v[32:35], a[224:227], v[48:51]
  s_add_u32 m0, s21, 131072
  ds_read_b64_tr_b16 v[240:241], v2 offset:49152
  ds_read_b64_tr_b16 v[242:243], v2 offset:49664
  v_mfma_f32_16x16x32_bf16 v[52:55], v[32:35], a[228:231], v[52:55]
  buffer_load_dwordx4 v11, s[8:11], s38 offen offset:0 lds
  v_mfma_f32_16x16x32_bf16 v[56:59], v[32:35], a[232:235], v[56:59]
  ds_read_b64_tr_b16 v[244:245], v2 offset:50176
  ds_read_b64_tr_b16 v[246:247], v2 offset:50688
  v_mfma_f32_16x16x32_bf16 v[76:79], v[36:39], a[252:255], v[56:59]
  ds_read_b64_tr_b16 v[248:249], v2 offset:51200
  ds_read_b64_tr_b16 v[250:251], v2 offset:51712
  v_mfma_f32_16x16x32_bf16 v[72:75], v[36:39], a[248:251], v[52:55]
  buffer_load_dwordx4 v11, s[8:11], s39 offen offset:1024 lds
  v_mfma_f32_16x16x32_bf16 v[68:71], v[36:39], a[244:247], v[48:51]
  v_mfma_f32_16x16x32_bf16 v[64:67], v[36:39], a[240:243], v[44:47]
  v_mfma_f32_16x16x32_bf16 v[60:63], v[36:39], a[236:239], v[40:43]
  s_waitcnt lgkmcnt(2)
L_B1:
  v_mfma_f32_16x16x32_bf16 v[40:43], v[240:243], v[116:119], 0
  v_mfma_f32_16x16x32_bf16 v[40:43], v[244:247], v[136:139], v[40:43]
  s_waitcnt lgkmcnt(0)
  buffer_load_dwordx4 v11, s[8:11], s40 offen offset:2048 lds
  v_mfma_f32_16x16x32_bf16 v[40:43], v[248:251], v[156:159], v[40:43]
  v_mfma_f32_16x16x32_bf16 v[44:47], v[248:251], v[160:163], 0
  v_mfma_f32_16x16x32_bf16 v[44:47], v[244:247], v[140:143], v[44:47]
  v_fmac_f32_dpp v60, v76, v17 row_newbcast:15 row_mask:0xf bank_mask:0xf
  v_fmac_f32_dpp v61, v77, v17 row_newbcast:15 row_mask:0xf bank_mask:0xf
  v_mfma_f32_16x16x32_bf16 v[44:47], v[240:243], v[120:123], v[44:47]
  s_add_u32 m0, s21, 143360
  ds_read_b64_tr_b16 v[28:29], v3 offset:0
  ds_read_b64_tr_b16 v[30:31], v3 offset:512
  v_mfma_f32_16x16x32_bf16 v[48:51], v[240:243], v[124:127], 0
  buffer_load_dwordx4 v11, s[8:11], s41 offen offset:0 lds
  v_mfma_f32_16x16x32_bf16 v[48:51], v[244:247], v[144:147], v[48:51]
  ds_read_b64_tr_b16 v[32:33], v3 offset:1024
  ds_read_b64_tr_b16 v[34:35], v3 offset:1536
  v_mfma_f32_16x16x32_bf16 v[48:51], v[248:251], v[164:167], v[48:51]
  v_fmac_f32_dpp v62, v78, v17 row_newbcast:15 row_mask:0xf bank_mask:0xf
  v_fmac_f32_dpp v63, v79, v17 row_newbcast:15 row_mask:0xf bank_mask:0xf
  v_mfma_f32_16x16x32_bf16 v[52:55], v[248:251], v[168:171], 0
  v_cvt_pk_bf16_f32 v60, v60, v61
  v_cvt_pk_bf16_f32 v61, v62, v63
  v_mfma_f32_16x16x32_bf16 v[52:55], v[244:247], v[148:151], v[52:55]
  s_add_u32 s90, s90, 128
  ds_read_b64_tr_b16 v[36:37], v3 offset:2048
  ds_read_b64_tr_b16 v[38:39], v3 offset:2560
  v_mfma_f32_16x16x32_bf16 v[52:55], v[240:243], v[128:131], v[52:55]
  s_and_b32 s90, s90, 1023
  buffer_load_dwordx4 v11, s[8:11], s42 offen offset:1024 lds
  v_mfma_f32_16x16x32_bf16 v[56:59], v[240:243], v[132:135], 0
  v_pk_max_i16 v222, v60, 0
  v_pk_max_i16 v223, v61, 0
  v_mfma_f32_16x16x32_bf16 v[56:59], v[244:247], v[152:155], v[56:59]
  v_fmac_f32_dpp v64, v76, v18 row_newbcast:15 row_mask:0xf bank_mask:0xf
  v_fmac_f32_dpp v65, v77, v18 row_newbcast:15 row_mask:0xf bank_mask:0xf
  v_mfma_f32_16x16x32_bf16 v[56:59], v[248:251], v[172:175], v[56:59]
  s_waitcnt lgkmcnt(2)
  v_fmac_f32_dpp v66, v78, v18 row_newbcast:15 row_mask:0xf bank_mask:0xf
  v_fmac_f32_dpp v67, v79, v18 row_newbcast:15 row_mask:0xf bank_mask:0xf
  v_mfma_f32_16x16x32_bf16 v[56:59], v[28:31], v[192:195], v[56:59]
  v_cvt_pk_bf16_f32 v64, v64, v65
  v_cvt_pk_bf16_f32 v65, v66, v67
  v_mfma_f32_16x16x32_bf16 v[56:59], v[32:35], v[212:215], v[56:59]
  s_waitcnt lgkmcnt(0)
  buffer_load_dwordx4 v11, s[8:11], s43 offen offset:2048 lds
  v_mfma_f32_16x16x32_bf16 v[56:59], v[36:39], a[12:15], v[56:59]
  v_pk_max_i16 v226, v64, 0
  v_pk_max_i16 v227, v65, 0
  v_mfma_f32_16x16x32_bf16 v[52:55], v[36:39], a[8:11], v[52:55]
  v_fmac_f32_dpp v68, v76, v19 row_newbcast:15 row_mask:0xf bank_mask:0xf
  v_fmac_f32_dpp v69, v77, v19 row_newbcast:15 row_mask:0xf bank_mask:0xf
  v_mfma_f32_16x16x32_bf16 v[52:55], v[32:35], v[208:211], v[52:55]
  v_add_u32 v11, s90, v14
  v_fmac_f32_dpp v70, v78, v19 row_newbcast:15 row_mask:0xf bank_mask:0xf
  v_mfma_f32_16x16x32_bf16 v[52:55], v[28:31], v[188:191], v[52:55]
  s_waitcnt vmcnt(6)
  v_fmac_f32_dpp v71, v79, v19 row_newbcast:15 row_mask:0xf bank_mask:0xf
  v_cvt_pk_bf16_f32 v68, v68, v69
  v_mfma_f32_16x16x32_bf16 v[48:51], v[28:31], v[184:187], v[48:51]
  s_barrier
  v_mfma_f32_16x16x32_bf16 v[48:51], v[32:35], v[204:207], v[48:51]
  s_add_u32 m0, s21, 81920
  ds_read_b64_tr_b16 v[240:241], v3 offset:12288
  ds_read_b64_tr_b16 v[242:243], v3 offset:12800
  v_mfma_f32_16x16x32_bf16 v[48:51], v[36:39], a[4:7], v[48:51]
  buffer_load_dwordx4 v11, s[8:11], s26 offen offset:0 lds
  v_mfma_f32_16x16x32_bf16 v[44:47], v[36:39], a[0:3], v[44:47]
  ds_read_b64_tr_b16 v[244:245], v3 offset:13312
  ds_read_b64_tr_b16 v[246:247], v3 offset:13824
  v_mfma_f32_16x16x32_bf16 v[44:47], v[32:35], v[200:203], v[44:47]
  ds_read_b64_tr_b16 v[248:249], v3 offset:14336
  ds_read_b64_tr_b16 v[250:251], v3 offset:14848
  v_mfma_f32_16x16x32_bf16 v[44:47], v[28:31], v[180:183], v[44:47]
  buffer_load_dwordx4 v11, s[8:11], s27 offen offset:1024 lds
  v_mfma_f32_16x16x32_bf16 v[40:43], v[28:31], v[176:179], v[40:43]
  ds_write_b128 v10, v[220:223] offset:0
  v_cvt_pk_bf16_f32 v69, v70, v71
  v_mfma_f32_16x16x32_bf16 v[40:43], v[32:35], v[196:199], v[40:43]
  v_pk_max_i16 v230, v68, 0
  v_pk_max_i16 v231, v69, 0
  v_mfma_f32_16x16x32_bf16 v[40:43], v[36:39], v[216:219], v[40:43]
  s_waitcnt lgkmcnt(3)
  v_fmac_f32_dpp v72, v76, v20 row_newbcast:15 row_mask:0xf bank_mask:0xf
  v_fmac_f32_dpp v73, v77, v20 row_newbcast:15 row_mask:0xf bank_mask:0xf
  v_mfma_f32_16x16x32_bf16 v[40:43], v[240:243], a[16:19], v[40:43]
  v_fmac_f32_dpp v74, v78, v20 row_newbcast:15 row_mask:0xf bank_mask:0xf
  v_fmac_f32_dpp v75, v79, v20 row_newbcast:15 row_mask:0xf bank_mask:0xf
  v_mfma_f32_16x16x32_bf16 v[40:43], v[244:247], a[36:39], v[40:43]
  s_waitcnt lgkmcnt(1)
  buffer_load_dwordx4 v11, s[8:11], s28 offen offset:2048 lds
  v_mfma_f32_16x16x32_bf16 v[40:43], v[248:251], a[56:59], v[40:43]
  v_cvt_pk_bf16_f32 v72, v72, v73
  v_cvt_pk_bf16_f32 v73, v74, v75
  v_mfma_f32_16x16x32_bf16 v[44:47], v[248:251], a[60:63], v[44:47]
  v_pk_max_i16 v234, v72, 0
  v_pk_max_i16 v235, v73, 0
  v_mfma_f32_16x16x32_bf16 v[44:47], v[244:247], a[40:43], v[44:47]
  v_fmac_f32_dpp v76, v76, v21 row_newbcast:15 row_mask:0xf bank_mask:0xf
  v_fmac_f32_dpp v77, v77, v21 row_newbcast:15 row_mask:0xf bank_mask:0xf
  v_mfma_f32_16x16x32_bf16 v[44:47], v[240:243], a[20:23], v[44:47]
  s_add_u32 m0, s21, 94208
  ds_read_b64_tr_b16 v[28:29], v3 offset:24576
  ds_read_b64_tr_b16 v[30:31], v3 offset:25088
  v_mfma_f32_16x16x32_bf16 v[48:51], v[240:243], a[24:27], v[48:51]
  buffer_load_dwordx4 v11, s[8:11], s29 offen offset:0 lds
  v_mfma_f32_16x16x32_bf16 v[48:51], v[244:247], a[44:47], v[48:51]
  ds_read_b64_tr_b16 v[32:33], v3 offset:25600
  ds_read_b64_tr_b16 v[34:35], v3 offset:26112
  v_mfma_f32_16x16x32_bf16 v[48:51], v[248:251], a[64:67], v[48:51]
  v_fmac_f32_dpp v78, v78, v21 row_newbcast:15 row_mask:0xf bank_mask:0xf
  v_fmac_f32_dpp v79, v79, v21 row_newbcast:15 row_mask:0xf bank_mask:0xf
  v_mfma_f32_16x16x32_bf16 v[52:55], v[248:251], a[68:71], v[52:55]
  v_cvt_pk_bf16_f32 v76, v76, v77
  v_cvt_pk_bf16_f32 v77, v78, v79
  v_mfma_f32_16x16x32_bf16 v[52:55], v[244:247], a[48:51], v[52:55]
  ds_read_b64_tr_b16 v[36:37], v3 offset:26624
  ds_read_b64_tr_b16 v[38:39], v3 offset:27136
  v_mfma_f32_16x16x32_bf16 v[52:55], v[240:243], a[28:31], v[52:55]
  buffer_load_dwordx4 v11, s[8:11], s30 offen offset:1024 lds
  v_mfma_f32_16x16x32_bf16 v[56:59], v[240:243], a[32:35], v[56:59]
  v_pk_max_i16 v238, v76, 0
  v_pk_max_i16 v239, v77, 0
  v_mfma_f32_16x16x32_bf16 v[56:59], v[244:247], a[52:55], v[56:59]
  v_mfma_f32_16x16x32_bf16 v[56:59], v[248:251], a[72:75], v[56:59]
  s_waitcnt lgkmcnt(2)
  v_mfma_f32_16x16x32_bf16 v[56:59], v[28:31], a[92:95], v[56:59]
  v_mfma_f32_16x16x32_bf16 v[56:59], v[32:35], a[112:115], v[56:59]
  s_waitcnt lgkmcnt(0)
  buffer_load_dwordx4 v11, s[8:11], s31 offen offset:2048 lds
  v_mfma_f32_16x16x32_bf16 v[56:59], v[36:39], a[132:135], v[56:59]
  v_mfma_f32_16x16x32_bf16 v[52:55], v[36:39], a[128:131], v[52:55]
  v_mfma_f32_16x16x32_bf16 v[52:55], v[32:35], a[108:111], v[52:55]
  v_mfma_f32_16x16x32_bf16 v[52:55], v[28:31], a[88:91], v[52:55]
  s_waitcnt vmcnt(6)
  v_mfma_f32_16x16x32_bf16 v[48:51], v[28:31], a[84:87], v[48:51]
  s_barrier
  v_mfma_f32_16x16x32_bf16 v[48:51], v[32:35], a[104:107], v[48:51]
  s_add_u32 m0, s21, 106496
  ds_read_b64_tr_b16 v[240:241], v3 offset:36864
  ds_read_b64_tr_b16 v[242:243], v3 offset:37376
  v_mfma_f32_16x16x32_bf16 v[48:51], v[36:39], a[124:127], v[48:51]
  buffer_load_dwordx4 v11, s[8:11], s32 offen offset:0 lds
  v_mfma_f32_16x16x32_bf16 v[44:47], v[36:39], a[120:123], v[44:47]
  ds_read_b64_tr_b16 v[244:245], v3 offset:37888
  ds_read_b64_tr_b16 v[246:247], v3 offset:38400
  v_mfma_f32_16x16x32_bf16 v[44:47], v[32:35], a[100:103], v[44:47]
  ds_read_b64_tr_b16 v[248:249], v3 offset:38912
  ds_read_b64_tr_b16 v[250:251], v3 offset:39424
  v_mfma_f32_16x16x32_bf16 v[44:47], v[28:31], a[80:83], v[44:47]
  buffer_load_dwordx4 v11, s[8:11], s33 offen offset:1024 lds
  v_mfma_f32_16x16x32_bf16 v[40:43], v[28:31], a[76:79], v[40:43]
  ds_write_b128 v10, v[224:227] offset:4096
  v_mfma_f32_16x16x32_bf16 v[40:43], v[32:35], a[96:99], v[40:43]
  v_mfma_f32_16x16x32_bf16 v[40:43], v[36:39], a[116:119], v[40:43]
  s_waitcnt lgkmcnt(3)
  v_mfma_f32_16x16x32_bf16 v[40:43], v[240:243], a[136:139], v[40:43]
  v_mfma_f32_16x16x32_bf16 v[40:43], v[244:247], a[156:159], v[40:43]
  s_waitcnt lgkmcnt(1)
  buffer_load_dwordx4 v11, s[8:11], s34 offen offset:2048 lds
  v_mfma_f32_16x16x32_bf16 v[40:43], v[248:251], a[176:179], v[40:43]
  v_mfma_f32_16x16x32_bf16 v[44:47], v[248:251], a[180:183], v[44:47]
  v_mfma_f32_16x16x32_bf16 v[44:47], v[244:247], a[160:163], v[44:47]
  v_mfma_f32_16x16x32_bf16 v[44:47], v[240:243], a[140:143], v[44:47]
  s_add_u32 m0, s21, 118784
  ds_read_b64_tr_b16 v[28:29], v3 offset:49152
  ds_read_b64_tr_b16 v[30:31], v3 offset:49664
  v_mfma_f32_16x16x32_bf16 v[48:51], v[240:243], a[144:147], v[48:51]
  buffer_load_dwordx4 v11, s[8:11], s35 offen offset:0 lds
  v_mfma_f32_16x16x32_bf16 v[48:51], v[244:247], a[164:167], v[48:51]
  ds_read_b64_tr_b16 v[32:33], v3 offset:50176
  ds_read_b64_tr_b16 v[34:35], v3 offset:50688
  v_mfma_f32_16x16x32_bf16 v[48:51], v[248:251], a[184:187], v[48:51]
  v_mfma_f32_16x16x32_bf16 v[52:55], v[248:251], a[188:191], v[52:55]
  v_mfma_f32_16x16x32_bf16 v[52:55], v[244:247], a[168:171], v[52:55]
  ds_read_b64_tr_b16 v[36:37], v3 offset:51200
  ds_read_b64_tr_b16 v[38:39], v3 offset:51712
  v_mfma_f32_16x16x32_bf16 v[52:55], v[240:243], a[148:151], v[52:55]
  buffer_load_dwordx4 v11, s[8:11], s36 offen offset:1024 lds
  v_mfma_f32_16x16x32_bf16 v[56:59], v[240:243], a[152:155], v[56:59]
  v_mfma_f32_16x16x32_bf16 v[56:59], v[244:247], a[172:175], v[56:59]
  v_mfma_f32_16x16x32_bf16 v[56:59], v[248:251], a[192:195], v[56:59]
  s_waitcnt lgkmcnt(2)
  v_mfma_f32_16x16x32_bf16 v[56:59], v[28:31], a[212:215], v[56:59]
  v_mfma_f32_16x16x32_bf16 v[56:59], v[32:35], a[232:235], v[56:59]
  s_waitcnt lgkmcnt(0)
  buffer_load_dwordx4 v11, s[8:11], s37 offen offset:2048 lds
  v_mfma_f32_16x16x32_bf16 v[76:79], v[36:39], a[252:255], v[56:59]
  v_mfma_f32_16x16x32_bf16 v[52:55], v[36:39], a[248:251], v[52:55]
  v_mfma_f32_16x16x32_bf16 v[52:55], v[32:35], a[228:231], v[52:55]
  v_mfma_f32_16x16x32_bf16 v[72:75], v[28:31], a[208:211], v[52:55]
  s_waitcnt vmcnt(6)
  v_mfma_f32_16x16x32_bf16 v[48:51], v[28:31], a[204:207], v[48:51]
  s_barrier
  v_mfma_f32_16x16x32_bf16 v[48:51], v[32:35], a[224:227], v[48:51]
  s_add_u32 m0, s21, 131072
  ds_read_b64_tr_b16 v[240:241], v2 offset:49152
  ds_read_b64_tr_b16 v[242:243], v2 offset:49664
  v_mfma_f32_16x16x32_bf16 v[68:71], v[36:39], a[244:247], v[48:51]
  buffer_load_dwordx4 v11, s[8:11], s38 offen offset:0 lds
  v_mfma_f32_16x16x32_bf16 v[44:47], v[36:39], a[240:243], v[44:47]
  ds_read_b64_tr_b16 v[244:245], v2 offset:50176
  ds_read_b64_tr_b16 v[246:247], v2 offset:50688
  v_mfma_f32_16x16x32_bf16 v[44:47], v[32:35], a[220:223], v[44:47]
  ds_read_b64_tr_b16 v[248:249], v2 offset:51200
  ds_read_b64_tr_b16 v[250:251], v2 offset:51712
  v_mfma_f32_16x16x32_bf16 v[64:67], v[28:31], a[200:203], v[44:47]
  buffer_load_dwordx4 v11, s[8:11], s39 offen offset:1024 lds
  v_mfma_f32_16x16x32_bf16 v[40:43], v[28:31], a[196:199], v[40:43]
  ds_write_b128 v10, v[228:231] offset:8192
  v_mfma_f32_16x16x32_bf16 v[40:43], v[32:35], a[216:219], v[40:43]
  v_mfma_f32_16x16x32_bf16 v[60:63], v[36:39], a[236:239], v[40:43]
  s_waitcnt lgkmcnt(3)
  v_mfma_f32_16x16x32_bf16 v[40:43], v[240:243], v[116:119], 0
  v_mfma_f32_16x16x32_bf16 v[40:43], v[244:247], v[136:139], v[40:43]
  s_waitcnt lgkmcnt(1)
  buffer_load_dwordx4 v11, s[8:11], s40 offen offset:2048 lds
  v_mfma_f32_16x16x32_bf16 v[40:43], v[248:251], v[156:159], v[40:43]
  v_mfma_f32_16x16x32_bf16 v[44:47], v[248:251], v[160:163], 0
  v_mfma_f32_16x16x32_bf16 v[44:47], v[244:247], v[140:143], v[44:47]
  v_fmac_f32_dpp v60, v76, v17 row_newbcast:15 row_mask:0xf bank_mask:0xf
  v_fmac_f32_dpp v61, v77, v17 row_newbcast:15 row_mask:0xf bank_mask:0xf
  v_mfma_f32_16x16x32_bf16 v[44:47], v[240:243], v[120:123], v[44:47]
  s_add_u32 m0, s21, 143360
  ds_read_b64_tr_b16 v[28:29], v3 offset:0
  ds_read_b64_tr_b16 v[30:31], v3 offset:512
  v_mfma_f32_16x16x32_bf16 v[48:51], v[240:243], v[124:127], 0
  buffer_load_dwordx4 v11, s[8:11], s41 offen offset:0 lds
  v_mfma_f32_16x16x32_bf16 v[48:51], v[244:247], v[144:147], v[48:51]
  ds_read_b64_tr_b16 v[32:33], v3 offset:1024
  ds_read_b64_tr_b16 v[34:35], v3 offset:1536
  v_mfma_f32_16x16x32_bf16 v[48:51], v[248:251], v[164:167], v[48:51]
  v_fmac_f32_dpp v62, v78, v17 row_newbcast:15 row_mask:0xf bank_mask:0xf
  v_fmac_f32_dpp v63, v79, v17 row_newbcast:15 row_mask:0xf bank_mask:0xf
  v_mfma_f32_16x16x32_bf16 v[52:55], v[248:251], v[168:171], 0
  v_cvt_pk_bf16_f32 v60, v60, v61
  v_cvt_pk_bf16_f32 v61, v62, v63
  v_mfma_f32_16x16x32_bf16 v[52:55], v[244:247], v[148:151], v[52:55]
  s_add_u32 s90, s90, 128
  ds_read_b64_tr_b16 v[36:37], v3 offset:2048
  ds_read_b64_tr_b16 v[38:39], v3 offset:2560
  v_mfma_f32_16x16x32_bf16 v[52:55], v[240:243], v[128:131], v[52:55]
  s_and_b32 s90, s90, 1023
  buffer_load_dwordx4 v11, s[8:11], s42 offen offset:1024 lds
  v_mfma_f32_16x16x32_bf16 v[56:59], v[240:243], v[132:135], 0
  v_pk_max_i16 v220, v60, 0
  v_pk_max_i16 v221, v61, 0
  v_mfma_f32_16x16x32_bf16 v[56:59], v[244:247], v[152:155], v[56:59]
  v_fmac_f32_dpp v64, v76, v18 row_newbcast:15 row_mask:0xf bank_mask:0xf
  v_fmac_f32_dpp v65, v77, v18 row_newbcast:15 row_mask:0xf bank_mask:0xf
  v_mfma_f32_16x16x32_bf16 v[56:59], v[248:251], v[172:175], v[56:59]
  s_waitcnt lgkmcnt(2)
  v_fmac_f32_dpp v66, v78, v18 row_newbcast:15 row_mask:0xf bank_mask:0xf
  v_fmac_f32_dpp v67, v79, v18 row_newbcast:15 row_mask:0xf bank_mask:0xf
  v_mfma_f32_16x16x32_bf16 v[56:59], v[28:31], v[192:195], v[56:59]
  v_cvt_pk_bf16_f32 v64, v64, v65
  v_cvt_pk_bf16_f32 v65, v66, v67
  v_mfma_f32_16x16x32_bf16 v[56:59], v[32:35], v[212:215], v[56:59]
  s_waitcnt lgkmcnt(0)
  buffer_load_dwordx4 v11, s[8:11], s43 offen offset:2048 lds
  v_mfma_f32_16x16x32_bf16 v[56:59], v[36:39], a[12:15], v[56:59]
  v_pk_max_i16 v224, v64, 0
  v_pk_max_i16 v225, v65, 0
  v_mfma_f32_16x16x32_bf16 v[52:55], v[36:39], a[8:11], v[52:55]
  v_fmac_f32_dpp v68, v76, v19 row_newbcast:15 row_mask:0xf bank_mask:0xf
  v_fmac_f32_dpp v69, v77, v19 row_newbcast:15 row_mask:0xf bank_mask:0xf
  v_mfma_f32_16x16x32_bf16 v[52:55], v[32:35], v[208:211], v[52:55]
  v_add_u32 v11, s90, v14
  v_fmac_f32_dpp v70, v78, v19 row_newbcast:15 row_mask:0xf bank_mask:0xf
  v_mfma_f32_16x16x32_bf16 v[52:55], v[28:31], v[188:191], v[52:55]
  s_waitcnt vmcnt(6)
  v_fmac_f32_dpp v71, v79, v19 row_newbcast:15 row_mask:0xf bank_mask:0xf
  v_cvt_pk_bf16_f32 v68, v68, v69
  v_mfma_f32_16x16x32_bf16 v[48:51], v[28:31], v[184:187], v[48:51]
  s_barrier
  v_mfma_f32_16x16x32_bf16 v[48:51], v[32:35], v[204:207], v[48:51]
  s_add_u32 m0, s21, 81920
  ds_read_b64_tr_b16 v[240:241], v3 offset:12288
  ds_read_b64_tr_b16 v[242:243], v3 offset:12800
  v_mfma_f32_16x16x32_bf16 v[48:51], v[36:39], a[4:7], v[48:51]
  buffer_load_dwordx4 v11, s[8:11], s26 offen offset:0 lds
  v_mfma_f32_16x16x32_bf16 v[44:47], v[36:39], a[0:3], v[44:47]
  ds_read_b64_tr_b16 v[244:245], v3 offset:13312
  ds_read_b64_tr_b16 v[246:247], v3 offset:13824
  v_mfma_f32_16x16x32_bf16 v[44:47], v[32:35], v[200:203], v[44:47]
  ds_read_b64_tr_b16 v[248:249], v3 offset:14336
  ds_read_b64_tr_b16 v[250:251], v3 offset:14848
  v_mfma_f32_16x16x32_bf16 v[44:47], v[28:31], v[180:183], v[44:47]
  buffer_load_dwordx4 v11, s[8:11], s27 offen offset:1024 lds
  v_mfma_f32_16x16x32_bf16 v[40:43], v[28:31], v[176:179], v[40:43]
  ds_write_b128 v10, v[232:235] offset:12288
  v_cvt_pk_bf16_f32 v69, v70, v71
  v_mfma_f32_16x16x32_bf16 v[40:43], v[32:35], v[196:199], v[40:43]
  v_pk_max_i16 v228, v68, 0
  v_pk_max_i16 v229, v69, 0
  v_mfma_f32_16x16x32_bf16 v[40:43], v[36:39], v[216:219], v[40:43]
  s_waitcnt lgkmcnt(3)
  v_fmac_f32_dpp v72, v76, v20 row_newbcast:15 row_mask:0xf bank_mask:0xf
  v_fmac_f32_dpp v73, v77, v20 row_newbcast:15 row_mask:0xf bank_mask:0xf
  v_mfma_f32_16x16x32_bf16 v[40:43], v[240:243], a[16:19], v[40:43]
  v_fmac_f32_dpp v74, v78, v20 row_newbcast:15 row_mask:0xf bank_mask:0xf
  v_fmac_f32_dpp v75, v79, v20 row_newbcast:15 row_mask:0xf bank_mask:0xf
  v_mfma_f32_16x16x32_bf16 v[40:43], v[244:247], a[36:39], v[40:43]
  s_waitcnt lgkmcnt(1)
  buffer_load_dwordx4 v11, s[8:11], s28 offen offset:2048 lds
  v_mfma_f32_16x16x32_bf16 v[40:43], v[248:251], a[56:59], v[40:43]
  v_cvt_pk_bf16_f32 v72, v72, v73
  v_cvt_pk_bf16_f32 v73, v74, v75
  v_mfma_f32_16x16x32_bf16 v[44:47], v[248:251], a[60:63], v[44:47]
  v_pk_max_i16 v232, v72, 0
  v_pk_max_i16 v233, v73, 0
  v_mfma_f32_16x16x32_bf16 v[44:47], v[244:247], a[40:43], v[44:47]
  v_fmac_f32_dpp v76, v76, v21 row_newbcast:15 row_mask:0xf bank_mask:0xf
  v_fmac_f32_dpp v77, v77, v21 row_newbcast:15 row_mask:0xf bank_mask:0xf
  v_mfma_f32_16x16x32_bf16 v[44:47], v[240:243], a[20:23], v[44:47]
  s_add_u32 m0, s21, 94208
  ds_read_b64_tr_b16 v[28:29], v3 offset:24576
  ds_read_b64_tr_b16 v[30:31], v3 offset:25088
  v_mfma_f32_16x16x32_bf16 v[48:51], v[240:243], a[24:27], v[48:51]
  buffer_load_dwordx4 v11, s[8:11], s29 offen offset:0 lds
  v_mfma_f32_16x16x32_bf16 v[48:51], v[244:247], a[44:47], v[48:51]
  ds_read_b64_tr_b16 v[32:33], v3 offset:25600
  ds_read_b64_tr_b16 v[34:35], v3 offset:26112
  v_mfma_f32_16x16x32_bf16 v[48:51], v[248:251], a[64:67], v[48:51]
  v_fmac_f32_dpp v78, v78, v21 row_newbcast:15 row_mask:0xf bank_mask:0xf
  v_fmac_f32_dpp v79, v79, v21 row_newbcast:15 row_mask:0xf bank_mask:0xf
  v_mfma_f32_16x16x32_bf16 v[52:55], v[248:251], a[68:71], v[52:55]
  v_cvt_pk_bf16_f32 v76, v76, v77
  v_cvt_pk_bf16_f32 v77, v78, v79
  v_mfma_f32_16x16x32_bf16 v[52:55], v[244:247], a[48:51], v[52:55]
L_fw1:
  s_cbranch_execz L_fw5
  ds_read_b64_tr_b16 v[36:37], v3 offset:26624
  ds_read_b64_tr_b16 v[38:39], v3 offset:27136
  v_mfma_f32_16x16x32_bf16 v[52:55], v[240:243], a[28:31], v[52:55]
  buffer_load_dwordx4 v11, s[8:11], s30 offen offset:1024 lds
  v_mfma_f32_16x16x32_bf16 v[56:59], v[240:243], a[32:35], v[56:59]
  v_mfma_f32_16x16x32_bf16 v[56:59], v[244:247], a[52:55], v[56:59]
  v_mfma_f32_16x16x32_bf16 v[56:59], v[248:251], a[72:75], v[56:59]
  s_waitcnt lgkmcnt(2)
  v_mfma_f32_16x16x32_bf16 v[56:59], v[28:31], a[92:95], v[56:59]
  v_mfma_f32_16x16x32_bf16 v[56:59], v[32:35], a[112:115], v[56:59]
  s_waitcnt lgkmcnt(0)
  buffer_load_dwordx4 v11, s[8:11], s31 offen offset:2048 lds
  v_mfma_f32_16x16x32_bf16 v[56:59], v[36:39], a[132:135], v[56:59]
  v_mfma_f32_16x16x32_bf16 v[52:55], v[36:39], a[128:131], v[52:55]
  v_mfma_f32_16x16x32_bf16 v[52:55], v[32:35], a[108:111], v[52:55]
  v_mfma_f32_16x16x32_bf16 v[52:55], v[28:31], a[88:91], v[52:55]
  s_waitcnt vmcnt(6)
  v_mfma_f32_16x16x32_bf16 v[48:51], v[28:31], a[84:87], v[48:51]
  s_barrier
  v_mfma_f32_16x16x32_bf16 v[48:51], v[32:35], a[104:107], v[48:51]
  s_add_u32 m0, s21, 106496
  ds_read_b64_tr_b16 v[240:241], v3 offset:36864
  ds_read_b64_tr_b16 v[242:243], v3 offset:37376
  v_mfma_f32_16x16x32_bf16 v[48:51], v[36:39], a[124:127], v[48:51]
  buffer_load_dwordx4 v11, s[8:11], s32 offen offset:0 lds
  v_mfma_f32_16x16x32_bf16 v[44:47], v[36:39], a[120:123], v[44:47]
  ds_read_b64_tr_b16 v[244:245], v3 offset:37888
  ds_read_b64_tr_b16 v[246:247], v3 offset:38400
  v_mfma_f32_16x16x32_bf16 v[44:47], v[32:35], a[100:103], v[44:47]
  ds_read_b64_tr_b16 v[248:249], v3 offset:38912
  ds_read_b64_tr_b16 v[250:251], v3 offset:39424
  v_mfma_f32_16x16x32_bf16 v[44:47], v[28:31], a[80:83], v[44:47]
  buffer_load_dwordx4 v11, s[8:11], s33 offen offset:1024 lds
  v_mfma_f32_16x16x32_bf16 v[40:43], v[28:31], a[76:79], v[40:43]
  ds_write_b128 v10, v[236:239] offset:16384
  v_subrev_u32 v10, 20480, v10
  v_mfma_f32_16x16x32_bf16 v[40:43], v[32:35], a[96:99], v[40:43]
  v_pk_max_i16 v236, v76, 0
  v_pk_max_i16 v237, v77, 0
  v_mfma_f32_16x16x32_bf16 v[40:43], v[36:39], a[116:119], v[40:43]
  s_waitcnt lgkmcnt(3)
  v_mfma_f32_16x16x32_bf16 v[40:43], v[240:243], a[136:139], v[40:43]
  v_mfma_f32_16x16x32_bf16 v[40:43], v[244:247], a[156:159], v[40:43]
  s_waitcnt lgkmcnt(1)
  buffer_load_dwordx4 v11, s[8:11], s34 offen offset:2048 lds
  v_mfma_f32_16x16x32_bf16 v[40:43], v[248:251], a[176:179], v[40:43]
  v_mfma_f32_16x16x32_bf16 v[44:47], v[248:251], a[180:183], v[44:47]
  v_mfma_f32_16x16x32_bf16 v[44:47], v[244:247], a[160:163], v[44:47]
  v_mfma_f32_16x16x32_bf16 v[44:47], v[240:243], a[140:143], v[44:47]
  s_add_u32 m0, s21, 118784
  ds_read_b64_tr_b16 v[28:29], v3 offset:49152
  ds_read_b64_tr_b16 v[30:31], v3 offset:49664
  v_mfma_f32_16x16x32_bf16 v[48:51], v[240:243], a[144:147], v[48:51]
  buffer_load_dwordx4 v11, s[8:11], s35 offen offset:0 lds
  v_mfma_f32_16x16x32_bf16 v[48:51], v[244:247], a[164:167], v[48:51]
  ds_read_b64_tr_b16 v[32:33], v3 offset:50176
  ds_read_b64_tr_b16 v[34:35], v3 offset:50688
  v_mfma_f32_16x16x32_bf16 v[48:51], v[248:251], a[184:187], v[48:51]
  v_mfma_f32_16x16x32_bf16 v[52:55], v[248:251], a[188:191], v[52:55]
  v_mfma_f32_16x16x32_bf16 v[52:55], v[244:247], a[168:171], v[52:55]
  ds_read_b64_tr_b16 v[36:37], v3 offset:51200
  ds_read_b64_tr_b16 v[38:39], v3 offset:51712
  v_mfma_f32_16x16x32_bf16 v[52:55], v[240:243], a[148:151], v[52:55]
  buffer_load_dwordx4 v11, s[8:11], s36 offen offset:1024 lds
  v_mfma_f32_16x16x32_bf16 v[56:59], v[240:243], a[152:155], v[56:59]
  v_mfma_f32_16x16x32_bf16 v[56:59], v[244:247], a[172:175], v[56:59]
  v_mfma_f32_16x16x32_bf16 v[56:59], v[248:251], a[192:195], v[56:59]
  s_waitcnt lgkmcnt(2)
  v_mfma_f32_16x16x32_bf16 v[56:59], v[28:31], a[212:215], v[56:59]
  v_mfma_f32_16x16x32_bf16 v[56:59], v[32:35], a[232:235], v[56:59]
  s_waitcnt lgkmcnt(0)
  buffer_load_dwordx4 v11, s[8:11], s37 offen offset:2048 lds
  v_mfma_f32_16x16x32_bf16 v[76:79], v[36:39], a[252:255], v[56:59]
  v_mfma_f32_16x16x32_bf16 v[52:55], v[36:39], a[248:251], v[52:55]
  v_mfma_f32_16x16x32_bf16 v[52:55], v[32:35], a[228:231], v[52:55]
  v_mfma_f32_16x16x32_bf16 v[72:75], v[28:31], a[208:211], v[52:55]
  s_waitcnt vmcnt(6)
  v_mfma_f32_16x16x32_bf16 v[48:51], v[28:31], a[204:207], v[48:51]
  s_barrier
  v_mfma_f32_16x16x32_bf16 v[48:51], v[32:35], a[224:227], v[48:51]
  s_add_u32 m0, s21, 131072
  ds_read_b64_tr_b16 v[240:241], v2 offset:49152
  ds_read_b64_tr_b16 v[242:243], v2 offset:49664
  v_mfma_f32_16x16x32_bf16 v[68:71], v[36:39], a[244:247], v[48:51]
  buffer_load_dwordx4 v11, s[8:11], s38 offen offset:0 lds
  v_mfma_f32_16x16x32_bf16 v[44:47], v[36:39], a[240:243], v[44:47]
  ds_read_b64_tr_b16 v[244:245], v2 offset:50176
  ds_read_b64_tr_b16 v[246:247], v2 offset:50688
  v_mfma_f32_16x16x32_bf16 v[44:47], v[32:35], a[220:223], v[44:47]
  ds_read_b64_tr_b16 v[248:249], v2 offset:51200
  ds_read_b64_tr_b16 v[250:251], v2 offset:51712
  v_mfma_f32_16x16x32_bf16 v[64:67], v[28:31], a[200:203], v[44:47]
  buffer_load_dwordx4 v11, s[8:11], s39 offen offset:1024 lds
  v_mfma_f32_16x16x32_bf16 v[40:43], v[28:31], a[196:199], v[40:43]
  s_sub_u32 s22, s22, 1
  v_mfma_f32_16x16x32_bf16 v[40:43], v[32:35], a[216:219], v[40:43]
  s_cmp_lg_u32 s22, 0
  v_mfma_f32_16x16x32_bf16 v[60:63], v[36:39], a[236:239], v[40:43]
  s_waitcnt lgkmcnt(2)
  s_cbranch_scc1 L_B1
  v_mfma_f32_16x16x32_bf16 v[40:43], v[240:243], v[116:119], 0
  v_mfma_f32_16x16x32_bf16 v[40:43], v[244:247], v[136:139], v[40:43]
  s_waitcnt lgkmcnt(0)
  buffer_load_dwordx4 v11, s[8:11], s40 offen offset:2048 lds
  v_mfma_f32_16x16x32_bf16 v[40:43], v[248:251], v[156:159], v[40:43]
  v_lshlrev_b32 v4, 4, v1
  v_add_u32 v5, 40960, v4
  v_mfma_f32_16x16x32_bf16 v[44:47], v[248:251], v[160:163], 0
  v_mfma_f32_16x16x32_bf16 v[44:47], v[244:247], v[140:143], v[44:47]
  v_fmac_f32_dpp v60, v76, v17 row_newbcast:15 row_mask:0xf bank_mask:0xf
  v_fmac_f32_dpp v61, v77, v17 row_newbcast:15 row_mask:0xf bank_mask:0xf
  v_mfma_f32_16x16x32_bf16 v[44:47], v[240:243], v[120:123], v[44:47]
  s_add_u32 m0, s21, 143360
  ds_read_b64_tr_b16 v[28:29], v3 offset:0
  ds_read_b64_tr_b16 v[30:31], v3 offset:512
  v_mfma_f32_16x16x32_bf16 v[48:51], v[240:243], v[124:127], 0
  buffer_load_dwordx4 v11, s[8:11], s41 offen offset:0 lds
  v_mfma_f32_16x16x32_bf16 v[48:51], v[244:247], v[144:147], v[48:51]
  ds_read_b64_tr_b16 v[32:33], v3 offset:1024
  ds_read_b64_tr_b16 v[34:35], v3 offset:1536
  v_mfma_f32_16x16x32_bf16 v[48:51], v[248:251], v[164:167], v[48:51]
  v_fmac_f32_dpp v62, v78, v17 row_newbcast:15 row_mask:0xf bank_mask:0xf
  v_mfma_f32_16x16x32_bf16 v[52:55], v[248:251], v[168:171], 0
  v_fmac_f32_dpp v63, v79, v17 row_newbcast:15 row_mask:0xf bank_mask:0xf
  v_mfma_f32_16x16x32_bf16 v[52:55], v[244:247], v[148:151], v[52:55]
  ds_read_b64_tr_b16 v[36:37], v3 offset:2048
  ds_read_b64_tr_b16 v[38:39], v3 offset:2560
  v_mfma_f32_16x16x32_bf16 v[52:55], v[240:243], v[128:131], v[52:55]
  buffer_load_dwordx4 v11, s[8:11], s42 offen offset:1024 lds
  v_mfma_f32_16x16x32_bf16 v[56:59], v[240:243], v[132:135], 0
  v_cvt_pk_bf16_f32 v60, v60, v61
  v_cvt_pk_bf16_f32 v61, v62, v63
  v_mfma_f32_16x16x32_bf16 v[56:59], v[244:247], v[152:155], v[56:59]
  v_pk_max_i16 v222, v60, 0
  v_mfma_f32_16x16x32_bf16 v[56:59], v[248:251], v[172:175], v[56:59]
  s_waitcnt lgkmcnt(2)
  v_pk_max_i16 v223, v61, 0
  v_mfma_f32_16x16x32_bf16 v[56:59], v[28:31], v[192:195], v[56:59]
  ds_read_b128 v[116:119], v5 offset:20480
  ds_read_b128 v[120:123], v5 offset:24576
  v_fmac_f32_dpp v64, v76, v18 row_newbcast:15 row_mask:0xf bank_mask:0xf
  v_mfma_f32_16x16x32_bf16 v[56:59], v[32:35], v[212:215], v[56:59]
  s_waitcnt lgkmcnt(2)
  buffer_load_dwordx4 v11, s[8:11], s43 offen offset:2048 lds
  v_mfma_f32_16x16x32_bf16 v[56:59], v[36:39], a[12:15], v[56:59]
  ds_read_b128 v[124:127], v5 offset:28672
  ds_read_b128 v[128:131], v5 offset:32768
  v_mfma_f32_16x16x32_bf16 v[52:55], v[36:39], a[8:11], v[52:55]
  ds_read_b128 v[132:135], v5 offset:36864
  ds_read_b128 v[136:139], v5 offset:21504
  v_fmac_f32_dpp v65, v77, v18 row_newbcast:15 row_mask:0xf bank_mask:0xf
  v_mfma_f32_16x16x32_bf16 v[52:55], v[32:35], v[208:211], v[52:55]
  ds_read_b128 v[140:143], v5 offset:25600
  v_fmac_f32_dpp v66, v78, v18 row_newbcast:15 row_mask:0xf bank_mask:0xf
  v_mfma_f32_16x16x32_bf16 v[52:55], v[28:31], v[188:191], v[52:55]
  s_waitcnt vmcnt(6)
  ds_read_b128 v[144:147], v5 offset:29696
  ds_read_b128 v[148:151], v5 offset:33792
  v_fmac_f32_dpp v67, v79, v18 row_newbcast:15 row_mask:0xf bank_mask:0xf
  v_mfma_f32_16x16x32_bf16 v[48:51], v[28:31], v[184:187], v[48:51]
  s_barrier
  v_mfma_f32_16x16x32_bf16 v[48:51], v[32:35], v[204:207], v[48:51]
  s_add_u32 m0, s21, 81920
  ds_read_b64_tr_b16 v[240:241], v3 offset:12288
  ds_read_b64_tr_b16 v[242:243], v3 offset:12800
  v_mfma_f32_16x16x32_bf16 v[48:51], v[36:39], a[4:7], v[48:51]
  buffer_load_dwordx4 v90, s[16:19], s72 offen offset:0 lds
  v_mfma_f32_16x16x32_bf16 v[44:47], v[36:39], a[0:3], v[44:47]
  ds_read_b64_tr_b16 v[244:245], v3 offset:13312
  ds_read_b64_tr_b16 v[246:247], v3 offset:13824
  v_cvt_pk_bf16_f32 v64, v64, v65
  v_mfma_f32_16x16x32_bf16 v[44:47], v[32:35], v[200:203], v[44:47]
  ds_read_b64_tr_b16 v[248:249], v3 offset:14336
  ds_read_b64_tr_b16 v[250:251], v3 offset:14848
  v_mfma_f32_16x16x32_bf16 v[44:47], v[28:31], v[180:183], v[44:47]
  buffer_load_dwordx4 v90, s[16:19], s73 offen offset:1024 lds
  v_mfma_f32_16x16x32_bf16 v[40:43], v[28:31], v[176:179], v[40:43]
  ds_write_b128 v10, v[220:223] offset:0
  v_cvt_pk_bf16_f32 v65, v66, v67
  v_pk_max_i16 v226, v64, 0
  v_mfma_f32_16x16x32_bf16 v[40:43], v[32:35], v[196:199], v[40:43]
  ds_read_b128 v[152:155], v5 offset:37888
  ds_read_b128 v[156:159], v5 offset:22528
  v_mfma_f32_16x16x32_bf16 v[40:43], v[36:39], v[216:219], v[40:43]
  s_waitcnt lgkmcnt(5)
  ds_read_b128 v[160:163], v5 offset:26624
  v_pk_max_i16 v227, v65, 0
  v_mfma_f32_16x16x32_bf16 v[40:43], v[240:243], a[16:19], v[40:43]
  ds_read_b128 v[164:167], v5 offset:30720
  ds_read_b128 v[168:171], v5 offset:34816
  v_fmac_f32_dpp v68, v76, v19 row_newbcast:15 row_mask:0xf bank_mask:0xf
  v_mfma_f32_16x16x32_bf16 v[40:43], v[244:247], a[36:39], v[40:43]
  s_waitcnt lgkmcnt(6)
  buffer_load_dwordx4 v90, s[16:19], s74 offen offset:2048 lds
  v_mfma_f32_16x16x32_bf16 v[40:43], v[248:251], a[56:59], v[40:43]
  ds_read_b128 v[172:175], v5 offset:38912
  v_fmac_f32_dpp v69, v77, v19 row_newbcast:15 row_mask:0xf bank_mask:0xf
  v_mfma_f32_16x16x32_bf16 v[44:47], v[248:251], a[60:63], v[44:47]
  ds_read_b128 v[176:179], v5 offset:23552
  v_fmac_f32_dpp v70, v78, v19 row_newbcast:15 row_mask:0xf bank_mask:0xf
  v_mfma_f32_16x16x32_bf16 v[44:47], v[244:247], a[40:43], v[44:47]
  ds_read_b128 v[180:183], v5 offset:27648
  v_fmac_f32_dpp v71, v79, v19 row_newbcast:15 row_mask:0xf bank_mask:0xf
  v_mfma_f32_16x16x32_bf16 v[44:47], v[240:243], a[20:23], v[44:47]
  s_add_u32 m0, s21, 94208
  ds_read_b64_tr_b16 v[28:29], v3 offset:24576
  ds_read_b64_tr_b16 v[30:31], v3 offset:25088
  v_mfma_f32_16x16x32_bf16 v[48:51], v[240:243], a[24:27], v[48:51]
  buffer_load_dwordx4 v90, s[16:19], s75 offen offset:0 lds
  v_mfma_f32_16x16x32_bf16 v[48:51], v[244:247], a[44:47], v[48:51]
  ds_read_b64_tr_b16 v[32:33], v3 offset:25600
  ds_read_b64_tr_b16 v[34:35], v3 offset:26112
  v_mfma_f32_16x16x32_bf16 v[48:51], v[248:251], a[64:67], v[48:51]
  ds_read_b128 v[184:187], v5 offset:31744
  v_cvt_pk_bf16_f32 v68, v68, v69
  v_mfma_f32_16x16x32_bf16 v[52:55], v[248:251], a[68:71], v[52:55]
  ds_read_b128 v[188:191], v5 offset:35840
  v_cvt_pk_bf16_f32 v69, v70, v71
  v_mfma_f32_16x16x32_bf16 v[52:55], v[244:247], a[48:51], v[52:55]
  ds_read_b64_tr_b16 v[36:37], v3 offset:26624
  ds_read_b64_tr_b16 v[38:39], v3 offset:27136
  v_mfma_f32_16x16x32_bf16 v[52:55], v[240:243], a[28:31], v[52:55]
  buffer_load_dwordx4 v91, s[16:19], s76 offen offset:1024 lds
  v_mfma_f32_16x16x32_bf16 v[56:59], v[240:243], a[32:35], v[56:59]
  ds_read_b128 v[192:195], v5 offset:39936
  ds_read_b128 v[196:199], v5 offset:0
  v_mfma_f32_16x16x32_bf16 v[56:59], v[244:247], a[52:55], v[56:59]
  ds_read_b128 v[200:203], v5 offset:4096
  v_pk_max_i16 v230, v68, 0
  v_mfma_f32_16x16x32_bf16 v[56:59], v[248:251], a[72:75], v[56:59]
  s_waitcnt lgkmcnt(7)
  ds_read_b128 v[204:207], v5 offset:8192
  v_pk_max_i16 v231, v69, 0
  v_mfma_f32_16x16x32_bf16 v[56:59], v[28:31], a[92:95], v[56:59]
  ds_read_b128 v[208:211], v5 offset:12288
  v_fmac_f32_dpp v72, v76, v20 row_newbcast:15 row_mask:0xf bank_mask:0xf
  v_mfma_f32_16x16x32_bf16 v[56:59], v[32:35], a[112:115], v[56:59]
  s_waitcnt lgkmcnt(5)
  buffer_load_dwordx4 v91, s[16:19], s77 offen offset:2048 lds
  v_mfma_f32_16x16x32_bf16 v[56:59], v[36:39], a[132:135], v[56:59]
  ds_read_b128 v[212:215], v5 offset:16384
  v_fmac_f32_dpp v73, v77, v20 row_newbcast:15 row_mask:0xf bank_mask:0xf
  v_mfma_f32_16x16x32_bf16 v[52:55], v[36:39], a[128:131], v[52:55]
  ds_read_b128 v[216:219], v5 offset:1024
  v_fmac_f32_dpp v74, v78, v20 row_newbcast:15 row_mask:0xf bank_mask:0xf
  v_mfma_f32_16x16x32_bf16 v[52:55], v[32:35], a[108:111], v[52:55]
  ds_read_b128 a[0:3], v5 offset:5120
  v_fmac_f32_dpp v75, v79, v20 row_newbcast:15 row_mask:0xf bank_mask:0xf
  v_mfma_f32_16x16x32_bf16 v[52:55], v[28:31], a[88:91], v[52:55]
  s_waitcnt vmcnt(6) lgkmcnt(7)
  ds_read_b128 a[4:7], v5 offset:9216
  ds_read_b128 a[8:11], v5 offset:13312
  v_mfma_f32_16x16x32_bf16 v[48:51], v[28:31], a[84:87], v[48:51]
  s_barrier
  v_mfma_f32_16x16x32_bf16 v[48:51], v[32:35], a[104:107], v[48:51]
  ds_read_b64_tr_b16 v[240:241], v3 offset:36864
  ds_read_b64_tr_b16 v[242:243], v3 offset:37376
  v_mfma_f32_16x16x32_bf16 v[48:51], v[36:39], a[124:127], v[48:51]
  ds_read_b128 a[12:15], v5 offset:17408
  v_cvt_pk_bf16_f32 v72, v72, v73
  v_mfma_f32_16x16x32_bf16 v[44:47], v[36:39], a[120:123], v[44:47]
  ds_read_b64_tr_b16 v[244:245], v3 offset:37888
  ds_read_b64_tr_b16 v[246:247], v3 offset:38400
  v_mfma_f32_16x16x32_bf16 v[44:47], v[32:35], a[100:103], v[44:47]
  s_add_u32 m0, s21, 106496
  ds_read_b64_tr_b16 v[248:249], v3 offset:38912
  ds_read_b64_tr_b16 v[250:251], v3 offset:39424
  v_mfma_f32_16x16x32_bf16 v[44:47], v[28:31], a[80:83], v[44:47]
  buffer_load_dwordx4 v91, s[16:19], s78 offen offset:0 lds
  v_mfma_f32_16x16x32_bf16 v[40:43], v[28:31], a[76:79], v[40:43]
  ds_write_b128 v10, v[224:227] offset:4096
  v_cvt_pk_bf16_f32 v73, v74, v75
  v_mfma_f32_16x16x32_bf16 v[40:43], v[32:35], a[96:99], v[40:43]
  ds_read_b128 a[16:19], v5 offset:2048
  v_pk_max_i16 v234, v72, 0
  v_mfma_f32_16x16x32_bf16 v[40:43], v[36:39], a[116:119], v[40:43]
  s_waitcnt lgkmcnt(4)
  ds_write_b128 v10, v[228:231] offset:8192
  v_pk_max_i16 v235, v73, 0
  v_mfma_f32_16x16x32_bf16 v[40:43], v[240:243], a[136:139], v[40:43]
  ds_read_b128 a[20:23], v5 offset:6144
  ds_read_b128 a[24:27], v5 offset:10240
  v_fmac_f32_dpp v76, v76, v21 row_newbcast:15 row_mask:0xf bank_mask:0xf
  v_mfma_f32_16x16x32_bf16 v[40:43], v[244:247], a[156:159], v[40:43]
  s_waitcnt lgkmcnt(5)
  buffer_load_dwordx4 v91, s[16:19], s79 offen offset:1024 lds
  v_mfma_f32_16x16x32_bf16 v[40:43], v[248:251], a[176:179], v[40:43]
  ds_read_b128 a[28:31], v5 offset:14336
  v_fmac_f32_dpp v77, v77, v21 row_newbcast:15 row_mask:0xf bank_mask:0xf
  v_mfma_f32_16x16x32_bf16 v[44:47], v[248:251], a[180:183], v[44:47]
  buffer_load_dwordx4 v27, s[16:19], s80 offen offset:2048 lds
  v_mfma_f32_16x16x32_bf16 v[44:47], v[244:247], a[160:163], v[44:47]
  ds_read_b128 a[32:35], v5 offset:18432
  v_fmac_f32_dpp v78, v78, v21 row_newbcast:15 row_mask:0xf bank_mask:0xf
  v_fmac_f32_dpp v79, v79, v21 row_newbcast:15 row_mask:0xf bank_mask:0xf
  v_mfma_f32_16x16x32_bf16 v[44:47], v[240:243], a[140:143], v[44:47]
  s_add_u32 m0, s21, 118784
  ds_read_b64_tr_b16 v[28:29], v3 offset:49152
  ds_read_b64_tr_b16 v[30:31], v3 offset:49664
  v_mfma_f32_16x16x32_bf16 v[48:51], v[240:243], a[144:147], v[48:51]
  buffer_load_dwordx4 v27, s[16:19], s81 offen offset:0 lds
  v_mfma_f32_16x16x32_bf16 v[48:51], v[244:247], a[164:167], v[48:51]
  ds_read_b64_tr_b16 v[32:33], v3 offset:50176
  ds_read_b64_tr_b16 v[34:35], v3 offset:50688
  v_cvt_pk_bf16_f32 v76, v76, v77
  v_mfma_f32_16x16x32_bf16 v[48:51], v[248:251], a[184:187], v[48:51]
  buffer_load_dwordx4 v27, s[16:19], s82 offen offset:1024 lds
  v_mfma_f32_16x16x32_bf16 v[52:55], v[248:251], a[188:191], v[52:55]
  ds_read_b128 a[36:39], v5 offset:3072
  ds_read_b128 a[40:43], v5 offset:7168
  v_mfma_f32_16x16x32_bf16 v[52:55], v[244:247], a[168:171], v[52:55]
  ds_read_b64_tr_b16 v[36:37], v3 offset:51200
  ds_read_b64_tr_b16 v[38:39], v3 offset:51712
  v_cvt_pk_bf16_f32 v77, v78, v79
  v_mfma_f32_16x16x32_bf16 v[52:55], v[240:243], a[148:151], v[52:55]
  buffer_load_dwordx4 v27, s[16:19], s83 offen offset:2048 lds
  v_mfma_f32_16x16x32_bf16 v[56:59], v[240:243], a[152:155], v[56:59]
  s_add_u32 m0, s21, 69632
  ds_read_b128 a[44:47], v5 offset:11264
  v_pk_max_i16 v238, v76, 0
  v_mfma_f32_16x16x32_bf16 v[56:59], v[244:247], a[172:175], v[56:59]
  buffer_load_dwordx4 v254, s[16:19], s84 offen offset:0 lds
  v_mfma_f32_16x16x32_bf16 v[56:59], v[248:251], a[192:195], v[56:59]
  s_waitcnt lgkmcnt(5)
  ds_read_b128 a[48:51], v5 offset:15360
  v_pk_max_i16 v239, v77, 0
  v_mfma_f32_16x16x32_bf16 v[56:59], v[28:31], a[212:215], v[56:59]
  ds_read_b128 a[52:55], v5 offset:19456
  ds_read_b128 a[56:59], v4 offset:20480
  v_mfma_f32_16x16x32_bf16 v[56:59], v[32:35], a[232:235], v[56:59]
  s_waitcnt lgkmcnt(4)
  buffer_load_dwordx4 v254, s[16:19], s85 offen offset:1024 lds
  v_mfma_f32_16x16x32_bf16 v[76:79], v[36:39], a[252:255], v[56:59]
  ds_read_b128 a[60:63], v4 offset:24576
  v_mfma_f32_16x16x32_bf16 v[52:55], v[36:39], a[248:251], v[52:55]
  ds_read_b128 a[64:67], v4 offset:28672
  v_mfma_f32_16x16x32_bf16 v[52:55], v[32:35], a[228:231], v[52:55]
  ds_read_b128 a[68:71], v4 offset:32768
  v_mfma_f32_16x16x32_bf16 v[72:75], v[28:31], a[208:211], v[52:55]
  s_waitcnt vmcnt(8) lgkmcnt(4)
  ds_read_b128 a[72:75], v4 offset:36864
  v_mfma_f32_16x16x32_bf16 v[48:51], v[28:31], a[204:207], v[48:51]
  s_barrier
  v_mfma_f32_16x16x32_bf16 v[48:51], v[32:35], a[224:227], v[48:51]
  ds_read_b64_tr_b16 v[240:241], v2 offset:49152
  ds_read_b64_tr_b16 v[242:243], v2 offset:49664
  v_mfma_f32_16x16x32_bf16 v[68:71], v[36:39], a[244:247], v[48:51]
  ds_read_b128 a[76:79], v4 offset:21504
  v_mfma_f32_16x16x32_bf16 v[44:47], v[36:39], a[240:243], v[44:47]
  ds_read_b64_tr_b16 v[244:245], v2 offset:50176
  ds_read_b64_tr_b16 v[246:247], v2 offset:50688
  v_mfma_f32_16x16x32_bf16 v[44:47], v[32:35], a[220:223], v[44:47]
  ds_read_b64_tr_b16 v[248:249], v2 offset:51200
  ds_read_b64_tr_b16 v[250:251], v2 offset:51712
  v_mfma_f32_16x16x32_bf16 v[64:67], v[28:31], a[200:203], v[44:47]
  ds_read_b128 a[80:83], v4 offset:25600
  v_mfma_f32_16x16x32_bf16 v[40:43], v[28:31], a[196:199], v[40:43]
  ds_read_b128 a[84:87], v4 offset:29696
  v_mfma_f32_16x16x32_bf16 v[40:43], v[32:35], a[216:219], v[40:43]
  ds_write_b128 v10, v[232:235] offset:12288
  v_mfma_f32_16x16x32_bf16 v[60:63], v[36:39], a[236:239], v[40:43]
  s_waitcnt lgkmcnt(5)
  v_mfma_f32_16x16x32_bf16 v[40:43], v[240:243], v[116:119], 0
  ds_read_b128 a[88:91], v4 offset:33792
  ds_read_b128 a[92:95], v4 offset:37888
  v_mfma_f32_16x16x32_bf16 v[40:43], v[244:247], v[136:139], v[40:43]
  s_waitcnt lgkmcnt(5)
  buffer_load_dwordx4 v254, s[16:19], s86 offen offset:2048 lds
  v_mfma_f32_16x16x32_bf16 v[40:43], v[248:251], v[156:159], v[40:43]
  s_add_u32 m0, s21, 131072
  ds_write_b128 v10, v[236:239] offset:16384
  v_mfma_f32_16x16x32_bf16 v[44:47], v[248:251], v[160:163], 0
  buffer_load_dwordx4 v254, s[16:19], s87 offen offset:0 lds
  v_mfma_f32_16x16x32_bf16 v[44:47], v[244:247], v[140:143], v[44:47]
  ds_read_b128 a[96:99], v4 offset:22528
  v_fmac_f32_dpp v60, v76, v17 row_newbcast:15 row_mask:0xf bank_mask:0xf
  v_fmac_f32_dpp v61, v77, v17 row_newbcast:15 row_mask:0xf bank_mask:0xf
  v_mfma_f32_16x16x32_bf16 v[44:47], v[240:243], v[120:123], v[44:47]
  ds_read_b64_tr_b16 v[28:29], v3 offset:0
  ds_read_b64_tr_b16 v[30:31], v3 offset:512
  v_fmac_f32_dpp v62, v78, v17 row_newbcast:15 row_mask:0xf bank_mask:0xf
  v_mfma_f32_16x16x32_bf16 v[48:51], v[240:243], v[124:127], 0
  buffer_load_dwordx4 v12, s[16:19], s88 offen offset:1024 lds
  v_mfma_f32_16x16x32_bf16 v[48:51], v[244:247], v[144:147], v[48:51]
  ds_read_b64_tr_b16 v[32:33], v3 offset:1024
  ds_read_b64_tr_b16 v[34:35], v3 offset:1536
  v_fmac_f32_dpp v63, v79, v17 row_newbcast:15 row_mask:0xf bank_mask:0xf
  v_mfma_f32_16x16x32_bf16 v[48:51], v[248:251], v[164:167], v[48:51]
  buffer_load_dwordx4 v12, s[16:19], s89 offen offset:2048 lds
  v_mfma_f32_16x16x32_bf16 v[52:55], v[248:251], v[168:171], 0
  s_xor_b32 s91, s91, 128
  s_add_u32 s16, s23, s91
  s_addc_u32 s17, s54, 0
  ds_read_b128 a[100:103], v4 offset:26624
  ds_read_b128 a[104:107], v4 offset:30720
  v_cvt_pk_bf16_f32 v60, v60, v61
  v_mfma_f32_16x16x32_bf16 v[52:55], v[244:247], v[148:151], v[52:55]
  s_add_u32 m0, s21, 143360
  ds_read_b64_tr_b16 v[36:37], v3 offset:2048
  ds_read_b64_tr_b16 v[38:39], v3 offset:2560
  v_cvt_pk_bf16_f32 v61, v62, v63
  v_mfma_f32_16x16x32_bf16 v[52:55], v[240:243], v[128:131], v[52:55]
  buffer_load_dwordx4 v90, s[16:19], s72 offen offset:0 lds
  v_mfma_f32_16x16x32_bf16 v[56:59], v[240:243], v[132:135], 0
  ds_read_b128 a[108:111], v4 offset:34816
  v_pk_max_i16 v60, v60, 0
  v_pk_max_i16 v61, v61, 0
  v_mfma_f32_16x16x32_bf16 v[56:59], v[244:247], v[152:155], v[56:59]
  buffer_load_dwordx4 v90, s[16:19], s73 offen offset:1024 lds
  v_mfma_f32_16x16x32_bf16 v[56:59], v[248:251], v[172:175], v[56:59]
  s_waitcnt lgkmcnt(5)
  ds_read_b128 a[112:115], v4 offset:38912
  ds_read_b128 a[116:119], v4 offset:23552
  v_fmac_f32_dpp v64, v76, v18 row_newbcast:15 row_mask:0xf bank_mask:0xf
  v_mfma_f32_16x16x32_bf16 v[56:59], v[28:31], v[192:195], v[56:59]
  ds_read_b128 a[120:123], v4 offset:27648
  v_fmac_f32_dpp v65, v77, v18 row_newbcast:15 row_mask:0xf bank_mask:0xf
  v_fmac_f32_dpp v66, v78, v18 row_newbcast:15 row_mask:0xf bank_mask:0xf
  v_mfma_f32_16x16x32_bf16 v[56:59], v[32:35], v[212:215], v[56:59]
  s_waitcnt lgkmcnt(4)
  buffer_load_dwordx4 v90, s[16:19], s74 offen offset:2048 lds
  v_mfma_f32_16x16x32_bf16 v[56:59], v[36:39], a[12:15], v[56:59]
  s_add_u32 m0, s21, 57344
  ds_read_b128 a[124:127], v4 offset:31744
  ds_read_b128 a[128:131], v4 offset:35840
  v_mfma_f32_16x16x32_bf16 v[52:55], v[36:39], a[8:11], v[52:55]
  buffer_load_dwordx4 v90, s[16:19], s75 offen offset:0 lds
  v_mfma_f32_16x16x32_bf16 v[52:55], v[32:35], v[208:211], v[52:55]
  ds_read_b128 a[132:135], v4 offset:39936
  v_fmac_f32_dpp v67, v79, v18 row_newbcast:15 row_mask:0xf bank_mask:0xf
  v_cvt_pk_bf16_f32 v64, v64, v65
  v_mfma_f32_16x16x32_bf16 v[52:55], v[28:31], v[188:191], v[52:55]
  s_waitcnt vmcnt(7) lgkmcnt(0)
  v_cvt_pk_bf16_f32 v65, v66, v67
  v_pk_max_i16 v64, v64, 0
  v_mfma_f32_16x16x32_bf16 v[48:51], v[28:31], v[184:187], v[48:51]
  s_barrier
  v_mfma_f32_16x16x32_bf16 v[48:51], v[32:35], v[204:207], v[48:51]
  ds_read_b64_tr_b16 v[240:241], v3 offset:12288
  ds_read_b64_tr_b16 v[242:243], v3 offset:12800
  v_pk_max_i16 v65, v65, 0
  v_mfma_f32_16x16x32_bf16 v[48:51], v[36:39], a[4:7], v[48:51]
  buffer_load_dwordx4 v91, s[16:19], s76 offen offset:1024 lds
  v_mfma_f32_16x16x32_bf16 v[44:47], v[36:39], a[0:3], v[44:47]
  ds_read_b64_tr_b16 v[244:245], v3 offset:13312
  ds_read_b64_tr_b16 v[246:247], v3 offset:13824
  v_mfma_f32_16x16x32_bf16 v[44:47], v[32:35], v[200:203], v[44:47]
  ds_read_b64_tr_b16 v[248:249], v3 offset:14336
  ds_read_b64_tr_b16 v[250:251], v3 offset:14848
  v_fmac_f32_dpp v68, v76, v19 row_newbcast:15 row_mask:0xf bank_mask:0xf
  v_mfma_f32_16x16x32_bf16 v[44:47], v[28:31], v[180:183], v[44:47]
  buffer_load_dwordx4 v91, s[16:19], s77 offen offset:2048 lds
  v_mfma_f32_16x16x32_bf16 v[40:43], v[28:31], v[176:179], v[40:43]
  s_add_u32 m0, s21, 45056
  ds_read_b128 a[136:139], v4 offset:0
  ds_read_b128 a[140:143], v4 offset:4096
  v_fmac_f32_dpp v69, v77, v19 row_newbcast:15 row_mask:0xf bank_mask:0xf
  v_mfma_f32_16x16x32_bf16 v[40:43], v[32:35], v[196:199], v[40:43]
  buffer_load_dwordx4 v91, s[16:19], s78 offen offset:0 lds
  v_mfma_f32_16x16x32_bf16 v[40:43], v[36:39], v[216:219], v[40:43]
  s_waitcnt lgkmcnt(4)
  ds_read_b128 a[144:147], v4 offset:8192
  v_fmac_f32_dpp v70, v78, v19 row_newbcast:15 row_mask:0xf bank_mask:0xf
  v_fmac_f32_dpp v71, v79, v19 row_newbcast:15 row_mask:0xf bank_mask:0xf
  v_mfma_f32_16x16x32_bf16 v[40:43], v[240:243], a[16:19], v[40:43]
  ds_read_b128 a[148:151], v4 offset:12288
  v_cvt_pk_bf16_f32 v68, v68, v69
  v_cvt_pk_bf16_f32 v69, v70, v71
  v_mfma_f32_16x16x32_bf16 v[40:43], v[244:247], a[36:39], v[40:43]
  s_waitcnt lgkmcnt(4)
  buffer_load_dwordx4 v91, s[16:19], s79 offen offset:1024 lds
  v_mfma_f32_16x16x32_bf16 v[40:43], v[248:251], a[56:59], v[40:43]
  ds_read_b128 a[152:155], v4 offset:16384
  v_pk_max_i16 v68, v68, 0
  v_pk_max_i16 v69, v69, 0
  v_mfma_f32_16x16x32_bf16 v[44:47], v[248:251], a[60:63], v[44:47]
  buffer_load_dwordx4 v27, s[16:19], s80 offen offset:2048 lds
  v_mfma_f32_16x16x32_bf16 v[44:47], v[244:247], a[40:43], v[44:47]
  ds_read_b128 a[156:159], v4 offset:1024
  ds_read_b128 a[160:163], v4 offset:5120
  v_mfma_f32_16x16x32_bf16 v[44:47], v[240:243], a[20:23], v[44:47]
  s_add_u32 m0, s21, 81920
  ds_read_b64_tr_b16 v[28:29], v3 offset:24576
  ds_read_b64_tr_b16 v[30:31], v3 offset:25088
  v_fmac_f32_dpp v72, v76, v20 row_newbcast:15 row_mask:0xf bank_mask:0xf
  v_mfma_f32_16x16x32_bf16 v[48:51], v[240:243], a[24:27], v[48:51]
  buffer_load_dwordx4 v27, s[16:19], s81 offen offset:0 lds
  v_mfma_f32_16x16x32_bf16 v[48:51], v[244:247], a[44:47], v[48:51]
  ds_read_b64_tr_b16 v[32:33], v3 offset:25600
  ds_read_b64_tr_b16 v[34:35], v3 offset:26112
  v_fmac_f32_dpp v73, v77, v20 row_newbcast:15 row_mask:0xf bank_mask:0xf
  v_mfma_f32_16x16x32_bf16 v[48:51], v[248:251], a[64:67], v[48:51]
  ds_read_b128 a[164:167], v4 offset:9216
  v_fmac_f32_dpp v74, v78, v20 row_newbcast:15 row_mask:0xf bank_mask:0xf
  v_fmac_f32_dpp v75, v79, v20 row_newbcast:15 row_mask:0xf bank_mask:0xf
  v_mfma_f32_16x16x32_bf16 v[52:55], v[248:251], a[68:71], v[52:55]
  ds_read_b128 a[168:171], v4 offset:13312
  v_cvt_pk_bf16_f32 v72, v72, v73
  v_cvt_pk_bf16_f32 v73, v74, v75
  v_mfma_f32_16x16x32_bf16 v[52:55], v[244:247], a[48:51], v[52:55]
  ds_read_b64_tr_b16 v[36:37], v3 offset:26624
  ds_read_b64_tr_b16 v[38:39], v3 offset:27136
  v_pk_max_i16 v72, v72, 0
  v_mfma_f32_16x16x32_bf16 v[52:55], v[240:243], a[28:31], v[52:55]
  ds_read_b128 a[172:175], v4 offset:17408
  v_pk_max_i16 v73, v73, 0
  v_mfma_f32_16x16x32_bf16 v[56:59], v[240:243], a[32:35], v[56:59]
  ds_read_b128 a[176:179], v4 offset:2048
  ds_read_b128 a[180:183], v4 offset:6144
  v_fmac_f32_dpp v76, v76, v21 row_newbcast:15 row_mask:0xf bank_mask:0xf
  v_mfma_f32_16x16x32_bf16 v[56:59], v[244:247], a[52:55], v[56:59]
  ds_read_b128 a[184:187], v4 offset:10240
  v_fmac_f32_dpp v77, v77, v21 row_newbcast:15 row_mask:0xf bank_mask:0xf
  v_mfma_f32_16x16x32_bf16 v[56:59], v[248:251], a[72:75], v[56:59]
  s_waitcnt lgkmcnt(8)
  ds_read_b128 a[188:191], v4 offset:14336
  v_fmac_f32_dpp v78, v78, v21 row_newbcast:15 row_mask:0xf bank_mask:0xf
  v_mfma_f32_16x16x32_bf16 v[56:59], v[28:31], a[92:95], v[56:59]
  ds_read_b128 a[192:195], v4 offset:18432
  v_fmac_f32_dpp v79, v79, v21 row_newbcast:15 row_mask:0xf bank_mask:0xf
  v_mfma_f32_16x16x32_bf16 v[56:59], v[32:35], a[112:115], v[56:59]
  s_waitcnt lgkmcnt(6)
  ds_read_b128 a[196:199], v4 offset:3072
  ds_read_b128 a[200:203], v4 offset:7168
  v_cvt_pk_bf16_f32 v76, v76, v77
  v_mfma_f32_16x16x32_bf16 v[56:59], v[36:39], a[132:135], v[56:59]
  ds_read_b128 a[204:207], v4 offset:11264
  v_cvt_pk_bf16_f32 v77, v78, v79
  v_mfma_f32_16x16x32_bf16 v[52:55], v[36:39], a[128:131], v[52:55]
  ds_read_b128 a[208:211], v4 offset:15360
  v_pk_max_i16 v76, v76, 0
  v_mfma_f32_16x16x32_bf16 v[52:55], v[32:35], a[108:111], v[52:55]
L_fw2:
  s_cbranch_execz L_ffn_ret
  ds_read_b128 a[212:215], v4 offset:19456
  v_pk_max_i16 v77, v77, 0
  v_mfma_f32_16x16x32_bf16 v[52:55], v[28:31], a[88:91], v[52:55]
  ds_read_b64_tr_b16 v[240:241], v2 offset:36864
  ds_read_b64_tr_b16 v[242:243], v2 offset:37376
  v_mfma_f32_16x16x32_bf16 v[48:51], v[28:31], a[84:87], v[48:51]
  ds_write_b64 v26, v[60:61] offset:0
  v_mfma_f32_16x16x32_bf16 v[48:51], v[32:35], a[104:107], v[48:51]
  ds_read_b64_tr_b16 v[244:245], v2 offset:37888
  ds_read_b64_tr_b16 v[246:247], v2 offset:38400
  v_mfma_f32_16x16x32_bf16 v[48:51], v[36:39], a[124:127], v[48:51]
  ds_write_b64 v26, v[64:65] offset:2048
  v_mfma_f32_16x16x32_bf16 v[44:47], v[36:39], a[120:123], v[44:47]
  v_mfma_f32_16x16x32_bf16 v[44:47], v[32:35], a[100:103], v[44:47]
  ds_read_b64_tr_b16 v[248:249], v2 offset:38912
  ds_read_b64_tr_b16 v[250:251], v2 offset:39424
  v_mfma_f32_16x16x32_bf16 v[44:47], v[28:31], a[80:83], v[44:47]
  buffer_load_dwordx4 v27, s[16:19], s82 offen offset:1024 lds
  v_mfma_f32_16x16x32_bf16 v[40:43], v[28:31], a[76:79], v[40:43]
  ds_write_b64 v26, v[68:69] offset:4096
  v_mfma_f32_16x16x32_bf16 v[40:43], v[32:35], a[96:99], v[40:43]
  v_mfma_f32_16x16x32_bf16 v[40:43], v[36:39], a[116:119], v[40:43]
  s_waitcnt lgkmcnt(4)
  ds_write_b64 v26, v[72:73] offset:6144
  v_mfma_f32_16x16x32_bf16 v[40:43], v[240:243], a[136:139], v[40:43]
  v_mfma_f32_16x16x32_bf16 v[40:43], v[244:247], a[156:159], v[40:43]
  s_waitcnt lgkmcnt(2)
  buffer_load_dwordx4 v27, s[16:19], s83 offen offset:2048 lds
  v_mfma_f32_16x16x32_bf16 v[40:43], v[248:251], a[176:179], v[40:43]
  ds_write_b64 v26, v[76:77] offset:8192
  v_mfma_f32_16x16x32_bf16 v[44:47], v[248:251], a[180:183], v[44:47]
  v_mfma_f32_16x16x32_bf16 v[44:47], v[244:247], a[160:163], v[44:47]
  v_mfma_f32_16x16x32_bf16 v[44:47], v[240:243], a[140:143], v[44:47]
  s_waitcnt vmcnt(6) lgkmcnt(0)
  v_mfma_f32_16x16x32_bf16 v[48:51], v[240:243], a[144:147], v[48:51]
  s_barrier
  v_mfma_f32_16x16x32_bf16 v[48:51], v[244:247], a[164:167], v[48:51]
  s_add_u32 m0, s21, 94208
  ds_read_b64_tr_b16 v[28:29], v3 offset:36864
  ds_read_b64_tr_b16 v[30:31], v3 offset:37376
  v_mfma_f32_16x16x32_bf16 v[48:51], v[248:251], a[184:187], v[48:51]
  buffer_load_dwordx4 v254, s[16:19], s84 offen offset:0 lds
  v_mfma_f32_16x16x32_bf16 v[52:55], v[248:251], a[188:191], v[52:55]
  ds_read_b64_tr_b16 v[32:33], v3 offset:37888
  ds_read_b64_tr_b16 v[34:35], v3 offset:38400
  v_mfma_f32_16x16x32_bf16 v[52:55], v[244:247], a[168:171], v[52:55]
  s_xor_b32 s91, s91, 384
  ds_read_b64_tr_b16 v[36:37], v3 offset:38912
  ds_read_b64_tr_b16 v[38:39], v3 offset:39424
  v_mfma_f32_16x16x32_bf16 v[52:55], v[240:243], a[148:151], v[52:55]
  buffer_load_dwordx4 v254, s[16:19], s85 offen offset:1024 lds
  v_mfma_f32_16x16x32_bf16 v[56:59], v[240:243], a[152:155], v[56:59]
  ds_read_b128 a[216:219], v4 offset:20480
  ds_read_b128 a[220:223], v4 offset:22528
  v_mfma_f32_16x16x32_bf16 v[56:59], v[244:247], a[172:175], v[56:59]
  ds_read_b128 a[224:227], v4 offset:24576
  ds_read_b128 a[228:231], v4 offset:26624
  v_mfma_f32_16x16x32_bf16 v[56:59], v[248:251], a[192:195], v[56:59]
  s_waitcnt lgkmcnt(8)
  ds_read_b128 a[232:235], v4 offset:28672
  v_mfma_f32_16x16x32_bf16 v[40:43], v[28:31], a[196:199], v[40:43]
  ds_read_b128 a[236:239], v4 offset:21504
  ds_read_b128 a[240:243], v4 offset:23552
  v_mfma_f32_16x16x32_bf16 v[44:47], v[28:31], a[200:203], v[44:47]
  buffer_load_dwordx4 v254, s[16:19], s86 offen offset:2048 lds
  v_mfma_f32_16x16x32_bf16 v[48:51], v[28:31], a[204:207], v[48:51]
  ds_read_b128 a[244:247], v4 offset:25600
  v_mfma_f32_16x16x32_bf16 v[52:55], v[28:31], a[208:211], v[52:55]
  ds_read_b128 a[248:251], v4 offset:27648
  v_mfma_f32_16x16x32_bf16 v[56:59], v[28:31], a[212:215], v[56:59]
  s_waitcnt lgkmcnt(4)
  s_mul_i32 s69, s20, 2560
  ds_read_b128 a[252:255], v4 offset:29696
  v_lshl_add_u32 v13, v1, 4, s69
  v_lshl_add_u32 v14, v1, 3, s69
  v_mfma_f32_16x16x32_bf16 v[40:43], v[32:35], a[216:219], v[40:43]
  s_add_u32 m0, s21, 106496
  s_lshl_b32 s69, s20, 9
  ds_read_b64_tr_b16 v[240:241], v3 offset:49152
  ds_read_b64_tr_b16 v[242:243], v3 offset:49664
  v_lshl_add_u32 v19, v1, 3, s69
  v_mfma_f32_16x16x32_bf16 v[44:47], v[32:35], a[220:223], v[44:47]
  buffer_load_dwordx4 v254, s[16:19], s87 offen offset:0 lds
  v_mfma_f32_16x16x32_bf16 v[48:51], v[32:35], a[224:227], v[48:51]
  ds_read_b64_tr_b16 v[244:245], v3 offset:50176
  ds_read_b64_tr_b16 v[246:247], v3 offset:50688
  v_add_u32 v21, 160512, v19
  v_mfma_f32_16x16x32_bf16 v[52:55], v[32:35], a[228:231], v[52:55]
  buffer_load_dwordx4 v12, s[16:19], s88 offen offset:1024 lds
  v_mfma_f32_16x16x32_bf16 v[56:59], v[32:35], a[232:235], v[56:59]
  s_waitcnt lgkmcnt(4)
  v_mfma_f32_16x16x32_bf16 v[60:63], v[36:39], a[236:239], v[40:43]
  ds_read_b64_tr_b16 v[248:249], v3 offset:51200
  ds_read_b64_tr_b16 v[250:251], v3 offset:51712
  v_mfma_f32_16x16x32_bf16 v[64:67], v[36:39], a[240:243], v[44:47]
  buffer_load_dwordx4 v12, s[16:19], s89 offen offset:2048 lds
  v_mfma_f32_16x16x32_bf16 v[68:71], v[36:39], a[244:247], v[48:51]
  s_add_u32 m0, s21, 118784
  s_add_u32 s16, s23, s91
  s_addc_u32 s17, s54, 0
  buffer_load_dword v6, off, s[48:51], 0 sc1
  v_mfma_f32_16x16x32_bf16 v[72:75], v[36:39], a[248:251], v[52:55]
  buffer_load_dwordx4 v90, s[16:19], s72 offen offset:0 lds
  v_mfma_f32_16x16x32_bf16 v[76:79], v[36:39], a[252:255], v[56:59]
  s_waitcnt lgkmcnt(2)
  v_mfma_f32_16x16x32_bf16 v[40:43], v[240:243], v[116:119], 0
  v_mfma_f32_16x16x32_bf16 v[40:43], v[244:247], v[136:139], v[40:43]
  s_waitcnt lgkmcnt(0)
  buffer_load_dwordx4 v90, s[16:19], s73 offen offset:1024 lds
  v_mfma_f32_16x16x32_bf16 v[40:43], v[248:251], v[156:159], v[40:43]
  s_mov_b32 s25, 0
  v_cvt_pk_bf16_f32 v80, v60, v61
  v_cvt_pk_bf16_f32 v81, v62, v63
  v_mfma_f32_16x16x32_bf16 v[44:47], v[248:251], v[160:163], 0
  v_cvt_pk_bf16_f32 v82, v64, v65
  v_cvt_pk_bf16_f32 v83, v66, v67
  v_mfma_f32_16x16x32_bf16 v[44:47], v[244:247], v[140:143], v[44:47]
  v_cvt_pk_bf16_f32 v84, v68, v69
  v_cvt_pk_bf16_f32 v85, v70, v71
  v_mfma_f32_16x16x32_bf16 v[44:47], v[240:243], v[120:123], v[44:47]
  ds_read_b64_tr_b16 v[28:29], v2 offset:24576
  ds_read_b64_tr_b16 v[30:31], v2 offset:25088
  v_mfma_f32_16x16x32_bf16 v[48:51], v[240:243], v[124:127], 0
  buffer_load_dwordx4 v90, s[16:19], s74 offen offset:2048 lds
  v_mfma_f32_16x16x32_bf16 v[48:51], v[244:247], v[144:147], v[48:51]
  ds_read_b64_tr_b16 v[32:33], v2 offset:25600
  ds_read_b64_tr_b16 v[34:35], v2 offset:26112
  v_mfma_f32_16x16x32_bf16 v[48:51], v[248:251], v[164:167], v[48:51]
  v_cvt_pk_bf16_f32 v86, v72, v73
  v_cvt_pk_bf16_f32 v87, v74, v75
  v_mfma_f32_16x16x32_bf16 v[52:55], v[248:251], v[168:171], 0
  v_cvt_pk_bf16_f32 v88, v76, v77
  v_cvt_pk_bf16_f32 v89, v78, v79
  v_mfma_f32_16x16x32_bf16 v[52:55], v[244:247], v[148:151], v[52:55]
  s_add_u32 m0, s21, 69632
  ds_read_b64_tr_b16 v[36:37], v2 offset:26624
  ds_read_b64_tr_b16 v[38:39], v2 offset:27136
  v_mfma_f32_16x16x32_bf16 v[52:55], v[240:243], v[128:131], v[52:55]
  buffer_load_dwordx4 v90, s[16:19], s75 offen offset:0 lds
  v_mfma_f32_16x16x32_bf16 v[56:59], v[240:243], v[132:135], 0
  v_mfma_f32_16x16x32_bf16 v[56:59], v[244:247], v[152:155], v[56:59]
  buffer_load_dwordx4 v91, s[16:19], s76 offen offset:1024 lds
  v_mfma_f32_16x16x32_bf16 v[56:59], v[248:251], v[172:175], v[56:59]
  s_waitcnt lgkmcnt(2)
  v_mfma_f32_16x16x32_bf16 v[56:59], v[28:31], v[192:195], v[56:59]
  v_mfma_f32_16x16x32_bf16 v[56:59], v[32:35], v[212:215], v[56:59]
  s_waitcnt lgkmcnt(0)
  buffer_load_dwordx4 v91, s[16:19], s77 offen offset:2048 lds
  v_mfma_f32_16x16x32_bf16 v[56:59], v[36:39], a[12:15], v[56:59]
  v_mfma_f32_16x16x32_bf16 v[52:55], v[36:39], a[8:11], v[52:55]
  v_mfma_f32_16x16x32_bf16 v[52:55], v[32:35], v[208:211], v[52:55]
  v_mfma_f32_16x16x32_bf16 v[52:55], v[28:31], v[188:191], v[52:55]
  s_waitcnt vmcnt(10)
  v_mfma_f32_16x16x32_bf16 v[48:51], v[28:31], v[184:187], v[48:51]
  s_barrier
  v_mfma_f32_16x16x32_bf16 v[48:51], v[32:35], v[204:207], v[48:51]
  s_add_u32 m0, s21, 131072
  ds_read_b64_tr_b16 v[240:241], v2 offset:12288
  ds_read_b64_tr_b16 v[242:243], v2 offset:12800
  v_mfma_f32_16x16x32_bf16 v[48:51], v[36:39], a[4:7], v[48:51]
  buffer_load_dwordx4 v91, s[16:19], s78 offen offset:0 lds
  v_mfma_f32_16x16x32_bf16 v[44:47], v[36:39], a[0:3], v[44:47]
  ds_read_b64_tr_b16 v[244:245], v2 offset:13312
  ds_read_b64_tr_b16 v[246:247], v2 offset:13824
  v_mfma_f32_16x16x32_bf16 v[44:47], v[32:35], v[200:203], v[44:47]
  ds_read_b64_tr_b16 v[248:249], v2 offset:14336
  ds_read_b64_tr_b16 v[250:251], v2 offset:14848
  v_mfma_f32_16x16x32_bf16 v[44:47], v[28:31], v[180:183], v[44:47]
  buffer_load_dwordx4 v91, s[16:19], s79 offen offset:1024 lds
  v_mfma_f32_16x16x32_bf16 v[40:43], v[28:31], v[176:179], v[40:43]
  v_mfma_f32_16x16x32_bf16 v[40:43], v[32:35], v[196:199], v[40:43]
  buffer_store_dwordx2 v[80:81], v14, s[12:15], 0 offen offset:0 sc1
  v_mfma_f32_16x16x32_bf16 v[40:43], v[36:39], v[216:219], v[40:43]
  s_waitcnt lgkmcnt(2)
  v_mfma_f32_16x16x32_bf16 v[40:43], v[240:243], a[16:19], v[40:43]
  v_mfma_f32_16x16x32_bf16 v[40:43], v[244:247], a[36:39], v[40:43]
  s_waitcnt lgkmcnt(0)
  buffer_load_dwordx4 v27, s[16:19], s80 offen offset:2048 lds
  v_mfma_f32_16x16x32_bf16 v[40:43], v[248:251], a[56:59], v[40:43]
  v_mfma_f32_16x16x32_bf16 v[44:47], v[248:251], a[60:63], v[44:47]
  buffer_store_dwordx2 v[82:83], v14, s[12:15], 0 offen offset:512 sc1
  v_mfma_f32_16x16x32_bf16 v[44:47], v[244:247], a[40:43], v[44:47]
  v_mfma_f32_16x16x32_bf16 v[44:47], v[240:243], a[20:23], v[44:47]
  s_add_u32 m0, s21, 143360
  ds_read_b64_tr_b16 v[28:29], v2 offset:49152
  ds_read_b64_tr_b16 v[30:31], v2 offset:49664
  v_mfma_f32_16x16x32_bf16 v[48:51], v[240:243], a[24:27], v[48:51]
  buffer_load_dwordx4 v27, s[16:19], s81 offen offset:0 lds
  v_mfma_f32_16x16x32_bf16 v[48:51], v[244:247], a[44:47], v[48:51]
  ds_read_b64_tr_b16 v[32:33], v2 offset:50176
  ds_read_b64_tr_b16 v[34:35], v2 offset:50688
  v_mfma_f32_16x16x32_bf16 v[48:51], v[248:251], a[64:67], v[48:51]
  buffer_store_dwordx2 v[84:85], v14, s[12:15], 0 offen offset:1024 sc1
  v_mfma_f32_16x16x32_bf16 v[52:55], v[248:251], a[68:71], v[52:55]
  v_mfma_f32_16x16x32_bf16 v[52:55], v[244:247], a[48:51], v[52:55]
  ds_read_b64_tr_b16 v[36:37], v2 offset:51200
  ds_read_b64_tr_b16 v[38:39], v2 offset:51712
  v_mfma_f32_16x16x32_bf16 v[52:55], v[240:243], a[28:31], v[52:55]
  buffer_load_dwordx4 v27, s[16:19], s82 offen offset:1024 lds
  v_mfma_f32_16x16x32_bf16 v[56:59], v[240:243], a[32:35], v[56:59]
  v_mfma_f32_16x16x32_bf16 v[56:59], v[244:247], a[52:55], v[56:59]
  buffer_store_dwordx2 v[86:87], v14, s[12:15], 0 offen offset:1536 sc1
  v_mfma_f32_16x16x32_bf16 v[56:59], v[248:251], a[72:75], v[56:59]
  s_waitcnt lgkmcnt(2)
  v_mfma_f32_16x16x32_bf16 v[56:59], v[28:31], a[92:95], v[56:59]
  v_mfma_f32_16x16x32_bf16 v[56:59], v[32:35], a[112:115], v[56:59]
  s_waitcnt lgkmcnt(0)
  buffer_load_dwordx4 v27, s[16:19], s83 offen offset:2048 lds
  v_mfma_f32_16x16x32_bf16 v[56:59], v[36:39], a[132:135], v[56:59]
  v_mfma_f32_16x16x32_bf16 v[52:55], v[36:39], a[128:131], v[52:55]
  buffer_store_dwordx2 v[88:89], v14, s[12:15], 0 offen offset:2048 sc1
  v_mfma_f32_16x16x32_bf16 v[52:55], v[32:35], a[108:111], v[52:55]
  v_mfma_f32_16x16x32_bf16 v[52:55], v[28:31], a[88:91], v[52:55]
  s_add_u32 m0, s21, 57344
  ds_read_b64_tr_b16 v[240:241], v3 offset:0
  ds_read_b64_tr_b16 v[242:243], v3 offset:512
  v_mfma_f32_16x16x32_bf16 v[48:51], v[28:31], a[84:87], v[48:51]
  buffer_load_dwordx4 v254, s[16:19], s84 offen offset:0 lds
  v_mfma_f32_16x16x32_bf16 v[48:51], v[32:35], a[104:107], v[48:51]
  ds_read_b64_tr_b16 v[244:245], v3 offset:1024
  ds_read_b64_tr_b16 v[246:247], v3 offset:1536
  v_mfma_f32_16x16x32_bf16 v[48:51], v[36:39], a[124:127], v[48:51]
  v_mfma_f32_16x16x32_bf16 v[44:47], v[36:39], a[120:123], v[44:47]
  v_mfma_f32_16x16x32_bf16 v[44:47], v[32:35], a[100:103], v[44:47]
  ds_read_b64_tr_b16 v[248:249], v3 offset:2048
  ds_read_b64_tr_b16 v[250:251], v3 offset:2560
  v_mfma_f32_16x16x32_bf16 v[44:47], v[28:31], a[80:83], v[44:47]
  buffer_load_dwordx4 v254, s[16:19], s85 offen offset:1024 lds
  v_mfma_f32_16x16x32_bf16 v[40:43], v[28:31], a[76:79], v[40:43]
  v_mfma_f32_16x16x32_bf16 v[40:43], v[32:35], a[96:99], v[40:43]
  v_mfma_f32_16x16x32_bf16 v[40:43], v[36:39], a[116:119], v[40:43]
  s_waitcnt lgkmcnt(2)
  v_mfma_f32_16x16x32_bf16 v[40:43], v[240:243], a[136:139], v[40:43]
  s_xor_b32 s91, s91, 128
  v_mfma_f32_16x16x32_bf16 v[40:43], v[244:247], a[156:159], v[40:43]
  s_waitcnt lgkmcnt(0)
  buffer_load_dwordx4 v254, s[16:19], s86 offen offset:2048 lds
  v_mfma_f32_16x16x32_bf16 v[40:43], v[248:251], a[176:179], v[40:43]
  s_add_u32 m0, s21, 32768
  v_mfma_f32_16x16x32_bf16 v[44:47], v[248:251], a[180:183], v[44:47]
  buffer_load_dwordx4 v254, s[16:19], s87 offen offset:0 lds
  v_mfma_f32_16x16x32_bf16 v[44:47], v[244:247], a[160:163], v[44:47]
  v_mfma_f32_16x16x32_bf16 v[44:47], v[240:243], a[140:143], v[44:47]
  s_waitcnt vmcnt(15)
  v_mfma_f32_16x16x32_bf16 v[48:51], v[240:243], a[144:147], v[48:51]
  s_barrier
  v_mfma_f32_16x16x32_bf16 v[48:51], v[244:247], a[164:167], v[48:51]
  ds_read_b64_tr_b16 v[28:29], v3 offset:12288
  ds_read_b64_tr_b16 v[30:31], v3 offset:12800
  v_mfma_f32_16x16x32_bf16 v[48:51], v[248:251], a[184:187], v[48:51]
  buffer_load_dwordx4 v12, s[16:19], s88 offen offset:1024 lds
  v_mfma_f32_16x16x32_bf16 v[52:55], v[248:251], a[188:191], v[52:55]
  ds_read_b64_tr_b16 v[32:33], v3 offset:13312
  ds_read_b64_tr_b16 v[34:35], v3 offset:13824
  v_mfma_f32_16x16x32_bf16 v[52:55], v[244:247], a[168:171], v[52:55]
  ds_read_b64_tr_b16 v[36:37], v3 offset:14336
  ds_read_b64_tr_b16 v[38:39], v3 offset:14848
  v_mfma_f32_16x16x32_bf16 v[52:55], v[240:243], a[148:151], v[52:55]
  buffer_load_dwordx4 v12, s[16:19], s89 offen offset:2048 lds
  v_mfma_f32_16x16x32_bf16 v[56:59], v[240:243], a[152:155], v[56:59]
  v_cmp_gt_u32 vcc, 1, v6
  s_cbranch_vccnz L_slow_rdy
L_poll_rdy_ok:
  v_mfma_f32_16x16x32_bf16 v[56:59], v[244:247], a[172:175], v[56:59]
  ds_write_b64 v21, v[252:253]
  v_mfma_f32_16x16x32_bf16 v[56:59], v[248:251], a[192:195], v[56:59]
  s_waitcnt lgkmcnt(3)
  s_add_u32 s16, s23, s91
  s_addc_u32 s17, s54, 0
  v_mfma_f32_16x16x32_bf16 v[56:59], v[28:31], a[212:215], v[56:59]
  s_add_u32 m0, s21, 45056
  v_mfma_f32_16x16x32_bf16 v[56:59], v[32:35], a[232:235], v[56:59]
  s_waitcnt lgkmcnt(1)
  buffer_load_dwordx4 v90, s[16:19], s72 offen offset:0 lds
  v_mfma_f32_16x16x32_bf16 v[76:79], v[36:39], a[252:255], v[56:59]
  v_mfma_f32_16x16x32_bf16 v[52:55], v[36:39], a[248:251], v[52:55]
  buffer_load_dwordx4 v90, s[16:19], s73 offen offset:1024 lds
  v_mfma_f32_16x16x32_bf16 v[52:55], v[32:35], a[228:231], v[52:55]
  v_mfma_f32_16x16x32_bf16 v[72:75], v[28:31], a[208:211], v[52:55]
  ds_read_b64_tr_b16 v[240:241], v3 offset:24576
  ds_read_b64_tr_b16 v[242:243], v3 offset:25088
  v_mfma_f32_16x16x32_bf16 v[48:51], v[28:31], a[204:207], v[48:51]
  buffer_load_dwordx4 v90, s[16:19], s74 offen offset:2048 lds
  v_mfma_f32_16x16x32_bf16 v[48:51], v[32:35], a[224:227], v[48:51]
  ds_read_b64_tr_b16 v[244:245], v3 offset:25600
  ds_read_b64_tr_b16 v[246:247], v3 offset:26112
  v_mfma_f32_16x16x32_bf16 v[68:71], v[36:39], a[244:247], v[48:51]
  v_mfma_f32_16x16x32_bf16 v[44:47], v[36:39], a[240:243], v[44:47]
  v_mfma_f32_16x16x32_bf16 v[44:47], v[32:35], a[220:223], v[44:47]
  s_add_u32 m0, s21, 81920
  ds_read_b64_tr_b16 v[248:249], v3 offset:26624
  ds_read_b64_tr_b16 v[250:251], v3 offset:27136
  v_mfma_f32_16x16x32_bf16 v[64:67], v[28:31], a[200:203], v[44:47]
  buffer_load_dwordx4 v90, s[16:19], s75 offen offset:0 lds
  v_mfma_f32_16x16x32_bf16 v[40:43], v[28:31], a[196:199], v[40:43]
  v_mfma_f32_16x16x32_bf16 v[40:43], v[32:35], a[216:219], v[40:43]
  v_mfma_f32_16x16x32_bf16 v[60:63], v[36:39], a[236:239], v[40:43]
  s_waitcnt lgkmcnt(2)
  v_mfma_f32_16x16x32_bf16 v[40:43], v[240:243], v[116:119], 0
  v_mfma_f32_16x16x32_bf16 v[40:43], v[244:247], v[136:139], v[40:43]
  s_waitcnt lgkmcnt(0)
  buffer_load_dwordx4 v91, s[16:19], s76 offen offset:1024 lds
  v_mfma_f32_16x16x32_bf16 v[40:43], v[248:251], v[156:159], v[40:43]
  s_mov_b32 s25, 10240
  v_cvt_pk_bf16_f32 v88, v76, v77
  v_cvt_pk_bf16_f32 v89, v78, v79
  v_mfma_f32_16x16x32_bf16 v[44:47], v[248:251], v[160:163], 0
  v_cvt_pk_bf16_f32 v86, v72, v73
  v_cvt_pk_bf16_f32 v87, v74, v75
  v_mfma_f32_16x16x32_bf16 v[44:47], v[244:247], v[140:143], v[44:47]
  v_cvt_pk_bf16_f32 v84, v68, v69
  v_cvt_pk_bf16_f32 v85, v70, v71
  v_mfma_f32_16x16x32_bf16 v[44:47], v[240:243], v[120:123], v[44:47]
  ds_read_b64_tr_b16 v[28:29], v2 offset:36864
  ds_read_b64_tr_b16 v[30:31], v2 offset:37376
  v_mfma_f32_16x16x32_bf16 v[48:51], v[240:243], v[124:127], 0
  buffer_load_dwordx4 v91, s[16:19], s77 offen offset:2048 lds
  v_mfma_f32_16x16x32_bf16 v[48:51], v[244:247], v[144:147], v[48:51]
  ds_read_b64_tr_b16 v[32:33], v2 offset:37888
  ds_read_b64_tr_b16 v[34:35], v2 offset:38400
  v_mfma_f32_16x16x32_bf16 v[48:51], v[248:251], v[164:167], v[48:51]
  v_cvt_pk_bf16_f32 v82, v64, v65
  v_cvt_pk_bf16_f32 v83, v66, v67
  v_mfma_f32_16x16x32_bf16 v[52:55], v[248:251], v[168:171], 0
  v_cvt_pk_bf16_f32 v80, v60, v61
  v_cvt_pk_bf16_f32 v81, v62, v63
  v_mfma_f32_16x16x32_bf16 v[52:55], v[244:247], v[148:151], v[52:55]
  s_add_u32 m0, s21, 94208
  ds_read_b64_tr_b16 v[36:37], v2 offset:38912
  ds_read_b64_tr_b16 v[38:39], v2 offset:39424
  v_mfma_f32_16x16x32_bf16 v[52:55], v[240:243], v[128:131], v[52:55]
  s_lshl_b32 s69, s52, 10
  buffer_load_dwordx4 v91, s[16:19], s78 offen offset:0 lds
  v_mfma_f32_16x16x32_bf16 v[56:59], v[240:243], v[132:135], 0
  s_add_u32 s69, s69, 23941120
  v_and_b32 v232, 15, v1
  v_lshlrev_b32 v233, 2, v232
  v_mfma_f32_16x16x32_bf16 v[56:59], v[244:247], v[152:155], v[56:59]
  s_lshl_b32 s66, s64, 2
  buffer_load_dwordx4 v91, s[16:19], s79 offen offset:1024 lds
  v_mfma_f32_16x16x32_bf16 v[56:59], v[248:251], v[172:175], v[56:59]
  s_waitcnt lgkmcnt(2)
  v_add_u32 v233, 160000, v233
  v_lshrrev_b32 v234, 2, v232
  v_mfma_f32_16x16x32_bf16 v[56:59], v[28:31], v[192:195], v[56:59]
  s_add_u32 s66, s66, s69
  v_lshl_add_u32 v234, v234, 4, v232
  v_lshlrev_b32 v234, 3, v234
  v_mfma_f32_16x16x32_bf16 v[56:59], v[32:35], v[212:215], v[56:59]
  s_waitcnt lgkmcnt(0)
  buffer_load_dwordx4 v27, s[16:19], s80 offen offset:2048 lds
  v_mfma_f32_16x16x32_bf16 v[56:59], v[36:39], a[12:15], v[56:59]
  v_add_u32 v234, 160512, v234
  v_or_b32 v22, s20, v1
  v_mfma_f32_16x16x32_bf16 v[52:55], v[36:39], a[8:11], v[52:55]
  s_min_u32 s68, s53, 4
  v_cmp_eq_u32 vcc, 0, v22
  v_mov_b32 v22, 2147483647
  v_mfma_f32_16x16x32_bf16 v[52:55], v[32:35], v[208:211], v[52:55]
  s_lshl_b32 s70, s68, 6
  v_add_u32 v235, s70, v233
  v_mov_b32 v23, s66
  v_mfma_f32_16x16x32_bf16 v[52:55], v[28:31], v[188:191], v[52:55]
  s_waitcnt vmcnt(12)
  v_mov_b32 v16, 1
  v_cndmask_b32 v15, v22, v23, vcc
  v_mfma_f32_16x16x32_bf16 v[48:51], v[28:31], v[184:187], v[48:51]
  s_barrier
  v_mfma_f32_16x16x32_bf16 v[48:51], v[32:35], v[204:207], v[48:51]
  s_add_u32 m0, s21, 106496
  ds_read_b64_tr_b16 v[240:241], v3 offset:36864
  ds_read_b64_tr_b16 v[242:243], v3 offset:37376
  v_mfma_f32_16x16x32_bf16 v[48:51], v[36:39], a[4:7], v[48:51]
  s_lshl_b32 s70, s68, 9
  buffer_load_dwordx4 v27, s[16:19], s81 offen offset:0 lds
  v_mfma_f32_16x16x32_bf16 v[44:47], v[36:39], a[0:3], v[44:47]
  s_cmp_eq_u32 s68, 4
  s_cselect_b32 s70, 4, s70
  ds_read_b64_tr_b16 v[244:245], v3 offset:37888
  ds_read_b64_tr_b16 v[246:247], v3 offset:38400
  v_mfma_f32_16x16x32_bf16 v[44:47], v[32:35], v[200:203], v[44:47]
  ds_read_b64_tr_b16 v[248:249], v3 offset:38912
  ds_read_b64_tr_b16 v[250:251], v3 offset:39424
  v_mfma_f32_16x16x32_bf16 v[44:47], v[28:31], v[180:183], v[44:47]
  buffer_load_dwordx4 v27, s[16:19], s82 offen offset:1024 lds
  v_mfma_f32_16x16x32_bf16 v[40:43], v[28:31], v[176:179], v[40:43]
  v_add_u32 v236, s70, v234
  v_and_b32 v23, 7, v1
  v_mfma_f32_16x16x32_bf16 v[40:43], v[32:35], v[196:199], v[40:43]
  s_mov_b32 s65, 0xffff0000
  buffer_store_dwordx4 v[80:83], v13, s[12:15], s25 offen sc1
  v_mfma_f32_16x16x32_bf16 v[40:43], v[36:39], v[216:219], v[40:43]
  s_waitcnt lgkmcnt(2)
  v_lshl_add_u32 v8, v23, 2, s69
  v_mfma_f32_16x16x32_bf16 v[40:43], v[240:243], a[16:19], v[40:43]
  s_add_u32 s69, s69, 384
  v_mov_b32 v9, s69
  v_mfma_f32_16x16x32_bf16 v[40:43], v[244:247], a[36:39], v[40:43]
  s_waitcnt lgkmcnt(0)
  buffer_load_dwordx4 v27, s[16:19], s83 offen offset:2048 lds
  v_mfma_f32_16x16x32_bf16 v[40:43], v[248:251], a[56:59], v[40:43]
  s_cmp_lt_u32 s53, 5
  s_cselect_b64 vcc, -1, 0
  v_mfma_f32_16x16x32_bf16 v[44:47], v[248:251], a[60:63], v[44:47]
  s_lshl_b32 s66, s53, 9
  buffer_store_dwordx4 v[84:87], v13, s[12:15], s25 offen offset:1024 sc1
  v_mfma_f32_16x16x32_bf16 v[44:47], v[244:247], a[40:43], v[44:47]
  v_add_u32 v23, s66, v14
  v_cndmask_b32 v17, v22, v23, vcc
  v_mfma_f32_16x16x32_bf16 v[44:47], v[240:243], a[20:23], v[44:47]
  s_add_u32 m0, s21, 118784
  ds_read_b64_tr_b16 v[28:29], v3 offset:49152
  ds_read_b64_tr_b16 v[30:31], v3 offset:49664
  v_mfma_f32_16x16x32_bf16 v[48:51], v[240:243], a[24:27], v[48:51]
  s_mul_i32 s69, s52, 737280
  buffer_load_dwordx4 v254, s[16:19], s84 offen offset:0 lds
  v_mfma_f32_16x16x32_bf16 v[48:51], v[244:247], a[44:47], v[48:51]
  s_xor_b32 s66, s64, 1
  ds_read_b64_tr_b16 v[32:33], v3 offset:50176
  ds_read_b64_tr_b16 v[34:35], v3 offset:50688
  v_mfma_f32_16x16x32_bf16 v[48:51], v[248:251], a[64:67], v[48:51]
  s_mul_i32 s66, s66, 92160
  buffer_store_dwordx2 v[88:89], v14, s[12:15], s25 offen offset:2048 sc1
  v_mfma_f32_16x16x32_bf16 v[52:55], v[248:251], a[68:71], v[52:55]
  s_add_u32 s66, s66, s69
  v_mfma_f32_16x16x32_bf16 v[52:55], v[244:247], a[48:51], v[52:55]
  ds_read_b64_tr_b16 v[36:37], v3 offset:51200
  ds_read_b64_tr_b16 v[38:39], v3 offset:51712
  v_mfma_f32_16x16x32_bf16 v[52:55], v[240:243], a[28:31], v[52:55]
  buffer_load_dwordx4 v254, s[16:19], s85 offen offset:1024 lds
  v_mfma_f32_16x16x32_bf16 v[56:59], v[240:243], a[32:35], v[56:59]
  ds_read_b32 v220, v233 offset:0
  v_mfma_f32_16x16x32_bf16 v[56:59], v[244:247], a[52:55], v[56:59]
  v_mfma_f32_16x16x32_bf16 v[56:59], v[248:251], a[72:75], v[56:59]
  s_waitcnt lgkmcnt(3)
  ds_read_b32 v221, v233 offset:64
  v_mfma_f32_16x16x32_bf16 v[56:59], v[28:31], a[92:95], v[56:59]
  v_mfma_f32_16x16x32_bf16 v[56:59], v[32:35], a[112:115], v[56:59]
  s_waitcnt lgkmcnt(2)
  buffer_load_dwordx4 v254, s[16:19], s86 offen offset:2048 lds
  v_mfma_f32_16x16x32_bf16 v[56:59], v[36:39], a[132:135], v[56:59]
  ds_read_b32 v222, v233 offset:128
  v_mfma_f32_16x16x32_bf16 v[52:55], v[36:39], a[128:131], v[52:55]
  v_mfma_f32_16x16x32_bf16 v[52:55], v[32:35], a[108:111], v[52:55]
  ds_read_b32 v223, v233 offset:192
  v_mfma_f32_16x16x32_bf16 v[52:55], v[28:31], a[88:91], v[52:55]
  s_add_u32 m0, s21, 69632
  ds_read_b64_tr_b16 v[240:241], v2 offset:24576
  ds_read_b64_tr_b16 v[242:243], v2 offset:25088
  v_mfma_f32_16x16x32_bf16 v[48:51], v[28:31], a[84:87], v[48:51]
  s_xor_b32 s91, s91, 896
  buffer_load_dwordx4 v254, s[16:19], s87 offen offset:0 lds
  v_mfma_f32_16x16x32_bf16 v[48:51], v[32:35], a[104:107], v[48:51]
  ds_read_b64_tr_b16 v[244:245], v2 offset:25600
  ds_read_b64_tr_b16 v[246:247], v2 offset:26112
  v_mfma_f32_16x16x32_bf16 v[48:51], v[36:39], a[124:127], v[48:51]
  v_mfma_f32_16x16x32_bf16 v[44:47], v[36:39], a[120:123], v[44:47]
  ds_read_b32 v224, v233 offset:256
  v_mfma_f32_16x16x32_bf16 v[44:47], v[32:35], a[100:103], v[44:47]
  ds_read_b64_tr_b16 v[248:249], v2 offset:26624
  ds_read_b64_tr_b16 v[250:251], v2 offset:27136
  v_mfma_f32_16x16x32_bf16 v[44:47], v[28:31], a[80:83], v[44:47]
  buffer_load_dwordx4 v12, s[16:19], s88 offen offset:1024 lds
  v_mfma_f32_16x16x32_bf16 v[40:43], v[28:31], a[76:79], v[40:43]
  v_mfma_f32_16x16x32_bf16 v[40:43], v[32:35], a[96:99], v[40:43]
  ds_read_b32 v4, v234 offset:0
  v_mfma_f32_16x16x32_bf16 v[40:43], v[36:39], a[116:119], v[40:43]
  s_waitcnt lgkmcnt(4)
  v_mfma_f32_16x16x32_bf16 v[40:43], v[240:243], a[136:139], v[40:43]
  ds_read_b32 v5, v234 offset:512
  v_mfma_f32_16x16x32_bf16 v[40:43], v[244:247], a[156:159], v[40:43]
  s_waitcnt lgkmcnt(2)
  buffer_load_dwordx4 v12, s[16:19], s89 offen offset:2048 lds
  v_mfma_f32_16x16x32_bf16 v[40:43], v[248:251], a[176:179], v[40:43]
  v_mfma_f32_16x16x32_bf16 v[44:47], v[248:251], a[180:183], v[44:47]
  ds_read_b32 v10, v234 offset:1024
  v_mfma_f32_16x16x32_bf16 v[44:47], v[244:247], a[160:163], v[44:47]
  s_add_u32 s16, s23, s91
  s_addc_u32 s17, s54, 0
  v_mfma_f32_16x16x32_bf16 v[44:47], v[240:243], a[140:143], v[44:47]
  s_waitcnt vmcnt(15)
  ds_read_b32 v11, v234 offset:1536
  v_mfma_f32_16x16x32_bf16 v[48:51], v[240:243], a[144:147], v[48:51]
  s_barrier
  v_mfma_f32_16x16x32_bf16 v[48:51], v[244:247], a[164:167], v[48:51]
  s_add_u32 m0, s21, 131072
  ds_read_b64_tr_b16 v[28:29], v2 offset:0
  ds_read_b64_tr_b16 v[30:31], v2 offset:512
  v_mfma_f32_16x16x32_bf16 v[48:51], v[248:251], a[184:187], v[48:51]
  buffer_load_dwordx4 v90, s[16:19], s72 offen offset:0 lds
  v_mfma_f32_16x16x32_bf16 v[52:55], v[248:251], a[188:191], v[52:55]
  ds_read_b64_tr_b16 v[32:33], v2 offset:1024
  ds_read_b64_tr_b16 v[34:35], v2 offset:1536
  v_mfma_f32_16x16x32_bf16 v[52:55], v[244:247], a[168:171], v[52:55]
  ds_read_b64_tr_b16 v[36:37], v2 offset:2048
  ds_read_b64_tr_b16 v[38:39], v2 offset:2560
  v_mfma_f32_16x16x32_bf16 v[52:55], v[240:243], a[148:151], v[52:55]
  buffer_load_dwordx4 v90, s[16:19], s73 offen offset:1024 lds
  v_mfma_f32_16x16x32_bf16 v[56:59], v[240:243], a[152:155], v[56:59]
  v_mfma_f32_16x16x32_bf16 v[56:59], v[244:247], a[172:175], v[56:59]
  ds_read_b32 v20, v234 offset:4
  v_mfma_f32_16x16x32_bf16 v[56:59], v[248:251], a[192:195], v[56:59]
  s_waitcnt lgkmcnt(3)
  v_mfma_f32_16x16x32_bf16 v[56:59], v[28:31], a[212:215], v[56:59]
  ds_read_b32 v225, v235
  v_mfma_f32_16x16x32_bf16 v[56:59], v[32:35], a[232:235], v[56:59]
  s_waitcnt lgkmcnt(2)
  buffer_load_dwordx4 v90, s[16:19], s74 offen offset:2048 lds
  v_mfma_f32_16x16x32_bf16 v[76:79], v[36:39], a[252:255], v[56:59]
  v_mfma_f32_16x16x32_bf16 v[52:55], v[36:39], a[248:251], v[52:55]
  ds_read_b32 v26, v236
  v_mfma_f32_16x16x32_bf16 v[52:55], v[32:35], a[228:231], v[52:55]
  v_mfma_f32_16x16x32_bf16 v[72:75], v[28:31], a[208:211], v[52:55]
  s_add_u32 m0, s21, 143360
  ds_read_b64_tr_b16 v[240:241], v2 offset:12288
  ds_read_b64_tr_b16 v[242:243], v2 offset:12800
  v_mfma_f32_16x16x32_bf16 v[48:51], v[28:31], a[204:207], v[48:51]
  buffer_load_dwordx4 v90, s[16:19], s75 offen offset:0 lds
  v_mfma_f32_16x16x32_bf16 v[48:51], v[32:35], a[224:227], v[48:51]
  ds_read_b64_tr_b16 v[244:245], v2 offset:13312
  ds_read_b64_tr_b16 v[246:247], v2 offset:13824
  v_mfma_f32_16x16x32_bf16 v[68:71], v[36:39], a[244:247], v[48:51]
  v_mfma_f32_16x16x32_bf16 v[44:47], v[36:39], a[240:243], v[44:47]
  v_mfma_f32_16x16x32_bf16 v[44:47], v[32:35], a[220:223], v[44:47]
  ds_read_b64_tr_b16 v[248:249], v2 offset:14336
  ds_read_b64_tr_b16 v[250:251], v2 offset:14848
  v_mfma_f32_16x16x32_bf16 v[64:67], v[28:31], a[200:203], v[44:47]
  buffer_load_dwordx4 v91, s[16:19], s76 offen offset:1024 lds
  v_mfma_f32_16x16x32_bf16 v[40:43], v[28:31], a[196:199], v[40:43]
  v_mfma_f32_16x16x32_bf16 v[40:43], v[32:35], a[216:219], v[40:43]
  v_mfma_f32_16x16x32_bf16 v[60:63], v[36:39], a[236:239], v[40:43]
  s_waitcnt lgkmcnt(2)
  v_mfma_f32_16x16x32_bf16 v[40:43], v[240:243], v[116:119], 0
  v_mfma_f32_16x16x32_bf16 v[40:43], v[244:247], v[136:139], v[40:43]
  s_waitcnt lgkmcnt(0)
  buffer_load_dwordx4 v91, s[16:19], s77 offen offset:2048 lds
  v_mfma_f32_16x16x32_bf16 v[40:43], v[248:251], v[156:159], v[40:43]
  s_mov_b32 s25, 20480
  v_cvt_pk_bf16_f32 v88, v76, v77
  v_cvt_pk_bf16_f32 v89, v78, v79
  v_mfma_f32_16x16x32_bf16 v[44:47], v[248:251], v[160:163], 0
  v_cvt_pk_bf16_f32 v86, v72, v73
  v_cvt_pk_bf16_f32 v87, v74, v75
  v_mfma_f32_16x16x32_bf16 v[44:47], v[244:247], v[140:143], v[44:47]
  v_cvt_pk_bf16_f32 v84, v68, v69
  v_cvt_pk_bf16_f32 v85, v70, v71
  v_mfma_f32_16x16x32_bf16 v[44:47], v[240:243], v[120:123], v[44:47]
  s_add_u32 m0, s21, 57344
  ds_read_b64_tr_b16 v[28:29], v2 offset:49152
  ds_read_b64_tr_b16 v[30:31], v2 offset:49664
  v_mfma_f32_16x16x32_bf16 v[48:51], v[240:243], v[124:127], 0
  buffer_load_dwordx4 v91, s[16:19], s78 offen offset:0 lds
  v_mfma_f32_16x16x32_bf16 v[48:51], v[244:247], v[144:147], v[48:51]
L_fw3:
  s_cbranch_execz L_ffn_ret
  ds_read_b64_tr_b16 v[32:33], v2 offset:50176
  ds_read_b64_tr_b16 v[34:35], v2 offset:50688
  v_mfma_f32_16x16x32_bf16 v[48:51], v[248:251], v[164:167], v[48:51]
  v_cvt_pk_bf16_f32 v82, v64, v65
  v_cvt_pk_bf16_f32 v83, v66, v67
  v_mfma_f32_16x16x32_bf16 v[52:55], v[248:251], v[168:171], 0
  v_cvt_pk_bf16_f32 v80, v60, v61
  v_cvt_pk_bf16_f32 v81, v62, v63
  v_mfma_f32_16x16x32_bf16 v[52:55], v[244:247], v[148:151], v[52:55]
  s_add_u32 s26, s66, 10240
  ds_read_b64_tr_b16 v[36:37], v2 offset:51200
  ds_read_b64_tr_b16 v[38:39], v2 offset:51712
  v_mfma_f32_16x16x32_bf16 v[52:55], v[240:243], v[128:131], v[52:55]
  s_xor_b32 s66, s64, 2
  buffer_load_dwordx4 v91, s[16:19], s79 offen offset:1024 lds
  v_mfma_f32_16x16x32_bf16 v[56:59], v[240:243], v[132:135], 0
  s_mul_i32 s66, s66, 92160
  v_mul_f32 v220, 0x3ae38e39, v220
  v_mul_f32 v221, 0x3ae38e39, v221
  v_mfma_f32_16x16x32_bf16 v[56:59], v[244:247], v[152:155], v[56:59]
  s_add_u32 s66, s66, s69
  v_mul_f32 v222, 0x3ae38e39, v222
  v_mfma_f32_16x16x32_bf16 v[56:59], v[248:251], v[172:175], v[56:59]
  s_waitcnt lgkmcnt(2)
  v_mul_f32 v223, 0x3ae38e39, v223
  v_mfma_f32_16x16x32_bf16 v[56:59], v[28:31], v[192:195], v[56:59]
  s_add_u32 s27, s66, 20480
  v_mul_f32 v224, 0x3ae38e39, v224
  v_mfma_f32_16x16x32_bf16 v[56:59], v[32:35], v[212:215], v[56:59]
  s_waitcnt lgkmcnt(0)
  buffer_load_dwordx4 v27, s[16:19], s80 offen offset:2048 lds
  v_mfma_f32_16x16x32_bf16 v[56:59], v[36:39], a[12:15], v[56:59]
  s_xor_b32 s66, s64, 3
  v_mul_f32 v225, 0x3ae38e39, v225
  v_mfma_f32_16x16x32_bf16 v[52:55], v[36:39], a[8:11], v[52:55]
  s_mul_i32 s66, s66, 92160
  v_mul_f32 v4, 0x3ae38e39, v4
  v_mul_f32 v5, 0x3ae38e39, v5
  v_mfma_f32_16x16x32_bf16 v[52:55], v[32:35], v[208:211], v[52:55]
  s_add_u32 s66, s66, s69
  v_mul_f32 v10, 0x3ae38e39, v10
  v_mfma_f32_16x16x32_bf16 v[52:55], v[28:31], v[188:191], v[52:55]
  s_waitcnt vmcnt(12)
  v_mul_f32 v11, 0x3ae38e39, v11
  v_mfma_f32_16x16x32_bf16 v[48:51], v[28:31], v[184:187], v[48:51]
  s_barrier
  v_mfma_f32_16x16x32_bf16 v[48:51], v[32:35], v[204:207], v[48:51]
  s_add_u32 m0, s21, 32768
  ds_read_b64_tr_b16 v[240:241], v3 offset:0
  ds_read_b64_tr_b16 v[242:243], v3 offset:512
  v_mfma_f32_16x16x32_bf16 v[48:51], v[36:39], a[4:7], v[48:51]
  s_add_u32 s28, s66, 30720
  buffer_load_dwordx4 v27, s[16:19], s81 offen offset:0 lds
  v_mfma_f32_16x16x32_bf16 v[44:47], v[36:39], a[0:3], v[44:47]
  s_xor_b32 s66, s64, 4
  ds_read_b64_tr_b16 v[244:245], v3 offset:1024
  ds_read_b64_tr_b16 v[246:247], v3 offset:1536
  v_mfma_f32_16x16x32_bf16 v[44:47], v[32:35], v[200:203], v[44:47]
  s_mul_i32 s66, s66, 92160
  ds_read_b64_tr_b16 v[248:249], v3 offset:2048
  ds_read_b64_tr_b16 v[250:251], v3 offset:2560
  v_mfma_f32_16x16x32_bf16 v[44:47], v[28:31], v[180:183], v[44:47]
  s_add_u32 s66, s66, s69
  buffer_load_dwordx4 v27, s[16:19], s82 offen offset:1024 lds
  v_mfma_f32_16x16x32_bf16 v[40:43], v[28:31], v[176:179], v[40:43]
  s_add_u32 s29, s66, 40960
  v_mul_f32 v20, 0x3ae38e39, v20
  v_mfma_f32_16x16x32_bf16 v[40:43], v[32:35], v[196:199], v[40:43]
  s_xor_b32 s66, s64, 5
  buffer_store_dwordx4 v[80:83], v13, s[12:15], s25 offen sc1
  v_mfma_f32_16x16x32_bf16 v[40:43], v[36:39], v[216:219], v[40:43]
  s_waitcnt lgkmcnt(2)
  v_mul_f32 v26, 0x3ae38e39, v26
  v_mfma_f32_16x16x32_bf16 v[40:43], v[240:243], a[16:19], v[40:43]
  s_mul_i32 s66, s66, 92160
  v_fma_f32 v4, -v220, v220, v4
  v_fma_f32 v5, -v221, v221, v5
  v_mfma_f32_16x16x32_bf16 v[40:43], v[244:247], a[36:39], v[40:43]
  s_waitcnt lgkmcnt(0)
  buffer_load_dwordx4 v27, s[16:19], s83 offen offset:2048 lds
  v_mfma_f32_16x16x32_bf16 v[40:43], v[248:251], a[56:59], v[40:43]
  s_add_u32 s66, s66, s69
  v_fma_f32 v10, -v222, v222, v10
  v_mfma_f32_16x16x32_bf16 v[44:47], v[248:251], a[60:63], v[44:47]
  s_add_u32 s30, s66, 51200
  buffer_store_dwordx4 v[84:87], v13, s[12:15], s25 offen offset:1024 sc1
  v_mfma_f32_16x16x32_bf16 v[44:47], v[244:247], a[40:43], v[44:47]
  s_xor_b32 s66, s64, 6
  v_fma_f32 v11, -v223, v223, v11
  v_mfma_f32_16x16x32_bf16 v[44:47], v[240:243], a[20:23], v[44:47]
  s_add_u32 m0, s21, 45056
  ds_read_b64_tr_b16 v[28:29], v3 offset:12288
  ds_read_b64_tr_b16 v[30:31], v3 offset:12800
  v_mfma_f32_16x16x32_bf16 v[48:51], v[240:243], a[24:27], v[48:51]
  s_mul_i32 s66, s66, 92160
  buffer_load_dwordx4 v254, s[16:19], s84 offen offset:0 lds
  v_mfma_f32_16x16x32_bf16 v[48:51], v[244:247], a[44:47], v[48:51]
  s_add_u32 s66, s66, s69
  ds_read_b64_tr_b16 v[32:33], v3 offset:13312
  ds_read_b64_tr_b16 v[34:35], v3 offset:13824
  v_mfma_f32_16x16x32_bf16 v[48:51], v[248:251], a[64:67], v[48:51]
  s_add_u32 s31, s66, 61440
  buffer_store_dwordx2 v[88:89], v14, s[12:15], s25 offen offset:2048 sc1
  v_mfma_f32_16x16x32_bf16 v[52:55], v[248:251], a[68:71], v[52:55]
  s_xor_b32 s66, s64, 7
  v_fma_f32 v20, -v224, v224, v20
  v_mfma_f32_16x16x32_bf16 v[52:55], v[244:247], a[48:51], v[52:55]
  ds_read_b64_tr_b16 v[36:37], v3 offset:14336
  ds_read_b64_tr_b16 v[38:39], v3 offset:14848
  v_mfma_f32_16x16x32_bf16 v[52:55], v[240:243], a[28:31], v[52:55]
  buffer_load_dwordx4 v254, s[16:19], s85 offen offset:1024 lds
  v_mfma_f32_16x16x32_bf16 v[56:59], v[240:243], a[32:35], v[56:59]
  v_fma_f32 v26, -v225, v225, v26
  v_mfma_f32_16x16x32_bf16 v[56:59], v[244:247], a[52:55], v[56:59]
  v_max_f32 v4, 0, v4
  v_mfma_f32_16x16x32_bf16 v[56:59], v[248:251], a[72:75], v[56:59]
  s_waitcnt lgkmcnt(2)
  v_max_f32 v5, 0, v5
  v_max_f32 v10, 0, v10
  v_mfma_f32_16x16x32_bf16 v[56:59], v[28:31], a[92:95], v[56:59]
  v_max_f32 v11, 0, v11
  v_mfma_f32_16x16x32_bf16 v[56:59], v[32:35], a[112:115], v[56:59]
  s_waitcnt lgkmcnt(0)
  buffer_load_dwordx4 v254, s[16:19], s86 offen offset:2048 lds
  v_mfma_f32_16x16x32_bf16 v[56:59], v[36:39], a[132:135], v[56:59]
  v_max_f32 v20, 0, v20
  v_mfma_f32_16x16x32_bf16 v[52:55], v[36:39], a[128:131], v[52:55]
  v_max_f32 v26, 0, v26
  v_mfma_f32_16x16x32_bf16 v[52:55], v[32:35], a[108:111], v[52:55]
  v_cvt_pk_bf16_f32 v220, v220, v4
  v_mfma_f32_16x16x32_bf16 v[52:55], v[28:31], a[88:91], v[52:55]
  s_add_u32 m0, s21, 81920
  ds_read_b64_tr_b16 v[240:241], v3 offset:24576
  ds_read_b64_tr_b16 v[242:243], v3 offset:25088
  v_mfma_f32_16x16x32_bf16 v[48:51], v[28:31], a[84:87], v[48:51]
  s_xor_b32 s91, s91, 128
  buffer_load_dwordx4 v254, s[16:19], s87 offen offset:0 lds
  v_mfma_f32_16x16x32_bf16 v[48:51], v[32:35], a[104:107], v[48:51]
  ds_read_b64_tr_b16 v[244:245], v3 offset:25600
  ds_read_b64_tr_b16 v[246:247], v3 offset:26112
  v_mfma_f32_16x16x32_bf16 v[48:51], v[36:39], a[124:127], v[48:51]
  v_cvt_pk_bf16_f32 v221, v221, v5
  v_cvt_pk_bf16_f32 v222, v222, v10
  v_mfma_f32_16x16x32_bf16 v[44:47], v[36:39], a[120:123], v[44:47]
  v_cvt_pk_bf16_f32 v223, v223, v11
  v_mfma_f32_16x16x32_bf16 v[44:47], v[32:35], a[100:103], v[44:47]
  ds_read_b64_tr_b16 v[248:249], v3 offset:26624
  ds_read_b64_tr_b16 v[250:251], v3 offset:27136
  v_mfma_f32_16x16x32_bf16 v[44:47], v[28:31], a[80:83], v[44:47]
  buffer_load_dwordx4 v12, s[16:19], s88 offen offset:1024 lds
  v_mfma_f32_16x16x32_bf16 v[40:43], v[28:31], a[76:79], v[40:43]
  v_cvt_pk_bf16_f32 v224, v224, v20
  v_mfma_f32_16x16x32_bf16 v[40:43], v[32:35], a[96:99], v[40:43]
  v_cvt_pk_bf16_f32 v225, v225, v26
  v_mfma_f32_16x16x32_bf16 v[40:43], v[36:39], a[116:119], v[40:43]
  s_waitcnt lgkmcnt(2)
  v_and_b32 v4, s65, v220
  v_mfma_f32_16x16x32_bf16 v[40:43], v[240:243], a[136:139], v[40:43]
  v_and_b32 v5, s65, v221
  v_and_b32 v10, s65, v222
  v_mfma_f32_16x16x32_bf16 v[40:43], v[244:247], a[156:159], v[40:43]
  s_waitcnt lgkmcnt(0)
  buffer_load_dwordx4 v12, s[16:19], s89 offen offset:2048 lds
  v_mfma_f32_16x16x32_bf16 v[40:43], v[248:251], a[176:179], v[40:43]
  v_and_b32 v11, s65, v223
  v_mfma_f32_16x16x32_bf16 v[44:47], v[248:251], a[180:183], v[44:47]
  v_and_b32 v20, s65, v224
  v_mfma_f32_16x16x32_bf16 v[44:47], v[244:247], a[160:163], v[44:47]
  s_add_u32 s16, s23, s91
  s_addc_u32 s17, s54, 0
  v_and_b32 v26, s65, v225
  v_mfma_f32_16x16x32_bf16 v[44:47], v[240:243], a[140:143], v[44:47]
  s_waitcnt vmcnt(15)
  v_lshlrev_b32 v220, 16, v220
  v_mfma_f32_16x16x32_bf16 v[48:51], v[240:243], a[144:147], v[48:51]
  s_barrier
  v_mfma_f32_16x16x32_bf16 v[48:51], v[244:247], a[164:167], v[48:51]
  s_add_u32 m0, s21, 94208
  ds_read_b64_tr_b16 v[28:29], v2 offset:36864
  ds_read_b64_tr_b16 v[30:31], v2 offset:37376
  v_mfma_f32_16x16x32_bf16 v[48:51], v[248:251], a[184:187], v[48:51]
  buffer_load_dwordx4 v90, s[16:19], s72 offen offset:0 lds
  v_mfma_f32_16x16x32_bf16 v[52:55], v[248:251], a[188:191], v[52:55]
  ds_read_b64_tr_b16 v[32:33], v2 offset:37888
  ds_read_b64_tr_b16 v[34:35], v2 offset:38400
  v_mfma_f32_16x16x32_bf16 v[52:55], v[244:247], a[168:171], v[52:55]
  ds_read_b64_tr_b16 v[36:37], v2 offset:38912
  ds_read_b64_tr_b16 v[38:39], v2 offset:39424
  v_mfma_f32_16x16x32_bf16 v[52:55], v[240:243], a[148:151], v[52:55]
  buffer_load_dwordx4 v90, s[16:19], s73 offen offset:1024 lds
  v_mfma_f32_16x16x32_bf16 v[56:59], v[240:243], a[152:155], v[56:59]
  v_lshlrev_b32 v221, 16, v221
  v_mfma_f32_16x16x32_bf16 v[56:59], v[244:247], a[172:175], v[56:59]
  v_lshlrev_b32 v222, 16, v222
  v_lshlrev_b32 v223, 16, v223
  v_mfma_f32_16x16x32_bf16 v[56:59], v[248:251], a[192:195], v[56:59]
  s_waitcnt lgkmcnt(2)
  v_lshlrev_b32 v224, 16, v224
  v_mfma_f32_16x16x32_bf16 v[56:59], v[28:31], a[212:215], v[56:59]
  v_lshlrev_b32 v225, 16, v225
  v_mfma_f32_16x16x32_bf16 v[56:59], v[32:35], a[232:235], v[56:59]
  s_waitcnt lgkmcnt(0)
  buffer_load_dwordx4 v90, s[16:19], s74 offen offset:2048 lds
  v_mfma_f32_16x16x32_bf16 v[76:79], v[36:39], a[252:255], v[56:59]
  v_add_f32 v4, 0x3727c5ac, v4
  v_mfma_f32_16x16x32_bf16 v[52:55], v[36:39], a[248:251], v[52:55]
  v_add_f32 v5, 0x3727c5ac, v5
  v_mfma_f32_16x16x32_bf16 v[52:55], v[32:35], a[228:231], v[52:55]
  v_add_f32 v10, 0x3727c5ac, v10
  v_add_f32 v11, 0x3727c5ac, v11
  v_mfma_f32_16x16x32_bf16 v[72:75], v[28:31], a[208:211], v[52:55]
  s_add_u32 m0, s21, 106496
  ds_read_b64_tr_b16 v[240:241], v3 offset:36864
  ds_read_b64_tr_b16 v[242:243], v3 offset:37376
  v_mfma_f32_16x16x32_bf16 v[48:51], v[28:31], a[204:207], v[48:51]
  buffer_load_dwordx4 v90, s[16:19], s75 offen offset:0 lds
  v_mfma_f32_16x16x32_bf16 v[48:51], v[32:35], a[224:227], v[48:51]
  ds_read_b64_tr_b16 v[244:245], v3 offset:37888
  ds_read_b64_tr_b16 v[246:247], v3 offset:38400
  v_mfma_f32_16x16x32_bf16 v[68:71], v[36:39], a[244:247], v[48:51]
  v_add_f32 v20, 0x3727c5ac, v20
  v_mfma_f32_16x16x32_bf16 v[44:47], v[36:39], a[240:243], v[44:47]
  v_add_f32 v26, 0x3727c5ac, v26
  v_mfma_f32_16x16x32_bf16 v[44:47], v[32:35], a[220:223], v[44:47]
  ds_read_b64_tr_b16 v[248:249], v3 offset:38912
  ds_read_b64_tr_b16 v[250:251], v3 offset:39424
  v_mfma_f32_16x16x32_bf16 v[64:67], v[28:31], a[200:203], v[44:47]
  buffer_load_dwordx4 v91, s[16:19], s76 offen offset:1024 lds
  v_mfma_f32_16x16x32_bf16 v[40:43], v[28:31], a[196:199], v[40:43]
  v_cvt_pk_bf16_f32 v4, v4, v4
  v_mfma_f32_16x16x32_bf16 v[40:43], v[32:35], a[216:219], v[40:43]
  v_cvt_pk_bf16_f32 v5, v5, v5
  v_mfma_f32_16x16x32_bf16 v[60:63], v[36:39], a[236:239], v[40:43]
  s_waitcnt lgkmcnt(2)
  v_cvt_pk_bf16_f32 v10, v10, v10
  v_mfma_f32_16x16x32_bf16 v[40:43], v[240:243], v[116:119], 0
  v_mfma_f32_16x16x32_bf16 v[40:43], v[244:247], v[136:139], v[40:43]
  s_waitcnt lgkmcnt(0)
  buffer_load_dwordx4 v91, s[16:19], s77 offen offset:2048 lds
  v_mfma_f32_16x16x32_bf16 v[40:43], v[248:251], v[156:159], v[40:43]
  s_mov_b32 s25, 30720
  v_cvt_pk_bf16_f32 v88, v76, v77
  v_cvt_pk_bf16_f32 v89, v78, v79
  v_mfma_f32_16x16x32_bf16 v[44:47], v[248:251], v[160:163], 0
  v_cvt_pk_bf16_f32 v86, v72, v73
  v_cvt_pk_bf16_f32 v87, v74, v75
  v_mfma_f32_16x16x32_bf16 v[44:47], v[244:247], v[140:143], v[44:47]
  v_cvt_pk_bf16_f32 v84, v68, v69
  v_cvt_pk_bf16_f32 v85, v70, v71
  v_mfma_f32_16x16x32_bf16 v[44:47], v[240:243], v[120:123], v[44:47]
  s_add_u32 m0, s21, 118784
  ds_read_b64_tr_b16 v[28:29], v3 offset:49152
  ds_read_b64_tr_b16 v[30:31], v3 offset:49664
  v_mfma_f32_16x16x32_bf16 v[48:51], v[240:243], v[124:127], 0
  buffer_load_dwordx4 v91, s[16:19], s78 offen offset:0 lds
  v_mfma_f32_16x16x32_bf16 v[48:51], v[244:247], v[144:147], v[48:51]
  ds_read_b64_tr_b16 v[32:33], v3 offset:50176
  ds_read_b64_tr_b16 v[34:35], v3 offset:50688
  v_mfma_f32_16x16x32_bf16 v[48:51], v[248:251], v[164:167], v[48:51]
  v_cvt_pk_bf16_f32 v82, v64, v65
  v_cvt_pk_bf16_f32 v83, v66, v67
  v_mfma_f32_16x16x32_bf16 v[52:55], v[248:251], v[168:171], 0
  v_cvt_pk_bf16_f32 v80, v60, v61
  v_cvt_pk_bf16_f32 v81, v62, v63
  v_mfma_f32_16x16x32_bf16 v[52:55], v[244:247], v[148:151], v[52:55]
  s_mul_i32 s66, s66, 92160
  ds_read_b64_tr_b16 v[36:37], v3 offset:51200
  ds_read_b64_tr_b16 v[38:39], v3 offset:51712
  v_mfma_f32_16x16x32_bf16 v[52:55], v[240:243], v[128:131], v[52:55]
  s_add_u32 s66, s66, s69
  buffer_load_dwordx4 v91, s[16:19], s79 offen offset:1024 lds
  v_mfma_f32_16x16x32_bf16 v[56:59], v[240:243], v[132:135], 0
  s_add_u32 s32, s66, 71680
  v_cvt_pk_bf16_f32 v11, v11, v11
  v_cvt_pk_bf16_f32 v20, v20, v20
  v_mfma_f32_16x16x32_bf16 v[56:59], v[244:247], v[152:155], v[56:59]
  s_add_u32 s33, s69, 0
  v_cvt_pk_bf16_f32 v26, v26, v26
  v_mfma_f32_16x16x32_bf16 v[56:59], v[248:251], v[172:175], v[56:59]
  s_waitcnt lgkmcnt(2)
  v_and_b32 v4, s65, v4
  v_mfma_f32_16x16x32_bf16 v[56:59], v[28:31], v[192:195], v[56:59]
  s_add_u32 s34, s69, 92160
  v_and_b32 v5, s65, v5
  v_mfma_f32_16x16x32_bf16 v[56:59], v[32:35], v[212:215], v[56:59]
  s_waitcnt lgkmcnt(0)
  buffer_load_dwordx4 v27, s[16:19], s80 offen offset:2048 lds
  v_mfma_f32_16x16x32_bf16 v[56:59], v[36:39], a[12:15], v[56:59]
  s_add_u32 s35, s69, 184320
  v_and_b32 v10, s65, v10
  v_mfma_f32_16x16x32_bf16 v[52:55], v[36:39], a[8:11], v[52:55]
  s_add_u32 s36, s69, 276480
  v_and_b32 v11, s65, v11
  v_and_b32 v20, s65, v20
  v_mfma_f32_16x16x32_bf16 v[52:55], v[32:35], v[208:211], v[52:55]
  s_add_u32 s37, s69, 368640
  v_and_b32 v26, s65, v26
  v_mfma_f32_16x16x32_bf16 v[52:55], v[28:31], v[188:191], v[52:55]
  s_waitcnt vmcnt(12)
  v_sqrt_f32 v4, v4
  v_mfma_f32_16x16x32_bf16 v[48:51], v[28:31], v[184:187], v[48:51]
  s_barrier
  v_mfma_f32_16x16x32_bf16 v[48:51], v[32:35], v[204:207], v[48:51]
  s_add_u32 m0, s21, 69632
  ds_read_b64_tr_b16 v[240:241], v2 offset:24576
  ds_read_b64_tr_b16 v[242:243], v2 offset:25088
  v_mfma_f32_16x16x32_bf16 v[48:51], v[36:39], a[4:7], v[48:51]
  s_add_u32 s38, s69, 460800
  buffer_load_dwordx4 v27, s[16:19], s81 offen offset:0 lds
  v_mfma_f32_16x16x32_bf16 v[44:47], v[36:39], a[0:3], v[44:47]
  s_add_u32 s39, s69, 552960
  ds_read_b64_tr_b16 v[244:245], v2 offset:25600
  ds_read_b64_tr_b16 v[246:247], v2 offset:26112
  v_mfma_f32_16x16x32_bf16 v[44:47], v[32:35], v[200:203], v[44:47]
  s_add_u32 s40, s69, 645120
  ds_read_b64_tr_b16 v[248:249], v2 offset:26624
  ds_read_b64_tr_b16 v[250:251], v2 offset:27136
  v_mfma_f32_16x16x32_bf16 v[44:47], v[28:31], v[180:183], v[44:47]
  s_mul_i32 s69, s52, 92160
  buffer_load_dwordx4 v27, s[16:19], s82 offen offset:1024 lds
  v_mfma_f32_16x16x32_bf16 v[40:43], v[28:31], v[176:179], v[40:43]
  s_add_u32 s69, s69, 19169280
  v_sqrt_f32 v5, v5
  v_mfma_f32_16x16x32_bf16 v[40:43], v[32:35], v[196:199], v[40:43]
  s_mul_i32 s66, s68, 18432
  buffer_store_dwordx4 v[80:83], v13, s[12:15], s25 offen sc1
  v_mfma_f32_16x16x32_bf16 v[40:43], v[36:39], v[216:219], v[40:43]
  s_waitcnt lgkmcnt(2)
  v_sqrt_f32 v10, v10
  v_mfma_f32_16x16x32_bf16 v[40:43], v[240:243], a[16:19], v[40:43]
  s_add_u32 s66, s66, s69
  v_sqrt_f32 v11, v11
  v_sqrt_f32 v20, v20
  v_mfma_f32_16x16x32_bf16 v[40:43], v[244:247], a[36:39], v[40:43]
  s_waitcnt lgkmcnt(0)
  buffer_load_dwordx4 v27, s[16:19], s83 offen offset:2048 lds
  v_mfma_f32_16x16x32_bf16 v[40:43], v[248:251], a[56:59], v[40:43]
  s_add_u32 s10, s66, 16384
  v_sqrt_f32 v26, v26
  v_mfma_f32_16x16x32_bf16 v[44:47], v[248:251], a[60:63], v[44:47]
  s_lshl_b32 s66, s64, 11
  buffer_store_dwordx4 v[84:87], v13, s[12:15], s25 offen offset:1024 sc1
  v_mfma_f32_16x16x32_bf16 v[44:47], v[244:247], a[40:43], v[44:47]
  s_add_u32 s41, s69, s66
  v_cvt_pk_bf16_f32 v4, v4, v4
  v_mfma_f32_16x16x32_bf16 v[44:47], v[240:243], a[20:23], v[44:47]
  s_add_u32 m0, s21, 131072
  ds_read_b64_tr_b16 v[28:29], v2 offset:0
  ds_read_b64_tr_b16 v[30:31], v2 offset:512
  v_mfma_f32_16x16x32_bf16 v[48:51], v[240:243], a[24:27], v[48:51]
  s_add_u32 s42, s41, 18432
  buffer_load_dwordx4 v254, s[16:19], s84 offen offset:0 lds
  v_mfma_f32_16x16x32_bf16 v[48:51], v[244:247], a[44:47], v[48:51]
  s_add_u32 s43, s41, 36864
  ds_read_b64_tr_b16 v[32:33], v2 offset:1024
  ds_read_b64_tr_b16 v[34:35], v2 offset:1536
  v_mfma_f32_16x16x32_bf16 v[48:51], v[248:251], a[64:67], v[48:51]
  s_add_u32 s8, s41, 55296
  buffer_store_dwordx2 v[88:89], v14, s[12:15], s25 offen offset:2048 sc1
  v_mfma_f32_16x16x32_bf16 v[52:55], v[248:251], a[68:71], v[52:55]
  s_add_u32 s9, s41, 73728
  v_cvt_pk_bf16_f32 v5, v5, v5
  v_mfma_f32_16x16x32_bf16 v[52:55], v[244:247], a[48:51], v[52:55]
  ds_read_b64_tr_b16 v[36:37], v2 offset:2048
  ds_read_b64_tr_b16 v[38:39], v2 offset:2560
  v_mfma_f32_16x16x32_bf16 v[52:55], v[240:243], a[28:31], v[52:55]
  buffer_load_dwordx4 v254, s[16:19], s85 offen offset:1024 lds
  v_mfma_f32_16x16x32_bf16 v[56:59], v[240:243], a[32:35], v[56:59]
  v_cvt_pk_bf16_f32 v10, v10, v10
  v_mfma_f32_16x16x32_bf16 v[56:59], v[244:247], a[52:55], v[56:59]
  v_cvt_pk_bf16_f32 v11, v11, v11
  v_mfma_f32_16x16x32_bf16 v[56:59], v[248:251], a[72:75], v[56:59]
  s_waitcnt lgkmcnt(2)
  v_cvt_pk_bf16_f32 v20, v20, v20
  v_cvt_pk_bf16_f32 v26, v26, v26
  v_mfma_f32_16x16x32_bf16 v[56:59], v[28:31], a[92:95], v[56:59]
  v_and_b32 v4, s65, v4
  v_mfma_f32_16x16x32_bf16 v[56:59], v[32:35], a[112:115], v[56:59]
  s_waitcnt lgkmcnt(0)
  buffer_load_dwordx4 v254, s[16:19], s86 offen offset:2048 lds
  v_mfma_f32_16x16x32_bf16 v[56:59], v[36:39], a[132:135], v[56:59]
  v_and_b32 v5, s65, v5
  v_mfma_f32_16x16x32_bf16 v[52:55], v[36:39], a[128:131], v[52:55]
  v_and_b32 v10, s65, v10
  v_mfma_f32_16x16x32_bf16 v[52:55], v[32:35], a[108:111], v[52:55]
  v_and_b32 v11, s65, v11
  v_mfma_f32_16x16x32_bf16 v[52:55], v[28:31], a[88:91], v[52:55]
  s_add_u32 m0, s21, 143360
  ds_read_b64_tr_b16 v[240:241], v2 offset:12288
  ds_read_b64_tr_b16 v[242:243], v2 offset:12800
  v_mfma_f32_16x16x32_bf16 v[48:51], v[28:31], a[84:87], v[48:51]
  s_xor_b32 s91, s91, 384
  buffer_load_dwordx4 v254, s[16:19], s87 offen offset:0 lds
  v_mfma_f32_16x16x32_bf16 v[48:51], v[32:35], a[104:107], v[48:51]
  ds_read_b64_tr_b16 v[244:245], v2 offset:13312
  ds_read_b64_tr_b16 v[246:247], v2 offset:13824
  v_mfma_f32_16x16x32_bf16 v[48:51], v[36:39], a[124:127], v[48:51]
  v_and_b32 v20, s65, v20
  v_and_b32 v26, s65, v26
  v_mfma_f32_16x16x32_bf16 v[44:47], v[36:39], a[120:123], v[44:47]
  v_rcp_f32 v4, v4
  v_mfma_f32_16x16x32_bf16 v[44:47], v[32:35], a[100:103], v[44:47]
  ds_read_b64_tr_b16 v[248:249], v2 offset:14336
  ds_read_b64_tr_b16 v[250:251], v2 offset:14848
  v_mfma_f32_16x16x32_bf16 v[44:47], v[28:31], a[80:83], v[44:47]
  buffer_load_dwordx4 v12, s[16:19], s88 offen offset:1024 lds
  v_mfma_f32_16x16x32_bf16 v[40:43], v[28:31], a[76:79], v[40:43]
  v_rcp_f32 v5, v5
  v_mfma_f32_16x16x32_bf16 v[40:43], v[32:35], a[96:99], v[40:43]
  v_rcp_f32 v10, v10
  v_mfma_f32_16x16x32_bf16 v[40:43], v[36:39], a[116:119], v[40:43]
  s_waitcnt lgkmcnt(2)
  v_rcp_f32 v11, v11
  v_mfma_f32_16x16x32_bf16 v[40:43], v[240:243], a[136:139], v[40:43]
  v_rcp_f32 v20, v20
  v_rcp_f32 v26, v26
  v_mfma_f32_16x16x32_bf16 v[40:43], v[244:247], a[156:159], v[40:43]
  s_waitcnt lgkmcnt(0)
  buffer_load_dwordx4 v12, s[16:19], s89 offen offset:2048 lds
  v_mfma_f32_16x16x32_bf16 v[40:43], v[248:251], a[176:179], v[40:43]
  v_lshlrev_b32 v226, 16, v92
  v_mfma_f32_16x16x32_bf16 v[44:47], v[248:251], a[180:183], v[44:47]
  v_and_b32 v227, s65, v92
  v_mfma_f32_16x16x32_bf16 v[44:47], v[244:247], a[160:163], v[44:47]
  s_add_u32 s16, s23, s91
  s_addc_u32 s17, s54, 0
  v_sub_f32 v226, v226, v220
  v_mfma_f32_16x16x32_bf16 v[44:47], v[240:243], a[140:143], v[44:47]
  s_waitcnt vmcnt(15)
  v_sub_f32 v227, v227, v220
  v_mfma_f32_16x16x32_bf16 v[48:51], v[240:243], a[144:147], v[48:51]
  s_barrier
  v_mfma_f32_16x16x32_bf16 v[48:51], v[244:247], a[164:167], v[48:51]
  s_add_u32 m0, s21, 57344
  ds_read_b64_tr_b16 v[28:29], v2 offset:49152
  ds_read_b64_tr_b16 v[30:31], v2 offset:49664
  v_mfma_f32_16x16x32_bf16 v[48:51], v[248:251], a[184:187], v[48:51]
  buffer_load_dwordx4 v90, s[16:19], s72 offen offset:0 lds
  v_mfma_f32_16x16x32_bf16 v[52:55], v[248:251], a[188:191], v[52:55]
  ds_read_b64_tr_b16 v[32:33], v2 offset:50176
  ds_read_b64_tr_b16 v[34:35], v2 offset:50688
  v_mfma_f32_16x16x32_bf16 v[52:55], v[244:247], a[168:171], v[52:55]
  ds_read_b64_tr_b16 v[36:37], v2 offset:51200
  ds_read_b64_tr_b16 v[38:39], v2 offset:51712
  v_mfma_f32_16x16x32_bf16 v[52:55], v[240:243], a[148:151], v[52:55]
  buffer_load_dwordx4 v90, s[16:19], s73 offen offset:1024 lds
  v_mfma_f32_16x16x32_bf16 v[56:59], v[240:243], a[152:155], v[56:59]
  v_cvt_pk_bf16_f32 v227, v226, v227
  v_mfma_f32_16x16x32_bf16 v[56:59], v[244:247], a[172:175], v[56:59]
  v_lshlrev_b32 v226, 16, v227
  v_and_b32 v227, s65, v227
  v_mfma_f32_16x16x32_bf16 v[56:59], v[248:251], a[192:195], v[56:59]
  s_waitcnt lgkmcnt(2)
  v_mul_f32 v226, v4, v226
  v_mfma_f32_16x16x32_bf16 v[56:59], v[28:31], a[212:215], v[56:59]
  v_mul_f32 v227, v4, v227
  v_mfma_f32_16x16x32_bf16 v[56:59], v[32:35], a[232:235], v[56:59]
  s_waitcnt lgkmcnt(0)
  buffer_load_dwordx4 v90, s[16:19], s74 offen offset:2048 lds
  v_mfma_f32_16x16x32_bf16 v[76:79], v[36:39], a[252:255], v[56:59]
  v_cvt_pk_bf16_f32 v104, v226, v227
  v_mfma_f32_16x16x32_bf16 v[52:55], v[36:39], a[248:251], v[52:55]
  v_lshlrev_b32 v228, 16, v93
  v_mfma_f32_16x16x32_bf16 v[52:55], v[32:35], a[228:231], v[52:55]
  v_and_b32 v229, s65, v93
  v_sub_f32 v228, v228, v220
  v_mfma_f32_16x16x32_bf16 v[72:75], v[28:31], a[208:211], v[52:55]
  s_add_u32 m0, s21, 32768
  ds_read_b64_tr_b16 v[240:241], v3 offset:0
  ds_read_b64_tr_b16 v[242:243], v3 offset:512
  v_mfma_f32_16x16x32_bf16 v[48:51], v[28:31], a[204:207], v[48:51]
  buffer_load_dwordx4 v90, s[16:19], s75 offen offset:0 lds
  v_mfma_f32_16x16x32_bf16 v[48:51], v[32:35], a[224:227], v[48:51]
  ds_read_b64_tr_b16 v[244:245], v3 offset:1024
  ds_read_b64_tr_b16 v[246:247], v3 offset:1536
  v_mfma_f32_16x16x32_bf16 v[68:71], v[36:39], a[244:247], v[48:51]
  v_sub_f32 v229, v229, v220
  v_mfma_f32_16x16x32_bf16 v[44:47], v[36:39], a[240:243], v[44:47]
  v_cvt_pk_bf16_f32 v229, v228, v229
  v_mfma_f32_16x16x32_bf16 v[44:47], v[32:35], a[220:223], v[44:47]
  ds_read_b64_tr_b16 v[248:249], v3 offset:2048
  ds_read_b64_tr_b16 v[250:251], v3 offset:2560
  v_mfma_f32_16x16x32_bf16 v[64:67], v[28:31], a[200:203], v[44:47]
  buffer_load_dwordx4 v91, s[16:19], s76 offen offset:1024 lds
  v_mfma_f32_16x16x32_bf16 v[40:43], v[28:31], a[196:199], v[40:43]
  v_lshlrev_b32 v228, 16, v229
  v_mfma_f32_16x16x32_bf16 v[40:43], v[32:35], a[216:219], v[40:43]
  v_and_b32 v229, s65, v229
  v_mfma_f32_16x16x32_bf16 v[60:63], v[36:39], a[236:239], v[40:43]
  s_waitcnt lgkmcnt(2)
  v_mul_f32 v228, v4, v228
  v_mfma_f32_16x16x32_bf16 v[40:43], v[240:243], v[116:119], 0
  v_mfma_f32_16x16x32_bf16 v[40:43], v[244:247], v[136:139], v[40:43]
  s_waitcnt lgkmcnt(0)
  buffer_load_dwordx4 v91, s[16:19], s77 offen offset:2048 lds
  v_mfma_f32_16x16x32_bf16 v[40:43], v[248:251], v[156:159], v[40:43]
  s_mov_b32 s25, 40960
  v_cvt_pk_bf16_f32 v88, v76, v77
  v_cvt_pk_bf16_f32 v89, v78, v79
  v_mfma_f32_16x16x32_bf16 v[44:47], v[248:251], v[160:163], 0
  v_cvt_pk_bf16_f32 v86, v72, v73
  v_cvt_pk_bf16_f32 v87, v74, v75
  v_mfma_f32_16x16x32_bf16 v[44:47], v[244:247], v[140:143], v[44:47]
  v_cvt_pk_bf16_f32 v84, v68, v69
  v_cvt_pk_bf16_f32 v85, v70, v71
  v_mfma_f32_16x16x32_bf16 v[44:47], v[240:243], v[120:123], v[44:47]
  s_add_u32 m0, s21, 45056
  ds_read_b64_tr_b16 v[28:29], v3 offset:12288
  ds_read_b64_tr_b16 v[30:31], v3 offset:12800
  v_mfma_f32_16x16x32_bf16 v[48:51], v[240:243], v[124:127], 0
  buffer_load_dwordx4 v91, s[16:19], s78 offen offset:0 lds
  v_mfma_f32_16x16x32_bf16 v[48:51], v[244:247], v[144:147], v[48:51]
  ds_read_b64_tr_b16 v[32:33], v3 offset:13312
  ds_read_b64_tr_b16 v[34:35], v3 offset:13824
  v_mfma_f32_16x16x32_bf16 v[48:51], v[248:251], v[164:167], v[48:51]
  v_cvt_pk_bf16_f32 v82, v64, v65
  v_cvt_pk_bf16_f32 v83, v66, v67
  v_mfma_f32_16x16x32_bf16 v[52:55], v[248:251], v[168:171], 0
  v_cvt_pk_bf16_f32 v80, v60, v61
  v_cvt_pk_bf16_f32 v81, v62, v63
  v_mfma_f32_16x16x32_bf16 v[52:55], v[244:247], v[148:151], v[52:55]
  ds_read_b64_tr_b16 v[36:37], v3 offset:14336
  ds_read_b64_tr_b16 v[38:39], v3 offset:14848
  v_mfma_f32_16x16x32_bf16 v[52:55], v[240:243], v[128:131], v[52:55]
  buffer_load_dwordx4 v91, s[16:19], s79 offen offset:1024 lds
  v_mfma_f32_16x16x32_bf16 v[56:59], v[240:243], v[132:135], 0
  v_mul_f32 v229, v4, v229
  v_cvt_pk_bf16_f32 v105, v228, v229
  v_mfma_f32_16x16x32_bf16 v[56:59], v[244:247], v[152:155], v[56:59]
  v_lshlrev_b32 v226, 16, v94
  v_mfma_f32_16x16x32_bf16 v[56:59], v[248:251], v[172:175], v[56:59]
  s_waitcnt lgkmcnt(2)
  v_and_b32 v227, s65, v94
  v_mfma_f32_16x16x32_bf16 v[56:59], v[28:31], v[192:195], v[56:59]
  v_sub_f32 v226, v226, v221
  v_mfma_f32_16x16x32_bf16 v[56:59], v[32:35], v[212:215], v[56:59]
  s_waitcnt lgkmcnt(0)
  buffer_load_dwordx4 v27, s[16:19], s80 offen offset:2048 lds
  v_mfma_f32_16x16x32_bf16 v[56:59], v[36:39], a[12:15], v[56:59]
  v_sub_f32 v227, v227, v221
  v_cvt_pk_bf16_f32 v227, v226, v227
  v_mfma_f32_16x16x32_bf16 v[52:55], v[36:39], a[8:11], v[52:55]
  v_lshlrev_b32 v226, 16, v227
  v_mfma_f32_16x16x32_bf16 v[52:55], v[32:35], v[208:211], v[52:55]
  v_and_b32 v227, s65, v227
  v_mfma_f32_16x16x32_bf16 v[52:55], v[28:31], v[188:191], v[52:55]
  s_waitcnt vmcnt(12)
  v_mul_f32 v226, v5, v226
  v_mfma_f32_16x16x32_bf16 v[48:51], v[28:31], v[184:187], v[48:51]
  s_barrier
  v_mfma_f32_16x16x32_bf16 v[48:51], v[32:35], v[204:207], v[48:51]
  s_add_u32 m0, s21, 81920
  ds_read_b64_tr_b16 v[240:241], v3 offset:24576
  ds_read_b64_tr_b16 v[242:243], v3 offset:25088
  v_mfma_f32_16x16x32_bf16 v[48:51], v[36:39], a[4:7], v[48:51]
  buffer_load_dwordx4 v27, s[16:19], s81 offen offset:0 lds
  v_mfma_f32_16x16x32_bf16 v[44:47], v[36:39], a[0:3], v[44:47]
  ds_read_b64_tr_b16 v[244:245], v3 offset:25600
  ds_read_b64_tr_b16 v[246:247], v3 offset:26112
  v_mfma_f32_16x16x32_bf16 v[44:47], v[32:35], v[200:203], v[44:47]
  ds_read_b64_tr_b16 v[248:249], v3 offset:26624
  ds_read_b64_tr_b16 v[250:251], v3 offset:27136
  v_mfma_f32_16x16x32_bf16 v[44:47], v[28:31], v[180:183], v[44:47]
  buffer_load_dwordx4 v27, s[16:19], s82 offen offset:1024 lds
  v_mfma_f32_16x16x32_bf16 v[40:43], v[28:31], v[176:179], v[40:43]
  v_mul_f32 v227, v5, v227
  v_mfma_f32_16x16x32_bf16 v[40:43], v[32:35], v[196:199], v[40:43]
  buffer_store_dwordx4 v[80:83], v13, s[12:15], s25 offen sc1
  v_mfma_f32_16x16x32_bf16 v[40:43], v[36:39], v[216:219], v[40:43]
  s_waitcnt lgkmcnt(2)
  v_cvt_pk_bf16_f32 v106, v226, v227
  v_lshlrev_b32 v228, 16, v95
  v_mfma_f32_16x16x32_bf16 v[40:43], v[240:243], a[16:19], v[40:43]
L_fw4:
  s_cbranch_execz L_ffn_ret
  v_and_b32 v229, s65, v95
  v_mfma_f32_16x16x32_bf16 v[40:43], v[244:247], a[36:39], v[40:43]
  s_waitcnt lgkmcnt(0)
  buffer_load_dwordx4 v27, s[16:19], s83 offen offset:2048 lds
  v_mfma_f32_16x16x32_bf16 v[40:43], v[248:251], a[56:59], v[40:43]
  v_sub_f32 v228, v228, v221
  v_mfma_f32_16x16x32_bf16 v[44:47], v[248:251], a[60:63], v[44:47]
  buffer_store_dwordx4 v[84:87], v13, s[12:15], s25 offen offset:1024 sc1
  v_mfma_f32_16x16x32_bf16 v[44:47], v[244:247], a[40:43], v[44:47]
  v_sub_f32 v229, v229, v221
  v_mfma_f32_16x16x32_bf16 v[44:47], v[240:243], a[20:23], v[44:47]
  s_add_u32 m0, s21, 94208
  ds_read_b64_tr_b16 v[28:29], v2 offset:36864
  ds_read_b64_tr_b16 v[30:31], v2 offset:37376
  v_mfma_f32_16x16x32_bf16 v[48:51], v[240:243], a[24:27], v[48:51]
  buffer_load_dwordx4 v254, s[16:19], s84 offen offset:0 lds
  v_mfma_f32_16x16x32_bf16 v[48:51], v[244:247], a[44:47], v[48:51]
  ds_read_b64_tr_b16 v[32:33], v2 offset:37888
  ds_read_b64_tr_b16 v[34:35], v2 offset:38400
  v_mfma_f32_16x16x32_bf16 v[48:51], v[248:251], a[64:67], v[48:51]
  buffer_store_dwordx2 v[88:89], v14, s[12:15], s25 offen offset:2048 sc1
  v_mfma_f32_16x16x32_bf16 v[52:55], v[248:251], a[68:71], v[52:55]
  v_cvt_pk_bf16_f32 v229, v228, v229
  v_mfma_f32_16x16x32_bf16 v[52:55], v[244:247], a[48:51], v[52:55]
  ds_read_b64_tr_b16 v[36:37], v2 offset:38912
  ds_read_b64_tr_b16 v[38:39], v2 offset:39424
  v_mfma_f32_16x16x32_bf16 v[52:55], v[240:243], a[28:31], v[52:55]
  buffer_load_dwordx4 v254, s[16:19], s85 offen offset:1024 lds
  v_mfma_f32_16x16x32_bf16 v[56:59], v[240:243], a[32:35], v[56:59]
  v_lshlrev_b32 v228, 16, v229
  v_and_b32 v229, s65, v229
  v_mfma_f32_16x16x32_bf16 v[56:59], v[244:247], a[52:55], v[56:59]
  buffer_store_dword v16, v15, s[44:47], 0 offen offset:0 sc1
  v_mfma_f32_16x16x32_bf16 v[56:59], v[248:251], a[72:75], v[56:59]
  s_waitcnt lgkmcnt(2)
  v_mul_f32 v228, v5, v228
  v_mfma_f32_16x16x32_bf16 v[56:59], v[28:31], a[92:95], v[56:59]
  v_mul_f32 v229, v5, v229
  v_mfma_f32_16x16x32_bf16 v[56:59], v[32:35], a[112:115], v[56:59]
  s_waitcnt lgkmcnt(0)
  buffer_load_dwordx4 v254, s[16:19], s86 offen offset:2048 lds
  v_mfma_f32_16x16x32_bf16 v[56:59], v[36:39], a[132:135], v[56:59]
  v_cvt_pk_bf16_f32 v107, v228, v229
  v_mfma_f32_16x16x32_bf16 v[52:55], v[36:39], a[128:131], v[52:55]
  v_lshlrev_b32 v226, 16, v96
  v_and_b32 v227, s65, v96
  v_mfma_f32_16x16x32_bf16 v[52:55], v[32:35], a[108:111], v[52:55]
  v_sub_f32 v226, v226, v222
  v_mfma_f32_16x16x32_bf16 v[52:55], v[28:31], a[88:91], v[52:55]
  s_add_u32 m0, s21, 106496
  ds_read_b64_tr_b16 v[240:241], v3 offset:36864
  ds_read_b64_tr_b16 v[242:243], v3 offset:37376
  v_mfma_f32_16x16x32_bf16 v[48:51], v[28:31], a[84:87], v[48:51]
  s_xor_b32 s91, s91, 128
  buffer_load_dwordx4 v254, s[16:19], s87 offen offset:0 lds
  v_mfma_f32_16x16x32_bf16 v[48:51], v[32:35], a[104:107], v[48:51]
  ds_read_b64_tr_b16 v[244:245], v3 offset:37888
  ds_read_b64_tr_b16 v[246:247], v3 offset:38400
  v_mfma_f32_16x16x32_bf16 v[48:51], v[36:39], a[124:127], v[48:51]
  v_sub_f32 v227, v227, v222
  v_mfma_f32_16x16x32_bf16 v[44:47], v[36:39], a[120:123], v[44:47]
  v_cvt_pk_bf16_f32 v227, v226, v227
  v_mfma_f32_16x16x32_bf16 v[44:47], v[32:35], a[100:103], v[44:47]
  ds_read_b64_tr_b16 v[248:249], v3 offset:38912
  ds_read_b64_tr_b16 v[250:251], v3 offset:39424
  v_mfma_f32_16x16x32_bf16 v[44:47], v[28:31], a[80:83], v[44:47]
  buffer_load_dwordx4 v12, s[16:19], s88 offen offset:1024 lds
  v_mfma_f32_16x16x32_bf16 v[40:43], v[28:31], a[76:79], v[40:43]
  v_lshlrev_b32 v226, 16, v227
  v_mfma_f32_16x16x32_bf16 v[40:43], v[32:35], a[96:99], v[40:43]
  v_and_b32 v227, s65, v227
  v_mul_f32 v226, v10, v226
  v_mfma_f32_16x16x32_bf16 v[40:43], v[36:39], a[116:119], v[40:43]
  s_waitcnt lgkmcnt(2)
  v_mul_f32 v227, v10, v227
  v_mfma_f32_16x16x32_bf16 v[40:43], v[240:243], a[136:139], v[40:43]
  v_cvt_pk_bf16_f32 v108, v226, v227
  v_mfma_f32_16x16x32_bf16 v[40:43], v[244:247], a[156:159], v[40:43]
  s_waitcnt lgkmcnt(0)
  buffer_load_dwordx4 v12, s[16:19], s89 offen offset:2048 lds
  v_mfma_f32_16x16x32_bf16 v[40:43], v[248:251], a[176:179], v[40:43]
  v_lshlrev_b32 v228, 16, v97
  v_mfma_f32_16x16x32_bf16 v[44:47], v[248:251], a[180:183], v[44:47]
  v_and_b32 v229, s65, v97
  v_mfma_f32_16x16x32_bf16 v[44:47], v[244:247], a[160:163], v[44:47]
  s_add_u32 s16, s23, s91
  s_addc_u32 s17, s54, 0
  v_sub_f32 v228, v228, v222
  v_sub_f32 v229, v229, v222
  v_mfma_f32_16x16x32_bf16 v[44:47], v[240:243], a[140:143], v[44:47]
  s_waitcnt vmcnt(16)
  v_cvt_pk_bf16_f32 v229, v228, v229
  v_mfma_f32_16x16x32_bf16 v[48:51], v[240:243], a[144:147], v[48:51]
  s_barrier
  v_mfma_f32_16x16x32_bf16 v[48:51], v[244:247], a[164:167], v[48:51]
  s_add_u32 m0, s21, 118784
  ds_read_b64_tr_b16 v[28:29], v3 offset:49152
  ds_read_b64_tr_b16 v[30:31], v3 offset:49664
  v_mfma_f32_16x16x32_bf16 v[48:51], v[248:251], a[184:187], v[48:51]
  buffer_load_dwordx4 v90, s[16:19], s72 offen offset:0 lds
  v_mfma_f32_16x16x32_bf16 v[52:55], v[248:251], a[188:191], v[52:55]
  ds_read_b64_tr_b16 v[32:33], v3 offset:50176
  ds_read_b64_tr_b16 v[34:35], v3 offset:50688
  v_mfma_f32_16x16x32_bf16 v[52:55], v[244:247], a[168:171], v[52:55]
  ds_read_b64_tr_b16 v[36:37], v3 offset:51200
  ds_read_b64_tr_b16 v[38:39], v3 offset:51712
  v_mfma_f32_16x16x32_bf16 v[52:55], v[240:243], a[148:151], v[52:55]
  buffer_load_dwordx4 v90, s[16:19], s73 offen offset:1024 lds
  v_mfma_f32_16x16x32_bf16 v[56:59], v[240:243], a[152:155], v[56:59]
  v_lshlrev_b32 v228, 16, v229
  v_mfma_f32_16x16x32_bf16 v[56:59], v[244:247], a[172:175], v[56:59]
  v_and_b32 v229, s65, v229
  v_mfma_f32_16x16x32_bf16 v[56:59], v[248:251], a[192:195], v[56:59]
  s_waitcnt lgkmcnt(2)
  v_mul_f32 v228, v10, v228
  v_mul_f32 v229, v10, v229
  v_mfma_f32_16x16x32_bf16 v[56:59], v[28:31], a[212:215], v[56:59]
  v_cvt_pk_bf16_f32 v109, v228, v229
  v_mfma_f32_16x16x32_bf16 v[56:59], v[32:35], a[232:235], v[56:59]
  s_waitcnt lgkmcnt(0)
  buffer_load_dwordx4 v90, s[16:19], s74 offen offset:2048 lds
  v_mfma_f32_16x16x32_bf16 v[76:79], v[36:39], a[252:255], v[56:59]
  v_lshlrev_b32 v226, 16, v98
  v_mfma_f32_16x16x32_bf16 v[52:55], v[36:39], a[248:251], v[52:55]
  v_and_b32 v227, s65, v98
  v_mfma_f32_16x16x32_bf16 v[52:55], v[32:35], a[228:231], v[52:55]
  v_sub_f32 v226, v226, v223
  v_mfma_f32_16x16x32_bf16 v[72:75], v[28:31], a[208:211], v[52:55]
  s_add_u32 m0, s21, 69632
  ds_read_b64_tr_b16 v[240:241], v2 offset:24576
  ds_read_b64_tr_b16 v[242:243], v2 offset:25088
  v_mfma_f32_16x16x32_bf16 v[48:51], v[28:31], a[204:207], v[48:51]
  buffer_load_dwordx4 v90, s[16:19], s75 offen offset:0 lds
  v_mfma_f32_16x16x32_bf16 v[48:51], v[32:35], a[224:227], v[48:51]
  ds_read_b64_tr_b16 v[244:245], v2 offset:25600
  ds_read_b64_tr_b16 v[246:247], v2 offset:26112
  v_mfma_f32_16x16x32_bf16 v[68:71], v[36:39], a[244:247], v[48:51]
  v_sub_f32 v227, v227, v223
  v_cvt_pk_bf16_f32 v227, v226, v227
  v_mfma_f32_16x16x32_bf16 v[44:47], v[36:39], a[240:243], v[44:47]
  v_lshlrev_b32 v226, 16, v227
  v_mfma_f32_16x16x32_bf16 v[44:47], v[32:35], a[220:223], v[44:47]
  ds_read_b64_tr_b16 v[248:249], v2 offset:26624
  ds_read_b64_tr_b16 v[250:251], v2 offset:27136
  v_mfma_f32_16x16x32_bf16 v[64:67], v[28:31], a[200:203], v[44:47]
  buffer_load_dwordx4 v91, s[16:19], s76 offen offset:1024 lds
  v_mfma_f32_16x16x32_bf16 v[40:43], v[28:31], a[196:199], v[40:43]
  v_and_b32 v227, s65, v227
  v_mfma_f32_16x16x32_bf16 v[40:43], v[32:35], a[216:219], v[40:43]
  v_mul_f32 v226, v11, v226
  v_mfma_f32_16x16x32_bf16 v[60:63], v[36:39], a[236:239], v[40:43]
  s_waitcnt lgkmcnt(2)
  v_mul_f32 v227, v11, v227
  v_mfma_f32_16x16x32_bf16 v[40:43], v[240:243], v[116:119], 0
  v_mfma_f32_16x16x32_bf16 v[40:43], v[244:247], v[136:139], v[40:43]
  s_waitcnt lgkmcnt(0)
  buffer_load_dwordx4 v91, s[16:19], s77 offen offset:2048 lds
  v_mfma_f32_16x16x32_bf16 v[40:43], v[248:251], v[156:159], v[40:43]
  s_mov_b32 s25, 51200
  v_cvt_pk_bf16_f32 v88, v76, v77
  v_cvt_pk_bf16_f32 v89, v78, v79
  v_mfma_f32_16x16x32_bf16 v[44:47], v[248:251], v[160:163], 0
  v_cvt_pk_bf16_f32 v86, v72, v73
  v_cvt_pk_bf16_f32 v87, v74, v75
  v_mfma_f32_16x16x32_bf16 v[44:47], v[244:247], v[140:143], v[44:47]
  v_cvt_pk_bf16_f32 v84, v68, v69
  v_cvt_pk_bf16_f32 v85, v70, v71
  v_mfma_f32_16x16x32_bf16 v[44:47], v[240:243], v[120:123], v[44:47]
  s_add_u32 m0, s21, 131072
  ds_read_b64_tr_b16 v[28:29], v2 offset:0
  ds_read_b64_tr_b16 v[30:31], v2 offset:512
  v_mfma_f32_16x16x32_bf16 v[48:51], v[240:243], v[124:127], 0
  buffer_load_dwordx4 v91, s[16:19], s78 offen offset:0 lds
  v_mfma_f32_16x16x32_bf16 v[48:51], v[244:247], v[144:147], v[48:51]
  ds_read_b64_tr_b16 v[32:33], v2 offset:1024
  ds_read_b64_tr_b16 v[34:35], v2 offset:1536
  v_mfma_f32_16x16x32_bf16 v[48:51], v[248:251], v[164:167], v[48:51]
  v_cvt_pk_bf16_f32 v82, v64, v65
  v_cvt_pk_bf16_f32 v83, v66, v67
  v_mfma_f32_16x16x32_bf16 v[52:55], v[248:251], v[168:171], 0
  v_cvt_pk_bf16_f32 v80, v60, v61
  v_cvt_pk_bf16_f32 v81, v62, v63
  v_mfma_f32_16x16x32_bf16 v[52:55], v[244:247], v[148:151], v[52:55]
  ds_read_b64_tr_b16 v[36:37], v2 offset:2048
  ds_read_b64_tr_b16 v[38:39], v2 offset:2560
  v_mfma_f32_16x16x32_bf16 v[52:55], v[240:243], v[128:131], v[52:55]
  buffer_load_dwordx4 v91, s[16:19], s79 offen offset:1024 lds
  v_mfma_f32_16x16x32_bf16 v[56:59], v[240:243], v[132:135], 0
  v_cvt_pk_bf16_f32 v110, v226, v227
  v_lshlrev_b32 v228, 16, v99
  v_mfma_f32_16x16x32_bf16 v[56:59], v[244:247], v[152:155], v[56:59]
  v_and_b32 v229, s65, v99
  v_mfma_f32_16x16x32_bf16 v[56:59], v[248:251], v[172:175], v[56:59]
  s_waitcnt lgkmcnt(2)
  v_sub_f32 v228, v228, v223
  v_mfma_f32_16x16x32_bf16 v[56:59], v[28:31], v[192:195], v[56:59]
  v_sub_f32 v229, v229, v223
  v_mfma_f32_16x16x32_bf16 v[56:59], v[32:35], v[212:215], v[56:59]
  s_waitcnt lgkmcnt(0)
  buffer_load_dwordx4 v27, s[16:19], s80 offen offset:2048 lds
  v_mfma_f32_16x16x32_bf16 v[56:59], v[36:39], a[12:15], v[56:59]
  v_cvt_pk_bf16_f32 v229, v228, v229
  v_lshlrev_b32 v228, 16, v229
  v_mfma_f32_16x16x32_bf16 v[52:55], v[36:39], a[8:11], v[52:55]
  v_and_b32 v229, s65, v229
  v_mfma_f32_16x16x32_bf16 v[52:55], v[32:35], v[208:211], v[52:55]
  v_mul_f32 v228, v11, v228
  v_mfma_f32_16x16x32_bf16 v[52:55], v[28:31], v[188:191], v[52:55]
  s_waitcnt vmcnt(12)
  v_mul_f32 v229, v11, v229
  v_mfma_f32_16x16x32_bf16 v[48:51], v[28:31], v[184:187], v[48:51]
  s_barrier
  v_mfma_f32_16x16x32_bf16 v[48:51], v[32:35], v[204:207], v[48:51]
  s_add_u32 m0, s21, 143360
  ds_read_b64_tr_b16 v[240:241], v2 offset:12288
  ds_read_b64_tr_b16 v[242:243], v2 offset:12800
  v_mfma_f32_16x16x32_bf16 v[48:51], v[36:39], a[4:7], v[48:51]
  buffer_load_dwordx4 v27, s[16:19], s81 offen offset:0 lds
  v_mfma_f32_16x16x32_bf16 v[44:47], v[36:39], a[0:3], v[44:47]
  ds_read_b64_tr_b16 v[244:245], v2 offset:13312
  ds_read_b64_tr_b16 v[246:247], v2 offset:13824
  v_mfma_f32_16x16x32_bf16 v[44:47], v[32:35], v[200:203], v[44:47]
  ds_read_b64_tr_b16 v[248:249], v2 offset:14336
  ds_read_b64_tr_b16 v[250:251], v2 offset:14848
  v_mfma_f32_16x16x32_bf16 v[44:47], v[28:31], v[180:183], v[44:47]
  buffer_load_dwordx4 v27, s[16:19], s82 offen offset:1024 lds
  v_mfma_f32_16x16x32_bf16 v[40:43], v[28:31], v[176:179], v[40:43]
  v_cvt_pk_bf16_f32 v111, v228, v229
  v_mfma_f32_16x16x32_bf16 v[40:43], v[32:35], v[196:199], v[40:43]
  buffer_store_dwordx4 v[80:83], v13, s[12:15], s25 offen sc1
  v_mfma_f32_16x16x32_bf16 v[40:43], v[36:39], v[216:219], v[40:43]
  s_waitcnt lgkmcnt(2)
  v_lshlrev_b32 v226, 16, v100
  v_and_b32 v227, s65, v100
  v_mfma_f32_16x16x32_bf16 v[40:43], v[240:243], a[16:19], v[40:43]
  v_sub_f32 v226, v226, v224
  v_mfma_f32_16x16x32_bf16 v[40:43], v[244:247], a[36:39], v[40:43]
  s_waitcnt lgkmcnt(0)
  buffer_load_dwordx4 v27, s[16:19], s83 offen offset:2048 lds
  v_mfma_f32_16x16x32_bf16 v[40:43], v[248:251], a[56:59], v[40:43]
  v_sub_f32 v227, v227, v224
  v_mfma_f32_16x16x32_bf16 v[44:47], v[248:251], a[60:63], v[44:47]
  buffer_store_dwordx4 v[84:87], v13, s[12:15], s25 offen offset:1024 sc1
  v_mfma_f32_16x16x32_bf16 v[44:47], v[244:247], a[40:43], v[44:47]
  v_cvt_pk_bf16_f32 v227, v226, v227
  v_mfma_f32_16x16x32_bf16 v[44:47], v[240:243], a[20:23], v[44:47]
  s_add_u32 m0, s21, 57344
  ds_read_b64_tr_b16 v[28:29], v2 offset:49152
  ds_read_b64_tr_b16 v[30:31], v2 offset:49664
  v_mfma_f32_16x16x32_bf16 v[48:51], v[240:243], a[24:27], v[48:51]
  buffer_load_dwordx4 v254, s[16:19], s84 offen offset:0 lds
  v_mfma_f32_16x16x32_bf16 v[48:51], v[244:247], a[44:47], v[48:51]
  ds_read_b64_tr_b16 v[32:33], v2 offset:50176
  ds_read_b64_tr_b16 v[34:35], v2 offset:50688
  v_mfma_f32_16x16x32_bf16 v[48:51], v[248:251], a[64:67], v[48:51]
  buffer_store_dwordx2 v[88:89], v14, s[12:15], s25 offen offset:2048 sc1
  v_mfma_f32_16x16x32_bf16 v[52:55], v[248:251], a[68:71], v[52:55]
  v_lshlrev_b32 v226, 16, v227
  v_mfma_f32_16x16x32_bf16 v[52:55], v[244:247], a[48:51], v[52:55]
  ds_read_b64_tr_b16 v[36:37], v2 offset:51200
  ds_read_b64_tr_b16 v[38:39], v2 offset:51712
  v_mfma_f32_16x16x32_bf16 v[52:55], v[240:243], a[28:31], v[52:55]
  buffer_load_dwordx4 v254, s[16:19], s85 offen offset:1024 lds
  v_mfma_f32_16x16x32_bf16 v[56:59], v[240:243], a[32:35], v[56:59]
  v_and_b32 v227, s65, v227
  v_mul_f32 v226, v20, v226
  v_mfma_f32_16x16x32_bf16 v[56:59], v[244:247], a[52:55], v[56:59]
  v_mul_f32 v227, v20, v227
  v_mfma_f32_16x16x32_bf16 v[56:59], v[248:251], a[72:75], v[56:59]
  s_waitcnt lgkmcnt(2)
  v_cvt_pk_bf16_f32 v112, v226, v227
  v_mfma_f32_16x16x32_bf16 v[56:59], v[28:31], a[92:95], v[56:59]
  v_lshlrev_b32 v228, 16, v101
  v_mfma_f32_16x16x32_bf16 v[56:59], v[32:35], a[112:115], v[56:59]
  s_waitcnt lgkmcnt(0)
  buffer_load_dwordx4 v254, s[16:19], s86 offen offset:2048 lds
  v_mfma_f32_16x16x32_bf16 v[56:59], v[36:39], a[132:135], v[56:59]
  v_and_b32 v229, s65, v101
  v_sub_f32 v228, v228, v224
  v_mfma_f32_16x16x32_bf16 v[52:55], v[36:39], a[128:131], v[52:55]
  v_sub_f32 v229, v229, v224
  v_mfma_f32_16x16x32_bf16 v[52:55], v[32:35], a[108:111], v[52:55]
  v_cvt_pk_bf16_f32 v229, v228, v229
  v_mfma_f32_16x16x32_bf16 v[52:55], v[28:31], a[88:91], v[52:55]
  s_add_u32 m0, s21, 32768
  ds_read_b64_tr_b16 v[240:241], v3 offset:0
  ds_read_b64_tr_b16 v[242:243], v3 offset:512
  v_mfma_f32_16x16x32_bf16 v[48:51], v[28:31], a[84:87], v[48:51]
  s_xor_b32 s91, s91, 896
  buffer_load_dwordx4 v254, s[16:19], s87 offen offset:0 lds
  v_mfma_f32_16x16x32_bf16 v[48:51], v[32:35], a[104:107], v[48:51]
  ds_read_b64_tr_b16 v[244:245], v3 offset:1024
  ds_read_b64_tr_b16 v[246:247], v3 offset:1536
  v_mfma_f32_16x16x32_bf16 v[48:51], v[36:39], a[124:127], v[48:51]
  v_lshlrev_b32 v228, 16, v229
  v_mfma_f32_16x16x32_bf16 v[44:47], v[36:39], a[120:123], v[44:47]
  v_and_b32 v229, s65, v229
  v_mfma_f32_16x16x32_bf16 v[44:47], v[32:35], a[100:103], v[44:47]
  ds_read_b64_tr_b16 v[248:249], v3 offset:2048
  ds_read_b64_tr_b16 v[250:251], v3 offset:2560
  v_mfma_f32_16x16x32_bf16 v[44:47], v[28:31], a[80:83], v[44:47]
  buffer_load_dwordx4 v12, s[16:19], s88 offen offset:1024 lds
  v_mfma_f32_16x16x32_bf16 v[40:43], v[28:31], a[76:79], v[40:43]
  v_mul_f32 v228, v20, v228
  v_mul_f32 v229, v20, v229
  v_mfma_f32_16x16x32_bf16 v[40:43], v[32:35], a[96:99], v[40:43]
  v_cvt_pk_bf16_f32 v113, v228, v229
  v_mfma_f32_16x16x32_bf16 v[40:43], v[36:39], a[116:119], v[40:43]
  s_waitcnt lgkmcnt(2)
  v_lshlrev_b32 v226, 16, v102
  v_mfma_f32_16x16x32_bf16 v[40:43], v[240:243], a[136:139], v[40:43]
  v_and_b32 v227, s65, v102
  v_mfma_f32_16x16x32_bf16 v[40:43], v[244:247], a[156:159], v[40:43]
  s_waitcnt lgkmcnt(0)
  buffer_load_dwordx4 v12, s[16:19], s89 offen offset:2048 lds
  v_mfma_f32_16x16x32_bf16 v[40:43], v[248:251], a[176:179], v[40:43]
  v_sub_f32 v226, v226, v225
  v_mfma_f32_16x16x32_bf16 v[44:47], v[248:251], a[180:183], v[44:47]
  v_sub_f32 v227, v227, v225
  v_cvt_pk_bf16_f32 v227, v226, v227
  v_mfma_f32_16x16x32_bf16 v[44:47], v[244:247], a[160:163], v[44:47]
  s_add_u32 s16, s23, s91
  s_addc_u32 s17, s54, 0
  v_lshlrev_b32 v226, 16, v227
  v_mfma_f32_16x16x32_bf16 v[44:47], v[240:243], a[140:143], v[44:47]
  s_waitcnt vmcnt(15)
  v_and_b32 v227, s65, v227
  v_mfma_f32_16x16x32_bf16 v[48:51], v[240:243], a[144:147], v[48:51]
  s_barrier
  v_mfma_f32_16x16x32_bf16 v[48:51], v[244:247], a[164:167], v[48:51]
  s_add_u32 m0, s21, 45056
  ds_read_b64_tr_b16 v[28:29], v3 offset:12288
  ds_read_b64_tr_b16 v[30:31], v3 offset:12800
  v_mfma_f32_16x16x32_bf16 v[48:51], v[248:251], a[184:187], v[48:51]
  buffer_load_dwordx4 v90, s[16:19], s72 offen offset:0 lds
  v_mfma_f32_16x16x32_bf16 v[52:55], v[248:251], a[188:191], v[52:55]
  ds_read_b64_tr_b16 v[32:33], v3 offset:13312
  ds_read_b64_tr_b16 v[34:35], v3 offset:13824
  v_mfma_f32_16x16x32_bf16 v[52:55], v[244:247], a[168:171], v[52:55]
  ds_read_b64_tr_b16 v[36:37], v3 offset:14336
  ds_read_b64_tr_b16 v[38:39], v3 offset:14848
  v_mfma_f32_16x16x32_bf16 v[52:55], v[240:243], a[148:151], v[52:55]
  buffer_load_dwordx4 v90, s[16:19], s73 offen offset:1024 lds
  v_mfma_f32_16x16x32_bf16 v[56:59], v[240:243], a[152:155], v[56:59]
  v_mul_f32 v226, v26, v226
  v_mfma_f32_16x16x32_bf16 v[56:59], v[244:247], a[172:175], v[56:59]
  buffer_load_dword v6, v8, s[44:47], 0 offen offset:0 sc1
  v_mfma_f32_16x16x32_bf16 v[56:59], v[248:251], a[192:195], v[56:59]
  s_waitcnt lgkmcnt(2)
  v_mul_f32 v227, v26, v227
  v_cvt_pk_bf16_f32 v114, v226, v227
  v_mfma_f32_16x16x32_bf16 v[56:59], v[28:31], a[212:215], v[56:59]
  v_lshlrev_b32 v228, 16, v103
  v_mfma_f32_16x16x32_bf16 v[56:59], v[32:35], a[232:235], v[56:59]
  s_waitcnt lgkmcnt(0)
  buffer_load_dwordx4 v90, s[16:19], s74 offen offset:2048 lds
  v_mfma_f32_16x16x32_bf16 v[76:79], v[36:39], a[252:255], v[56:59]
  v_and_b32 v229, s65, v103
  v_mfma_f32_16x16x32_bf16 v[52:55], v[36:39], a[248:251], v[52:55]
  v_sub_f32 v228, v228, v225
  v_mfma_f32_16x16x32_bf16 v[52:55], v[32:35], a[228:231], v[52:55]
  v_sub_f32 v229, v229, v225
  v_mfma_f32_16x16x32_bf16 v[72:75], v[28:31], a[208:211], v[52:55]
  s_add_u32 m0, s21, 81920
  ds_read_b64_tr_b16 v[240:241], v3 offset:24576
  ds_read_b64_tr_b16 v[242:243], v3 offset:25088
  v_mfma_f32_16x16x32_bf16 v[48:51], v[28:31], a[204:207], v[48:51]
  buffer_load_dwordx4 v90, s[16:19], s75 offen offset:0 lds
  v_mfma_f32_16x16x32_bf16 v[48:51], v[32:35], a[224:227], v[48:51]
  ds_read_b64_tr_b16 v[244:245], v3 offset:25600
  ds_read_b64_tr_b16 v[246:247], v3 offset:26112
  v_mfma_f32_16x16x32_bf16 v[68:71], v[36:39], a[244:247], v[48:51]
  v_cvt_pk_bf16_f32 v229, v228, v229
  v_lshlrev_b32 v228, 16, v229
  v_mfma_f32_16x16x32_bf16 v[44:47], v[36:39], a[240:243], v[44:47]
  v_and_b32 v229, s65, v229
  v_mfma_f32_16x16x32_bf16 v[44:47], v[32:35], a[220:223], v[44:47]
  ds_read_b64_tr_b16 v[248:249], v3 offset:26624
  ds_read_b64_tr_b16 v[250:251], v3 offset:27136
  v_mfma_f32_16x16x32_bf16 v[64:67], v[28:31], a[200:203], v[44:47]
  buffer_load_dwordx4 v91, s[16:19], s76 offen offset:1024 lds
  v_mfma_f32_16x16x32_bf16 v[40:43], v[28:31], a[196:199], v[40:43]
  v_mul_f32 v228, v26, v228
  v_mfma_f32_16x16x32_bf16 v[40:43], v[32:35], a[216:219], v[40:43]
  v_mul_f32 v229, v26, v229
  v_mfma_f32_16x16x32_bf16 v[60:63], v[36:39], a[236:239], v[40:43]
  s_waitcnt lgkmcnt(2)
  v_cvt_pk_bf16_f32 v115, v228, v229
  v_mfma_f32_16x16x32_bf16 v[40:43], v[240:243], v[116:119], 0
  v_mfma_f32_16x16x32_bf16 v[40:43], v[244:247], v[136:139], v[40:43]
  s_waitcnt lgkmcnt(0)
  buffer_load_dwordx4 v91, s[16:19], s77 offen offset:2048 lds
  v_mfma_f32_16x16x32_bf16 v[40:43], v[248:251], v[156:159], v[40:43]
  s_mov_b32 s25, 61440
  v_cvt_pk_bf16_f32 v88, v76, v77
  v_cvt_pk_bf16_f32 v89, v78, v79
  v_mfma_f32_16x16x32_bf16 v[44:47], v[248:251], v[160:163], 0
  v_cvt_pk_bf16_f32 v86, v72, v73
  v_cvt_pk_bf16_f32 v87, v74, v75
  v_mfma_f32_16x16x32_bf16 v[44:47], v[244:247], v[140:143], v[44:47]
  v_cvt_pk_bf16_f32 v84, v68, v69
  v_cvt_pk_bf16_f32 v85, v70, v71
  v_mfma_f32_16x16x32_bf16 v[44:47], v[240:243], v[120:123], v[44:47]
  s_add_u32 m0, s21, 94208
  ds_read_b64_tr_b16 v[28:29], v2 offset:36864
  ds_read_b64_tr_b16 v[30:31], v2 offset:37376
  v_mfma_f32_16x16x32_bf16 v[48:51], v[240:243], v[124:127], 0
  buffer_load_dwordx4 v91, s[16:19], s78 offen offset:0 lds
  v_mfma_f32_16x16x32_bf16 v[48:51], v[244:247], v[144:147], v[48:51]
  ds_read_b64_tr_b16 v[32:33], v2 offset:37888
  ds_read_b64_tr_b16 v[34:35], v2 offset:38400
  v_mfma_f32_16x16x32_bf16 v[48:51], v[248:251], v[164:167], v[48:51]
  v_cvt_pk_bf16_f32 v82, v64, v65
  v_cvt_pk_bf16_f32 v83, v66, v67
  v_mfma_f32_16x16x32_bf16 v[52:55], v[248:251], v[168:171], 0
  v_cvt_pk_bf16_f32 v80, v60, v61
  v_cvt_pk_bf16_f32 v81, v62, v63
  v_mfma_f32_16x16x32_bf16 v[52:55], v[244:247], v[148:151], v[52:55]
  ds_read_b64_tr_b16 v[36:37], v2 offset:38912
  ds_read_b64_tr_b16 v[38:39], v2 offset:39424
  v_mfma_f32_16x16x32_bf16 v[52:55], v[240:243], v[128:131], v[52:55]
  buffer_load_dwordx4 v91, s[16:19], s79 offen offset:1024 lds
  v_mfma_f32_16x16x32_bf16 v[56:59], v[240:243], v[132:135], 0
  v_mfma_f32_16x16x32_bf16 v[56:59], v[244:247], v[152:155], v[56:59]
  v_mfma_f32_16x16x32_bf16 v[56:59], v[248:251], v[172:175], v[56:59]
  s_waitcnt lgkmcnt(2)
  v_mfma_f32_16x16x32_bf16 v[56:59], v[28:31], v[192:195], v[56:59]
  v_mfma_f32_16x16x32_bf16 v[56:59], v[32:35], v[212:215], v[56:59]
  s_waitcnt lgkmcnt(0)
  buffer_load_dwordx4 v27, s[16:19], s80 offen offset:2048 lds
  v_mfma_f32_16x16x32_bf16 v[56:59], v[36:39], a[12:15], v[56:59]
  v_mfma_f32_16x16x32_bf16 v[52:55], v[36:39], a[8:11], v[52:55]
  v_mfma_f32_16x16x32_bf16 v[52:55], v[32:35], v[208:211], v[52:55]
  v_mfma_f32_16x16x32_bf16 v[52:55], v[28:31], v[188:191], v[52:55]
  s_waitcnt vmcnt(13)
  v_mfma_f32_16x16x32_bf16 v[48:51], v[28:31], v[184:187], v[48:51]
  s_barrier
  v_mfma_f32_16x16x32_bf16 v[48:51], v[32:35], v[204:207], v[48:51]
  s_add_u32 m0, s21, 106496
  ds_read_b64_tr_b16 v[240:241], v3 offset:36864
  ds_read_b64_tr_b16 v[242:243], v3 offset:37376
  v_mfma_f32_16x16x32_bf16 v[48:51], v[36:39], a[4:7], v[48:51]
  buffer_load_dwordx4 v27, s[16:19], s81 offen offset:0 lds
  v_mfma_f32_16x16x32_bf16 v[44:47], v[36:39], a[0:3], v[44:47]
  ds_read_b64_tr_b16 v[244:245], v3 offset:37888
  ds_read_b64_tr_b16 v[246:247], v3 offset:38400
  v_mfma_f32_16x16x32_bf16 v[44:47], v[32:35], v[200:203], v[44:47]
  ds_read_b64_tr_b16 v[248:249], v3 offset:38912
  ds_read_b64_tr_b16 v[250:251], v3 offset:39424
  v_mfma_f32_16x16x32_bf16 v[44:47], v[28:31], v[180:183], v[44:47]
  buffer_load_dwordx4 v27, s[16:19], s82 offen offset:1024 lds
  v_mfma_f32_16x16x32_bf16 v[40:43], v[28:31], v[176:179], v[40:43]
  v_mfma_f32_16x16x32_bf16 v[40:43], v[32:35], v[196:199], v[40:43]
  buffer_store_dwordx4 v[80:83], v13, s[12:15], s25 offen sc1
  v_mfma_f32_16x16x32_bf16 v[40:43], v[36:39], v[216:219], v[40:43]
  s_waitcnt lgkmcnt(2)
  v_mfma_f32_16x16x32_bf16 v[40:43], v[240:243], a[16:19], v[40:43]
  v_mfma_f32_16x16x32_bf16 v[40:43], v[244:247], a[36:39], v[40:43]
  s_waitcnt lgkmcnt(0)
  buffer_load_dwordx4 v27, s[16:19], s83 offen offset:2048 lds
  v_mfma_f32_16x16x32_bf16 v[40:43], v[248:251], a[56:59], v[40:43]
  v_mfma_f32_16x16x32_bf16 v[44:47], v[248:251], a[60:63], v[44:47]
  buffer_store_dwordx4 v[84:87], v13, s[12:15], s25 offen offset:1024 sc1
  v_mfma_f32_16x16x32_bf16 v[44:47], v[244:247], a[40:43], v[44:47]
  v_mfma_f32_16x16x32_bf16 v[44:47], v[240:243], a[20:23], v[44:47]
  s_add_u32 m0, s21, 118784
  ds_read_b64_tr_b16 v[28:29], v3 offset:49152
  ds_read_b64_tr_b16 v[30:31], v3 offset:49664
  v_mfma_f32_16x16x32_bf16 v[48:51], v[240:243], a[24:27], v[48:51]
  buffer_load_dwordx4 v254, s[16:19], s84 offen offset:0 lds
  v_mfma_f32_16x16x32_bf16 v[48:51], v[244:247], a[44:47], v[48:51]
  ds_read_b64_tr_b16 v[32:33], v3 offset:50176
  ds_read_b64_tr_b16 v[34:35], v3 offset:50688
  v_mfma_f32_16x16x32_bf16 v[48:51], v[248:251], a[64:67], v[48:51]
  buffer_store_dwordx2 v[88:89], v14, s[12:15], s25 offen offset:2048 sc1
  v_mfma_f32_16x16x32_bf16 v[52:55], v[248:251], a[68:71], v[52:55]
  v_mfma_f32_16x16x32_bf16 v[52:55], v[244:247], a[48:51], v[52:55]
  ds_read_b64_tr_b16 v[36:37], v3 offset:51200
  ds_read_b64_tr_b16 v[38:39], v3 offset:51712
  v_mfma_f32_16x16x32_bf16 v[52:55], v[240:243], a[28:31], v[52:55]
  buffer_load_dwordx4 v254, s[16:19], s85 offen offset:1024 lds
  v_mfma_f32_16x16x32_bf16 v[56:59], v[240:243], a[32:35], v[56:59]
  v_mfma_f32_16x16x32_bf16 v[56:59], v[244:247], a[52:55], v[56:59]
  buffer_store_dword v16, v15, s[44:47], 0 offen offset:128 sc1
  v_mfma_f32_16x16x32_bf16 v[56:59], v[248:251], a[72:75], v[56:59]
  s_waitcnt lgkmcnt(2)
  v_mfma_f32_16x16x32_bf16 v[56:59], v[28:31], a[92:95], v[56:59]
  v_mfma_f32_16x16x32_bf16 v[56:59], v[32:35], a[112:115], v[56:59]
  s_waitcnt lgkmcnt(0)
  buffer_load_dwordx4 v254, s[16:19], s86 offen offset:2048 lds
  v_mfma_f32_16x16x32_bf16 v[56:59], v[36:39], a[132:135], v[56:59]
  v_mfma_f32_16x16x32_bf16 v[52:55], v[36:39], a[128:131], v[52:55]
  v_mfma_f32_16x16x32_bf16 v[52:55], v[32:35], a[108:111], v[52:55]
  v_mfma_f32_16x16x32_bf16 v[52:55], v[28:31], a[88:91], v[52:55]
  s_add_u32 m0, s21, 69632
  ds_read_b64_tr_b16 v[240:241], v2 offset:24576
  ds_read_b64_tr_b16 v[242:243], v2 offset:25088
  v_mfma_f32_16x16x32_bf16 v[48:51], v[28:31], a[84:87], v[48:51]
  buffer_load_dwordx4 v254, s[16:19], s87 offen offset:0 lds
  v_mfma_f32_16x16x32_bf16 v[48:51], v[32:35], a[104:107], v[48:51]
  ds_read_b64_tr_b16 v[244:245], v2 offset:25600
  ds_read_b64_tr_b16 v[246:247], v2 offset:26112
  v_mfma_f32_16x16x32_bf16 v[48:51], v[36:39], a[124:127], v[48:51]
  v_mfma_f32_16x16x32_bf16 v[44:47], v[36:39], a[120:123], v[44:47]
  v_mfma_f32_16x16x32_bf16 v[44:47], v[32:35], a[100:103], v[44:47]
  ds_read_b64_tr_b16 v[248:249], v2 offset:26624
  ds_read_b64_tr_b16 v[250:251], v2 offset:27136
  v_mfma_f32_16x16x32_bf16 v[44:47], v[28:31], a[80:83], v[44:47]
  buffer_load_dwordx4 v12, s[16:19], s88 offen offset:1024 lds
  v_mfma_f32_16x16x32_bf16 v[40:43], v[28:31], a[76:79], v[40:43]
  v_mfma_f32_16x16x32_bf16 v[40:43], v[32:35], a[96:99], v[40:43]
  v_mfma_f32_16x16x32_bf16 v[40:43], v[36:39], a[116:119], v[40:43]
  s_waitcnt lgkmcnt(2)
  v_mfma_f32_16x16x32_bf16 v[40:43], v[240:243], a[136:139], v[40:43]
  v_mfma_f32_16x16x32_bf16 v[40:43], v[244:247], a[156:159], v[40:43]
  s_waitcnt lgkmcnt(0)
  buffer_load_dwordx4 v12, s[16:19], s89 offen offset:2048 lds
  v_mfma_f32_16x16x32_bf16 v[40:43], v[248:251], a[176:179], v[40:43]
  s_waitcnt vmcnt(20)
  v_cmp_gt_u32 vcc, 1, v6
  s_cbranch_vccnz L_slow_u0
L_poll_u0_ok:
  v_mfma_f32_16x16x32_bf16 v[44:47], v[248:251], a[180:183], v[44:47]
  v_mfma_f32_16x16x32_bf16 v[44:47], v[244:247], a[160:163], v[44:47]
  v_mfma_f32_16x16x32_bf16 v[44:47], v[240:243], a[140:143], v[44:47]
  s_waitcnt vmcnt(16)
  v_mfma_f32_16x16x32_bf16 v[48:51], v[240:243], a[144:147], v[48:51]
  s_barrier
  v_mfma_f32_16x16x32_bf16 v[48:51], v[244:247], a[164:167], v[48:51]
  ds_read_b64_tr_b16 v[28:29], v2 offset:0
  ds_read_b64_tr_b16 v[30:31], v2 offset:512
  v_mfma_f32_16x16x32_bf16 v[48:51], v[248:251], a[184:187], v[48:51]
  buffer_load_dwordx4 v[220:223], v13, s[44:47], s26 offen sc1
  v_mfma_f32_16x16x32_bf16 v[52:55], v[248:251], a[188:191], v[52:55]
  ds_read_b64_tr_b16 v[32:33], v2 offset:1024
  ds_read_b64_tr_b16 v[34:35], v2 offset:1536
  v_mfma_f32_16x16x32_bf16 v[52:55], v[244:247], a[168:171], v[52:55]
  ds_read_b64_tr_b16 v[36:37], v2 offset:2048
  ds_read_b64_tr_b16 v[38:39], v2 offset:2560
  v_mfma_f32_16x16x32_bf16 v[52:55], v[240:243], a[148:151], v[52:55]
  buffer_load_dwordx4 v[224:227], v13, s[44:47], s26 offen offset:1024 sc1
  v_mfma_f32_16x16x32_bf16 v[56:59], v[240:243], a[152:155], v[56:59]
  v_mfma_f32_16x16x32_bf16 v[56:59], v[244:247], a[172:175], v[56:59]
  v_mfma_f32_16x16x32_bf16 v[56:59], v[248:251], a[192:195], v[56:59]
  s_waitcnt lgkmcnt(2)
  v_mfma_f32_16x16x32_bf16 v[56:59], v[28:31], a[212:215], v[56:59]
  v_mfma_f32_16x16x32_bf16 v[56:59], v[32:35], a[232:235], v[56:59]
  s_waitcnt lgkmcnt(0)
  buffer_load_dwordx2 v[228:229], v14, s[44:47], s26 offen offset:2048 sc1
  v_mfma_f32_16x16x32_bf16 v[76:79], v[36:39], a[252:255], v[56:59]
  v_mfma_f32_16x16x32_bf16 v[52:55], v[36:39], a[248:251], v[52:55]
  v_mfma_f32_16x16x32_bf16 v[52:55], v[32:35], a[228:231], v[52:55]
  v_mfma_f32_16x16x32_bf16 v[72:75], v[28:31], a[208:211], v[52:55]
  ds_read_b64_tr_b16 v[240:241], v2 offset:12288
  ds_read_b64_tr_b16 v[242:243], v2 offset:12800
  v_mfma_f32_16x16x32_bf16 v[48:51], v[28:31], a[204:207], v[48:51]
  v_mfma_f32_16x16x32_bf16 v[48:51], v[32:35], a[224:227], v[48:51]
  ds_read_b64_tr_b16 v[244:245], v2 offset:13312
  ds_read_b64_tr_b16 v[246:247], v2 offset:13824
  v_mfma_f32_16x16x32_bf16 v[68:71], v[36:39], a[244:247], v[48:51]
  v_mfma_f32_16x16x32_bf16 v[44:47], v[36:39], a[240:243], v[44:47]
  v_mfma_f32_16x16x32_bf16 v[44:47], v[32:35], a[220:223], v[44:47]
  ds_read_b64_tr_b16 v[248:249], v2 offset:14336
  ds_read_b64_tr_b16 v[250:251], v2 offset:14848
  v_mfma_f32_16x16x32_bf16 v[64:67], v[28:31], a[200:203], v[44:47]
  buffer_load_dwordx4 v[230:233], v13, s[44:47], s27 offen sc1
  v_mfma_f32_16x16x32_bf16 v[40:43], v[28:31], a[196:199], v[40:43]
  v_mfma_f32_16x16x32_bf16 v[40:43], v[32:35], a[216:219], v[40:43]
  v_mfma_f32_16x16x32_bf16 v[60:63], v[36:39], a[236:239], v[40:43]
  s_waitcnt lgkmcnt(2)
  v_mfma_f32_16x16x32_bf16 v[40:43], v[240:243], v[116:119], 0
  v_mfma_f32_16x16x32_bf16 v[40:43], v[244:247], v[136:139], v[40:43]
L_fw5:
  s_cbranch_execz L_ffn_ret
  s_waitcnt lgkmcnt(0)
  buffer_load_dwordx4 v[234:237], v13, s[44:47], s27 offen offset:1024 sc1
  v_mfma_f32_16x16x32_bf16 v[40:43], v[248:251], v[156:159], v[40:43]
  s_mov_b32 s25, 71680
  v_cvt_pk_bf16_f32 v88, v76, v77
  v_cvt_pk_bf16_f32 v89, v78, v79
  v_mfma_f32_16x16x32_bf16 v[44:47], v[248:251], v[160:163], 0
  v_cvt_pk_bf16_f32 v86, v72, v73
  v_cvt_pk_bf16_f32 v87, v74, v75
  v_mfma_f32_16x16x32_bf16 v[44:47], v[244:247], v[140:143], v[44:47]
  v_cvt_pk_bf16_f32 v84, v68, v69
  v_mfma_f32_16x16x32_bf16 v[44:47], v[240:243], v[120:123], v[44:47]
  ds_read_b64_tr_b16 v[28:29], v2 offset:49152
  ds_read_b64_tr_b16 v[30:31], v2 offset:49664
  v_mfma_f32_16x16x32_bf16 v[48:51], v[240:243], v[124:127], 0
  v_cvt_pk_bf16_f32 v85, v70, v71
  v_cvt_pk_bf16_f32 v82, v64, v65
  v_mfma_f32_16x16x32_bf16 v[48:51], v[244:247], v[144:147], v[48:51]
  ds_read_b64_tr_b16 v[32:33], v2 offset:50176
  ds_read_b64_tr_b16 v[34:35], v2 offset:50688
  v_mfma_f32_16x16x32_bf16 v[48:51], v[248:251], v[164:167], v[48:51]
  v_cvt_pk_bf16_f32 v83, v66, v67
  v_cvt_pk_bf16_f32 v80, v60, v61
  v_mfma_f32_16x16x32_bf16 v[52:55], v[248:251], v[168:171], 0
  v_cvt_pk_bf16_f32 v81, v62, v63
  v_mfma_f32_16x16x32_bf16 v[52:55], v[244:247], v[148:151], v[52:55]
  ds_read_b64_tr_b16 v[36:37], v2 offset:51200
  ds_read_b64_tr_b16 v[38:39], v2 offset:51712
  v_mfma_f32_16x16x32_bf16 v[52:55], v[240:243], v[128:131], v[52:55]
  buffer_load_dwordx2 v[238:239], v14, s[44:47], s27 offen offset:2048 sc1
  v_mfma_f32_16x16x32_bf16 v[56:59], v[240:243], v[132:135], 0
  v_mfma_f32_16x16x32_bf16 v[56:59], v[244:247], v[152:155], v[56:59]
  buffer_store_dwordx4 v[80:83], v13, s[12:15], s25 offen sc1
  v_mfma_f32_16x16x32_bf16 v[56:59], v[248:251], v[172:175], v[56:59]
  s_waitcnt lgkmcnt(2)
  v_mfma_f32_16x16x32_bf16 v[56:59], v[28:31], v[192:195], v[56:59]
  v_mfma_f32_16x16x32_bf16 v[56:59], v[32:35], v[212:215], v[56:59]
  s_waitcnt lgkmcnt(0)
  buffer_load_dwordx4 v[116:119], v13, s[44:47], s28 offen sc1
  v_mfma_f32_16x16x32_bf16 v[56:59], v[36:39], a[12:15], v[56:59]
  v_mfma_f32_16x16x32_bf16 v[52:55], v[36:39], a[8:11], v[52:55]
  buffer_store_dwordx4 v[84:87], v13, s[12:15], s25 offen offset:1024 sc1
  v_mfma_f32_16x16x32_bf16 v[52:55], v[32:35], v[208:211], v[52:55]
  v_mfma_f32_16x16x32_bf16 v[52:55], v[28:31], v[188:191], v[52:55]
  s_waitcnt vmcnt(9)
  v_mfma_f32_16x16x32_bf16 v[48:51], v[28:31], v[184:187], v[48:51]
  s_barrier
  v_mfma_f32_16x16x32_bf16 v[48:51], v[32:35], v[204:207], v[48:51]
  ds_read_b64_tr_b16 v[240:241], v3 offset:0
  ds_read_b64_tr_b16 v[242:243], v3 offset:512
  v_mfma_f32_16x16x32_bf16 v[48:51], v[36:39], a[4:7], v[48:51]
  v_mfma_f32_16x16x32_bf16 v[44:47], v[36:39], a[0:3], v[44:47]
  ds_read_b64_tr_b16 v[244:245], v3 offset:1024
  ds_read_b64_tr_b16 v[246:247], v3 offset:1536
  v_mfma_f32_16x16x32_bf16 v[44:47], v[32:35], v[200:203], v[44:47]
  ds_read_b64_tr_b16 v[248:249], v3 offset:2048
  ds_read_b64_tr_b16 v[250:251], v3 offset:2560
  v_mfma_f32_16x16x32_bf16 v[44:47], v[28:31], v[180:183], v[44:47]
  buffer_load_dwordx4 v[120:123], v13, s[44:47], s28 offen offset:1024 sc1
  v_mfma_f32_16x16x32_bf16 v[40:43], v[28:31], v[176:179], v[40:43]
  v_mfma_f32_16x16x32_bf16 v[40:43], v[32:35], v[196:199], v[40:43]
  buffer_store_dwordx2 v[88:89], v14, s[12:15], s25 offen offset:2048 sc1
  v_mfma_f32_16x16x32_bf16 v[40:43], v[36:39], v[216:219], v[40:43]
  s_waitcnt lgkmcnt(2)
  v_mfma_f32_16x16x32_bf16 v[40:43], v[240:243], a[16:19], v[40:43]
  v_and_b32 v206, 1, v1
  v_xor_b32 v206, s64, v206
  v_mfma_f32_16x16x32_bf16 v[40:43], v[244:247], a[36:39], v[40:43]
  s_waitcnt lgkmcnt(0)
  buffer_load_dwordx2 v[124:125], v14, s[44:47], s28 offen offset:2048 sc1
  v_mfma_f32_16x16x32_bf16 v[40:43], v[248:251], a[56:59], v[40:43]
  v_xor_b32 v207, 4, v206
  v_lshl_add_u32 v207, v207, 2, v9
  v_mfma_f32_16x16x32_bf16 v[44:47], v[248:251], a[60:63], v[44:47]
  v_subrev_u32 v8, 384, v207
  v_xor_b32 v206, 6, v206
  v_mfma_f32_16x16x32_bf16 v[44:47], v[244:247], a[40:43], v[44:47]
  v_lshl_add_u32 v207, v206, 2, v9
  v_lshrrev_b32 v206, 1, v206
  v_mfma_f32_16x16x32_bf16 v[44:47], v[240:243], a[20:23], v[44:47]
  ds_read_b64_tr_b16 v[28:29], v3 offset:12288
  ds_read_b64_tr_b16 v[30:31], v3 offset:12800
  v_mfma_f32_16x16x32_bf16 v[48:51], v[240:243], a[24:27], v[48:51]
  buffer_load_dwordx2 v[126:127], v17, s[44:47], s33 offen sc1
  v_mfma_f32_16x16x32_bf16 v[48:51], v[244:247], a[44:47], v[48:51]
  ds_read_b64_tr_b16 v[32:33], v3 offset:13312
  ds_read_b64_tr_b16 v[34:35], v3 offset:13824
  v_mfma_f32_16x16x32_bf16 v[48:51], v[248:251], a[64:67], v[48:51]
  v_lshl_add_u32 v216, v206, 7, v207
  v_mfma_f32_16x16x32_bf16 v[52:55], v[248:251], a[68:71], v[52:55]
  s_lshr_b32 s90, s64, 1
  v_mfma_f32_16x16x32_bf16 v[52:55], v[244:247], a[48:51], v[52:55]
  s_lshl_b32 s90, s90, 7
  ds_read_b64_tr_b16 v[36:37], v3 offset:14336
  ds_read_b64_tr_b16 v[38:39], v3 offset:14848
  v_mfma_f32_16x16x32_bf16 v[52:55], v[240:243], a[28:31], v[52:55]
  v_and_b32 v206, 15, v1
  v_lshrrev_b32 v207, 4, v1
  v_mfma_f32_16x16x32_bf16 v[56:59], v[240:243], a[32:35], v[56:59]
  v_and_b32 v208, 7, v1
  v_lshrrev_b32 v209, 1, v207
  v_mfma_f32_16x16x32_bf16 v[56:59], v[244:247], a[52:55], v[56:59]
  s_lshl_b32 s69, s20, 1
  v_add_u32 v209, s69, v209
  v_xor_b32 v209, v209, v208
  v_mfma_f32_16x16x32_bf16 v[56:59], v[248:251], a[72:75], v[56:59]
  s_waitcnt lgkmcnt(2)
  v_lshlrev_b32 v209, 4, v209
  v_lshl_add_u32 v209, v206, 7, v209
  v_mfma_f32_16x16x32_bf16 v[56:59], v[28:31], a[92:95], v[56:59]
  v_and_b32 v210, 1, v207
  v_lshl_add_u32 v211, v210, 3, v209
  v_mfma_f32_16x16x32_bf16 v[56:59], v[32:35], a[112:115], v[56:59]
  s_waitcnt lgkmcnt(0)
  buffer_load_dwordx2 v[128:129], v17, s[44:47], s34 offen sc1
  v_mfma_f32_16x16x32_bf16 v[56:59], v[36:39], a[132:135], v[56:59]
  v_lshl_add_u32 v212, v1, 4, s60
  v_lshrrev_b32 v209, 3, v1
  v_mfma_f32_16x16x32_bf16 v[52:55], v[36:39], a[128:131], v[52:55]
  v_xor_b32 v210, v208, v209
  v_mfma_f32_16x16x32_bf16 v[52:55], v[32:35], a[108:111], v[52:55]
  s_lshl_b32 s69, s20, 3
  v_add_u32 v209, s69, v209
  v_mul_u32_u24 v209, 1152, v209
  v_mfma_f32_16x16x32_bf16 v[52:55], v[28:31], a[88:91], v[52:55]
  ds_read_b64_tr_b16 v[240:241], v3 offset:24576
  ds_read_b64_tr_b16 v[242:243], v3 offset:25088
  v_mfma_f32_16x16x32_bf16 v[48:51], v[28:31], a[84:87], v[48:51]
  buffer_load_dwordx2 v[130:131], v17, s[44:47], s35 offen sc1
  v_mfma_f32_16x16x32_bf16 v[48:51], v[32:35], a[104:107], v[48:51]
  ds_read_b64_tr_b16 v[244:245], v3 offset:25600
  ds_read_b64_tr_b16 v[246:247], v3 offset:26112
  v_mfma_f32_16x16x32_bf16 v[48:51], v[36:39], a[124:127], v[48:51]
  v_lshl_add_u32 v18, v210, 4, v209
  v_add_u32 v213, 36864, v18
  v_mfma_f32_16x16x32_bf16 v[44:47], v[36:39], a[120:123], v[44:47]
  s_and_b32 s69, s20, 1
  v_mfma_f32_16x16x32_bf16 v[44:47], v[32:35], a[100:103], v[44:47]
  s_lshl_b32 s69, s69, 2
  ds_read_b64_tr_b16 v[248:249], v3 offset:26624
  ds_read_b64_tr_b16 v[250:251], v3 offset:27136
  v_mfma_f32_16x16x32_bf16 v[44:47], v[28:31], a[80:83], v[44:47]
  buffer_load_dwordx2 v[132:133], v17, s[44:47], s36 offen sc1
  v_mfma_f32_16x16x32_bf16 v[40:43], v[28:31], a[76:79], v[40:43]
  v_add_u32 v209, s69, v207
  v_lshrrev_b32 v210, 1, v206
  v_mfma_f32_16x16x32_bf16 v[40:43], v[32:35], a[96:99], v[40:43]
  v_xor_b32 v210, v210, v209
  v_lshlrev_b32 v210, 4, v210
  v_mfma_f32_16x16x32_bf16 v[40:43], v[36:39], a[116:119], v[40:43]
  s_waitcnt lgkmcnt(2)
  v_and_b32 v209, 1, v1
  v_lshl_add_u32 v210, v209, 3, v210
  v_mfma_f32_16x16x32_bf16 v[40:43], v[240:243], a[136:139], v[40:43]
  s_lshl_b32 s69, s20, 2
  v_add_u32 v209, s69, v207
  v_mov_b32 v208, 2147483647
  v_mfma_f32_16x16x32_bf16 v[40:43], v[244:247], a[156:159], v[40:43]
  s_waitcnt lgkmcnt(0)
  buffer_load_dwordx2 v[134:135], v17, s[44:47], s37 offen sc1
  v_mfma_f32_16x16x32_bf16 v[40:43], v[248:251], a[176:179], v[40:43]
  s_lshl_b32 s69, s53, 4
  v_add_u32 v215, s69, v209
  v_cmp_le_u32 vcc, 79, v215
  v_mfma_f32_16x16x32_bf16 v[44:47], v[248:251], a[180:183], v[44:47]
  v_mul_u32_u24 v215, 1152, v215
  v_add_u32 v215, v215, v210
  v_mfma_f32_16x16x32_bf16 v[44:47], v[244:247], a[160:163], v[44:47]
  v_cndmask_b32 v215, v215, v208, vcc
  v_cmp_eq_u32 vcc, 15, v209
  v_mfma_f32_16x16x32_bf16 v[44:47], v[240:243], a[140:143], v[44:47]
  ds_read_b64_tr_b16 v[28:29], v2 offset:36864
  ds_read_b64_tr_b16 v[30:31], v2 offset:37376
  v_mfma_f32_16x16x32_bf16 v[48:51], v[240:243], a[144:147], v[48:51]
  buffer_load_dwordx2 v[136:137], v17, s[44:47], s38 offen sc1
  v_mfma_f32_16x16x32_bf16 v[48:51], v[244:247], a[164:167], v[48:51]
  ds_read_b64_tr_b16 v[32:33], v2 offset:37888
  ds_read_b64_tr_b16 v[34:35], v2 offset:38400
  v_mfma_f32_16x16x32_bf16 v[48:51], v[248:251], a[184:187], v[48:51]
  v_add_u32 v209, 64, v209
  v_mul_u32_u24 v209, 1152, v209
  v_mfma_f32_16x16x32_bf16 v[52:55], v[248:251], a[188:191], v[52:55]
  v_add_u32 v209, v209, v210
  v_cndmask_b32 v214, v209, v208, vcc
  v_mfma_f32_16x16x32_bf16 v[52:55], v[244:247], a[168:171], v[52:55]
  s_add_u32 s4, s56, s55
  s_addc_u32 s5, s57, 0
  ds_read_b64_tr_b16 v[36:37], v2 offset:38912
  ds_read_b64_tr_b16 v[38:39], v2 offset:39424
  v_mfma_f32_16x16x32_bf16 v[52:55], v[240:243], a[148:151], v[52:55]
  s_lshl_b32 s25, s64, 7
  buffer_load_dwordx2 v[138:139], v17, s[44:47], s39 offen sc1
  v_mfma_f32_16x16x32_bf16 v[56:59], v[240:243], a[152:155], v[56:59]
  s_mov_b32 s66, 0x3f80
  v_mfma_f32_16x16x32_bf16 v[56:59], v[244:247], a[172:175], v[56:59]
  s_mov_b32 s67, 0x3f800000
  buffer_load_dword v6, v8, s[44:47], 0 offen offset:128 sc1
  v_mfma_f32_16x16x32_bf16 v[56:59], v[248:251], a[192:195], v[56:59]
  s_waitcnt lgkmcnt(2)
  buffer_load_dword v7, v9, s[44:47], 0 offen offset:0 sc1
  v_mfma_f32_16x16x32_bf16 v[56:59], v[28:31], a[212:215], v[56:59]
  v_mfma_f32_16x16x32_bf16 v[56:59], v[32:35], a[232:235], v[56:59]
  s_waitcnt lgkmcnt(0)
  buffer_load_dwordx2 v[140:141], v17, s[44:47], s40 offen sc1
  v_mfma_f32_16x16x32_bf16 v[76:79], v[36:39], a[252:255], v[56:59]
  s_waitcnt vmcnt(11)
  v_mfma_f32_16x16x32_bf16 v[52:55], v[36:39], a[248:251], v[52:55]
  s_barrier
  v_mfma_f32_16x16x32_bf16 v[52:55], v[32:35], a[228:231], v[52:55]
  buffer_store_dword v16, v15, s[44:47], s90 offen offset:512 sc1
  v_mfma_f32_16x16x32_bf16 v[72:75], v[28:31], a[208:211], v[52:55]
  v_mfma_f32_16x16x32_bf16 v[48:51], v[28:31], a[204:207], v[48:51]
  v_mfma_f32_16x16x32_bf16 v[48:51], v[32:35], a[224:227], v[48:51]
  v_mfma_f32_16x16x32_bf16 v[68:71], v[36:39], a[244:247], v[48:51]
  v_mfma_f32_16x16x32_bf16 v[44:47], v[36:39], a[240:243], v[44:47]
  v_mfma_f32_16x16x32_bf16 v[44:47], v[32:35], a[220:223], v[44:47]
  v_mfma_f32_16x16x32_bf16 v[64:67], v[28:31], a[200:203], v[44:47]
  v_mfma_f32_16x16x32_bf16 v[40:43], v[28:31], a[196:199], v[40:43]
  v_mfma_f32_16x16x32_bf16 v[40:43], v[32:35], a[216:219], v[40:43]
  buffer_load_dword v217, v216, s[44:47], 0 offen offset:128 sc1
  v_mfma_f32_16x16x32_bf16 v[60:63], v[36:39], a[236:239], v[40:43]
  s_waitcnt vmcnt(3)
  v_cmp_gt_u32 vcc, 1, v6
  s_cbranch_vccnz L_slow_u1
L_poll_u1_ok:
  buffer_load_dwordx4 v[142:145], v13, s[44:47], s29 offen sc1
  buffer_load_dwordx4 v[146:149], v13, s[44:47], s29 offen offset:1024 sc1
  buffer_load_dwordx2 v[150:151], v14, s[44:47], s29 offen offset:2048 sc1
  buffer_load_dwordx4 v[152:155], v13, s[44:47], s30 offen sc1
  buffer_load_dwordx4 v[156:159], v13, s[44:47], s30 offen offset:1024 sc1
  buffer_load_dwordx2 v[160:161], v14, s[44:47], s30 offen offset:2048 sc1
  v_cmp_gt_u32 vcc, 1, v7
  s_cbranch_vccnz L_slow_cv
L_poll_cv_ok:
  buffer_load_dwordx2 v[80:81], v19, s[44:47], s41 offen sc1
  buffer_load_dwordx2 v[82:83], v19, s[44:47], s42 offen sc1
  buffer_load_dwordx2 v[84:85], v19, s[44:47], s43 offen sc1
  buffer_load_dwordx2 v[86:87], v19, s[44:47], s8 offen sc1
  buffer_load_dwordx2 v[88:89], v19, s[44:47], s9 offen sc1
  buffer_load_dwordx2 v[90:91], v19, s[44:47], s10 offen sc1
  s_waitcnt vmcnt(12)
  v_cmp_gt_u32 vcc, 1, v217
  s_cmp_lg_u64 vcc, 0
  s_cselect_b32 s68, 1, 0
  s_cbranch_scc1 L_u2_later
  buffer_load_dwordx4 v[162:165], v13, s[44:47], s31 offen sc1
  buffer_load_dwordx4 v[172:175], v13, s[44:47], s32 offen sc1
  buffer_load_dwordx4 v[166:169], v13, s[44:47], s31 offen offset:1024 sc1
  buffer_load_dwordx4 v[176:179], v13, s[44:47], s32 offen offset:1024 sc1
  buffer_load_dwordx2 v[170:171], v14, s[44:47], s31 offen offset:2048 sc1
  buffer_load_dwordx2 v[180:181], v14, s[44:47], s32 offen offset:2048 sc1
L_u2_later:
  v_lshlrev_b32 v182, 16, v92
  v_and_b32 v183, s65, v92
  v_lshlrev_b32 v28, 16, v104
  v_and_b32 v29, s65, v104
  v_lshlrev_b32 v184, 16, v93
  v_and_b32 v185, s65, v93
  v_lshlrev_b32 v30, 16, v105
  v_and_b32 v31, s65, v105
  v_lshlrev_b32 v186, 16, v94
  v_and_b32 v187, s65, v94
  v_lshlrev_b32 v32, 16, v106
  v_and_b32 v33, s65, v106
  v_lshlrev_b32 v188, 16, v95
  v_and_b32 v189, s65, v95
  v_lshlrev_b32 v34, 16, v107
  v_and_b32 v35, s65, v107
  v_lshlrev_b32 v190, 16, v96
  v_and_b32 v191, s65, v96
  v_lshlrev_b32 v36, 16, v108
  v_and_b32 v37, s65, v108
  v_lshlrev_b32 v192, 16, v97
  v_and_b32 v193, s65, v97
  v_lshlrev_b32 v38, 16, v109
  v_and_b32 v39, s65, v109
  v_lshlrev_b32 v194, 16, v98
  v_and_b32 v195, s65, v98
  v_lshlrev_b32 v40, 16, v110
  v_and_b32 v41, s65, v110
  v_lshlrev_b32 v196, 16, v99
  v_and_b32 v197, s65, v99
  v_lshlrev_b32 v42, 16, v111
  v_and_b32 v43, s65, v111
  v_lshlrev_b32 v198, 16, v100
  v_and_b32 v199, s65, v100
  v_lshlrev_b32 v44, 16, v112
  v_and_b32 v45, s65, v112
  v_lshlrev_b32 v200, 16, v101
  v_and_b32 v201, s65, v101
  v_lshlrev_b32 v46, 16, v113
  v_and_b32 v47, s65, v113
  v_lshlrev_b32 v202, 16, v102
  v_and_b32 v203, s65, v102
  v_lshlrev_b32 v48, 16, v114
  v_and_b32 v49, s65, v114
  v_lshlrev_b32 v204, 16, v103
  v_and_b32 v205, s65, v103
  v_lshlrev_b32 v50, 16, v115
  v_and_b32 v51, s65, v115
  v_dot2c_f32_bf16 v60, s66, v220
  v_dot2c_f32_bf16 v61, s67, v220
  v_dot2c_f32_bf16 v62, s66, v221
  v_dot2c_f32_bf16 v63, s67, v221
  v_dot2c_f32_bf16 v64, s66, v222
  v_dot2c_f32_bf16 v65, s67, v222
  v_dot2c_f32_bf16 v66, s66, v223
  v_dot2c_f32_bf16 v67, s67, v223
  v_dot2c_f32_bf16 v68, s66, v224
  v_dot2c_f32_bf16 v69, s67, v224
  v_dot2c_f32_bf16 v70, s66, v225
  v_dot2c_f32_bf16 v71, s67, v225
  v_dot2c_f32_bf16 v72, s66, v226
  v_dot2c_f32_bf16 v73, s67, v226
  v_dot2c_f32_bf16 v74, s66, v227
  v_dot2c_f32_bf16 v75, s67, v227
  v_dot2c_f32_bf16 v76, s66, v228
  v_dot2c_f32_bf16 v77, s67, v228
  v_dot2c_f32_bf16 v78, s66, v229
  v_dot2c_f32_bf16 v79, s67, v229
  v_dot2c_f32_bf16 v60, s66, v230
  v_dot2c_f32_bf16 v61, s67, v230
  v_dot2c_f32_bf16 v62, s66, v231
  v_dot2c_f32_bf16 v63, s67, v231
  v_dot2c_f32_bf16 v64, s66, v232
  v_dot2c_f32_bf16 v65, s67, v232
  v_dot2c_f32_bf16 v66, s66, v233
  v_dot2c_f32_bf16 v67, s67, v233
  v_dot2c_f32_bf16 v68, s66, v234
  v_dot2c_f32_bf16 v69, s67, v234
  v_dot2c_f32_bf16 v70, s66, v235
  v_dot2c_f32_bf16 v71, s67, v235
  v_dot2c_f32_bf16 v72, s66, v236
  v_dot2c_f32_bf16 v73, s67, v236
  v_dot2c_f32_bf16 v74, s66, v237
  v_dot2c_f32_bf16 v75, s67, v237
  v_dot2c_f32_bf16 v76, s66, v238
  v_dot2c_f32_bf16 v77, s67, v238
  v_dot2c_f32_bf16 v78, s66, v239
  v_dot2c_f32_bf16 v79, s67, v239
  v_dot2c_f32_bf16 v60, s66, v116
  v_dot2c_f32_bf16 v61, s67, v116
  v_dot2c_f32_bf16 v62, s66, v117
  v_dot2c_f32_bf16 v63, s67, v117
  v_dot2c_f32_bf16 v64, s66, v118
  v_dot2c_f32_bf16 v65, s67, v118
  v_dot2c_f32_bf16 v66, s66, v119
  v_dot2c_f32_bf16 v67, s67, v119
  v_dot2c_f32_bf16 v68, s66, v120
  v_dot2c_f32_bf16 v69, s67, v120
  v_dot2c_f32_bf16 v70, s66, v121
  v_dot2c_f32_bf16 v71, s67, v121
  v_dot2c_f32_bf16 v72, s66, v122
  v_dot2c_f32_bf16 v73, s67, v122
  v_dot2c_f32_bf16 v74, s66, v123
  v_dot2c_f32_bf16 v75, s67, v123
  v_dot2c_f32_bf16 v76, s66, v124
  v_dot2c_f32_bf16 v77, s67, v124
  v_dot2c_f32_bf16 v78, s66, v125
  v_dot2c_f32_bf16 v79, s67, v125
  v_dot2_f32_bf16 v52, v126, s66, 0
  v_dot2_f32_bf16 v53, v126, s67, 0
  v_dot2_f32_bf16 v54, v127, s66, 0
  v_dot2_f32_bf16 v55, v127, s67, 0
  v_dot2c_f32_bf16 v52, s66, v128
  v_dot2c_f32_bf16 v53, s67, v128
  v_dot2c_f32_bf16 v54, s66, v129
  v_dot2c_f32_bf16 v55, s67, v129
  v_dot2c_f32_bf16 v52, s66, v130
  v_dot2c_f32_bf16 v53, s67, v130
  v_dot2c_f32_bf16 v54, s66, v131
  v_dot2c_f32_bf16 v55, s67, v131
  v_dot2c_f32_bf16 v52, s66, v132
  v_dot2c_f32_bf16 v53, s67, v132
  v_dot2c_f32_bf16 v54, s66, v133
  v_dot2c_f32_bf16 v55, s67, v133
  v_dot2c_f32_bf16 v52, s66, v134
  v_dot2c_f32_bf16 v53, s67, v134
  v_dot2c_f32_bf16 v54, s66, v135
  v_dot2c_f32_bf16 v55, s67, v135
  v_dot2c_f32_bf16 v52, s66, v136
  v_dot2c_f32_bf16 v53, s67, v136
  v_dot2c_f32_bf16 v54, s66, v137
  v_dot2c_f32_bf16 v55, s67, v137
  v_dot2c_f32_bf16 v52, s66, v138
  v_dot2c_f32_bf16 v53, s67, v138
  v_dot2c_f32_bf16 v54, s66, v139
  v_dot2c_f32_bf16 v55, s67, v139
  v_dot2c_f32_bf16 v52, s66, v140
  v_dot2c_f32_bf16 v53, s67, v140
  v_dot2c_f32_bf16 v54, s66, v141
  v_dot2c_f32_bf16 v55, s67, v141
  s_cmp_eq_u32 s20, 1
  s_cselect_b32 s70, s68, 0
  s_cmp_eq_u32 s70, 0
  s_cbranch_scc1 L_poll_u2_ok
  s_mov_b32 s71, 0
L_poll_u2:
  buffer_load_dword v6, v216, s[44:47], 0 offen offset:128 sc1
  s_add_u32 s71, s71, 1
  s_cmp_gt_u32 s71, 0x200000
  s_cbranch_scc1 L_poll_u2_ok
  s_waitcnt vmcnt(0)
  v_cmp_gt_u32 vcc, 1, v6
  s_cbranch_vccz L_poll_u2_ok
  s_sleep 2
  s_branch L_poll_u2
L_poll_u2_ok:
  s_barrier
  s_cmp_eq_u32 s68, 0
  s_cbranch_scc1 L_u2_done
  buffer_load_dwordx4 v[162:165], v13, s[44:47], s31 offen sc1
  buffer_load_dwordx4 v[172:175], v13, s[44:47], s32 offen sc1
  buffer_load_dwordx4 v[166:169], v13, s[44:47], s31 offen offset:1024 sc1
  buffer_load_dwordx4 v[176:179], v13, s[44:47], s32 offen offset:1024 sc1
  buffer_load_dwordx2 v[170:171], v14, s[44:47], s31 offen offset:2048 sc1
  buffer_load_dwordx2 v[180:181], v14, s[44:47], s32 offen offset:2048 sc1
L_u2_done:
  s_waitcnt vmcnt(17)
  v_dot2c_f32_bf16 v60, s66, v142
  v_dot2c_f32_bf16 v61, s67, v142
  v_dot2c_f32_bf16 v62, s66, v143
  v_dot2c_f32_bf16 v63, s67, v143
  v_dot2c_f32_bf16 v64, s66, v144
  v_dot2c_f32_bf16 v65, s67, v144
  v_dot2c_f32_bf16 v66, s66, v145
  v_dot2c_f32_bf16 v67, s67, v145
  s_waitcnt vmcnt(16)
  v_dot2c_f32_bf16 v68, s66, v146
  v_dot2c_f32_bf16 v69, s67, v146
  v_dot2c_f32_bf16 v70, s66, v147
  v_dot2c_f32_bf16 v71, s67, v147
  v_dot2c_f32_bf16 v72, s66, v148
  v_dot2c_f32_bf16 v73, s67, v148
  v_dot2c_f32_bf16 v74, s66, v149
  v_dot2c_f32_bf16 v75, s67, v149
  s_waitcnt vmcnt(15)
  v_dot2c_f32_bf16 v76, s66, v150
  v_dot2c_f32_bf16 v77, s67, v150
  v_dot2c_f32_bf16 v78, s66, v151
  v_dot2c_f32_bf16 v79, s67, v151
  s_waitcnt vmcnt(14)
  v_dot2c_f32_bf16 v60, s66, v152
  v_dot2c_f32_bf16 v61, s67, v152
  v_dot2c_f32_bf16 v62, s66, v153
  v_dot2c_f32_bf16 v63, s67, v153
  v_dot2c_f32_bf16 v64, s66, v154
  v_dot2c_f32_bf16 v65, s67, v154
  v_dot2c_f32_bf16 v66, s66, v155
  v_dot2c_f32_bf16 v67, s67, v155
  s_waitcnt vmcnt(13)
  v_dot2c_f32_bf16 v68, s66, v156
  v_dot2c_f32_bf16 v69, s67, v156
  v_dot2c_f32_bf16 v70, s66, v157
  v_dot2c_f32_bf16 v71, s67, v157
  v_dot2c_f32_bf16 v72, s66, v158
  v_dot2c_f32_bf16 v73, s67, v158
  v_dot2c_f32_bf16 v74, s66, v159
  v_dot2c_f32_bf16 v75, s67, v159
  s_waitcnt vmcnt(12)
  v_dot2c_f32_bf16 v76, s66, v160
  v_dot2c_f32_bf16 v77, s67, v160
  v_dot2c_f32_bf16 v78, s66, v161
  v_dot2c_f32_bf16 v79, s67, v161
  s_waitcnt vmcnt(6)
  v_lshlrev_b32 v240, 16, v80
  v_and_b32 v241, s65, v80
  v_pk_fma_f32 v[182:183], v[240:241], v[28:29], v[182:183]
  v_lshlrev_b32 v240, 16, v81
  v_and_b32 v241, s65, v81
  v_pk_fma_f32 v[184:185], v[240:241], v[30:31], v[184:185]
  v_lshlrev_b32 v240, 16, v82
  v_and_b32 v241, s65, v82
  v_pk_fma_f32 v[186:187], v[240:241], v[32:33], v[186:187]
  v_lshlrev_b32 v240, 16, v83
  v_and_b32 v241, s65, v83
  v_pk_fma_f32 v[188:189], v[240:241], v[34:35], v[188:189]
  v_lshlrev_b32 v240, 16, v84
  v_and_b32 v241, s65, v84
  v_pk_fma_f32 v[190:191], v[240:241], v[36:37], v[190:191]
  v_lshlrev_b32 v240, 16, v85
  v_and_b32 v241, s65, v85
  v_pk_fma_f32 v[192:193], v[240:241], v[38:39], v[192:193]
  v_lshlrev_b32 v240, 16, v86
  v_and_b32 v241, s65, v86
  v_pk_fma_f32 v[194:195], v[240:241], v[40:41], v[194:195]
  v_lshlrev_b32 v240, 16, v87
  v_and_b32 v241, s65, v87
  v_pk_fma_f32 v[196:197], v[240:241], v[42:43], v[196:197]
  v_lshlrev_b32 v240, 16, v88
  v_and_b32 v241, s65, v88
  v_pk_fma_f32 v[198:199], v[240:241], v[44:45], v[198:199]
  v_lshlrev_b32 v240, 16, v89
  v_and_b32 v241, s65, v89
  v_pk_fma_f32 v[200:201], v[240:241], v[46:47], v[200:201]
  v_lshlrev_b32 v240, 16, v90
  v_and_b32 v241, s65, v90
  v_pk_fma_f32 v[202:203], v[240:241], v[48:49], v[202:203]
  v_lshlrev_b32 v240, 16, v91
  v_and_b32 v241, s65, v91
  v_pk_fma_f32 v[204:205], v[240:241], v[50:51], v[204:205]
  v_pk_fma_f32 v[202:203], v[52:53], v[26:27], v[202:203] op_sel:[0,0,0] op_sel_hi:[1,0,1]
  v_pk_fma_f32 v[204:205], v[54:55], v[26:27], v[204:205] op_sel:[0,0,0] op_sel_hi:[1,0,1]
  v_cvt_pk_bf16_f32 v202, v202, v203
  v_cvt_pk_bf16_f32 v203, v204, v205
  ds_write_b64 v211, v[202:203] offset:10240
  s_waitcnt vmcnt(5)
  v_dot2c_f32_bf16 v60, s66, v162
  v_dot2c_f32_bf16 v61, s67, v162
  v_dot2c_f32_bf16 v62, s66, v163
  v_dot2c_f32_bf16 v63, s67, v163
  v_dot2c_f32_bf16 v64, s66, v164
  v_dot2c_f32_bf16 v65, s67, v164
  v_dot2c_f32_bf16 v66, s66, v165
  v_dot2c_f32_bf16 v67, s67, v165
  s_waitcnt vmcnt(4)
  v_dot2c_f32_bf16 v60, s66, v172
  v_dot2c_f32_bf16 v61, s67, v172
  v_dot2c_f32_bf16 v62, s66, v173
  v_dot2c_f32_bf16 v63, s67, v173
  v_dot2c_f32_bf16 v64, s66, v174
  v_dot2c_f32_bf16 v65, s67, v174
  v_dot2c_f32_bf16 v66, s66, v175
  v_dot2c_f32_bf16 v67, s67, v175
  v_pk_fma_f32 v[182:183], v[60:61], v[4:5], v[182:183] op_sel:[0,0,0] op_sel_hi:[1,0,1]
  v_pk_fma_f32 v[184:185], v[62:63], v[4:5], v[184:185] op_sel:[0,0,0] op_sel_hi:[1,0,1]
  v_cvt_pk_bf16_f32 v182, v182, v183
  v_cvt_pk_bf16_f32 v183, v184, v185
  ds_write_b64 v211, v[182:183] offset:0
  v_pk_fma_f32 v[186:187], v[64:65], v[4:5], v[186:187] op_sel:[0,1,0] op_sel_hi:[1,1,1]
  v_pk_fma_f32 v[188:189], v[66:67], v[4:5], v[188:189] op_sel:[0,1,0] op_sel_hi:[1,1,1]
  v_cvt_pk_bf16_f32 v186, v186, v187
  v_cvt_pk_bf16_f32 v187, v188, v189
  ds_write_b64 v211, v[186:187] offset:2048
  s_waitcnt vmcnt(3)
  v_dot2c_f32_bf16 v68, s66, v166
  v_dot2c_f32_bf16 v69, s67, v166
  v_dot2c_f32_bf16 v70, s66, v167
  v_dot2c_f32_bf16 v71, s67, v167
  v_dot2c_f32_bf16 v72, s66, v168
  v_dot2c_f32_bf16 v73, s67, v168
  v_dot2c_f32_bf16 v74, s66, v169
  v_dot2c_f32_bf16 v75, s67, v169
  s_waitcnt vmcnt(2)
  v_dot2c_f32_bf16 v68, s66, v176
  v_dot2c_f32_bf16 v69, s67, v176
  v_dot2c_f32_bf16 v70, s66, v177
  v_dot2c_f32_bf16 v71, s67, v177
  v_dot2c_f32_bf16 v72, s66, v178
  v_dot2c_f32_bf16 v73, s67, v178
  v_dot2c_f32_bf16 v74, s66, v179
  v_dot2c_f32_bf16 v75, s67, v179
  v_pk_fma_f32 v[190:191], v[68:69], v[10:11], v[190:191] op_sel:[0,0,0] op_sel_hi:[1,0,1]
  v_pk_fma_f32 v[192:193], v[70:71], v[10:11], v[192:193] op_sel:[0,0,0] op_sel_hi:[1,0,1]
  v_cvt_pk_bf16_f32 v190, v190, v191
  v_cvt_pk_bf16_f32 v191, v192, v193
  ds_write_b64 v211, v[190:191] offset:4096
  v_pk_fma_f32 v[194:195], v[72:73], v[10:11], v[194:195] op_sel:[0,1,0] op_sel_hi:[1,1,1]
  v_pk_fma_f32 v[196:197], v[74:75], v[10:11], v[196:197] op_sel:[0,1,0] op_sel_hi:[1,1,1]
  v_cvt_pk_bf16_f32 v194, v194, v195
  v_cvt_pk_bf16_f32 v195, v196, v197
  ds_write_b64 v211, v[194:195] offset:6144
  s_waitcnt vmcnt(1)
  v_dot2c_f32_bf16 v76, s66, v170
  v_dot2c_f32_bf16 v77, s67, v170
  v_dot2c_f32_bf16 v78, s66, v171
  v_dot2c_f32_bf16 v79, s67, v171
  s_waitcnt vmcnt(0)
  v_dot2c_f32_bf16 v76, s66, v180
  v_dot2c_f32_bf16 v77, s67, v180
  v_dot2c_f32_bf16 v78, s66, v181
  v_dot2c_f32_bf16 v79, s67, v181
  s_nop 0
  v_pk_fma_f32 v[198:199], v[76:77], v[20:21], v[198:199] op_sel:[0,0,0] op_sel_hi:[1,0,1]
  s_nop 0
  v_pk_fma_f32 v[200:201], v[78:79], v[20:21], v[200:201] op_sel:[0,0,0] op_sel_hi:[1,0,1]
  v_cvt_pk_bf16_f32 v198, v198, v199
  v_cvt_pk_bf16_f32 v199, v200, v201
  ds_write_b64 v211, v[198:199] offset:8192
  s_waitcnt lgkmcnt(0)
  s_barrier
  ds_read_b128 v[28:31], v212
  ds_read_b128 v[32:35], v212 offset:4096
  ds_read_b64 v[36:37], v19 offset:8192
  ds_read_b64 v[38:39], v19 offset:10240
  s_waitcnt lgkmcnt(3)
  buffer_store_dwordx4 v[28:31], v18, s[4:7], s25 offen
  s_waitcnt lgkmcnt(2)
  buffer_store_dwordx4 v[32:35], v213, s[4:7], s25 offen
  s_waitcnt lgkmcnt(1)
  buffer_store_dwordx2 v[36:37], v214, s[4:7], s25 offen
  s_waitcnt lgkmcnt(0)
  buffer_store_dwordx2 v[38:39], v215, s[4:7], 0 offen offset:1024
  s_endpgm
L_slow_rdy:
  s_mov_b32 s71, 0
L_poll_rdy:
  buffer_load_dword v6, off, s[48:51], 0 sc1
  s_add_u32 s71, s71, 1
  s_cmp_gt_u32 s71, 0x200000
  s_cbranch_scc1 L_poll_rdy_ok
  s_waitcnt vmcnt(0)
  v_cmp_gt_u32 vcc, 1, v6
  s_cbranch_vccz L_poll_rdy_ok
  s_sleep 4
  s_branch L_poll_rdy
  s_branch L_poll_rdy_ok
L_slow_u0:
  s_mov_b32 s71, 0
L_poll_u0:
  buffer_load_dword v6, v8, s[44:47], 0 offen offset:0 sc1
  s_add_u32 s71, s71, 1
  s_cmp_gt_u32 s71, 0x200000
  s_cbranch_scc1 L_poll_u0_ok
  s_waitcnt vmcnt(0)
  v_cmp_gt_u32 vcc, 1, v6
  s_cbranch_vccz L_poll_u0_ok
  s_sleep 4
  s_branch L_poll_u0
  s_branch L_poll_u0_ok
L_slow_u1:
  s_mov_b32 s71, 0
L_poll_u1:
  buffer_load_dword v6, v8, s[44:47], 0 offen offset:128 sc1
  s_add_u32 s71, s71, 1
  s_cmp_gt_u32 s71, 0x200000
  s_cbranch_scc1 L_poll_u1_ok
  s_waitcnt vmcnt(0)
  v_cmp_gt_u32 vcc, 1, v6
  s_cbranch_vccz L_poll_u1_ok
  s_sleep 4
  s_branch L_poll_u1
  s_branch L_poll_u1_ok
L_slow_cv:
  s_mov_b32 s71, 0
L_poll_cv:
  buffer_load_dword v7, v9, s[44:47], 0 offen offset:0 sc1
  s_add_u32 s71, s71, 1
  s_cmp_gt_u32 s71, 0x200000
  s_cbranch_scc1 L_poll_cv_ok
  s_waitcnt vmcnt(0)
  v_cmp_gt_u32 vcc, 1, v7
  s_cbranch_vccz L_poll_cv_ok
  s_sleep 4
  s_branch L_poll_cv
  s_branch L_poll_cv_ok
.p2align 12
L_c_s1:
  s_lshl_b32 s68, s20, 14
  s_add_u32 s68, s68, 101760
  v_lshlrev_b32 v8, 1, v2
  v_xor_b32 v8, v8, v3
  v_lshlrev_b32 v8, 4, v8
  v_lshl_add_u32 v8, v3, 11, v8
  v_add_u32 v8, s68, v8
  v_xor_b32 v9, 16, v8
  v_lshl_add_u32 v10, v1, 4, s68
  v_lshrrev_b32 v11, 4, v1
  v_lshlrev_b32 v11, 12, v11
  v_and_b32 v12, 15, v1
  v_lshl_add_u32 v11, v12, 4, v11
  s_lshl_b32 s68, s66, 18
  s_lshl_b32 s69, s67, 8
  s_add_u32 s68, s68, s69
  s_add_u32 s68, s68, 21565440
  s_lshl_b32 s69, s66, 7
  s_lshl_b32 s70, s67, 2
  s_add_u32 s69, s69, s70
  s_add_u32 s69, s69, 23967744
  v_and_b32 v15, 4, v1
  s_waitcnt vmcnt(13)
  v_lshlrev_b32 v80, 16, v208
  v_lshlrev_b32 v81, 16, v210
  v_and_b32 v82, s60, v208
  v_and_b32 v83, s60, v210
  v_lshlrev_b32 v84, 16, v209
  v_lshlrev_b32 v85, 16, v211
  v_and_b32 v86, s60, v209
  v_and_b32 v87, s60, v211
  v_lshlrev_b32 v88, 16, v212
  v_lshlrev_b32 v89, 16, v214
  v_and_b32 v90, s60, v212
  v_and_b32 v91, s60, v214
  v_lshlrev_b32 v92, 16, v213
  v_lshlrev_b32 v93, 16, v215
  v_and_b32 v94, s60, v213
  v_and_b32 v95, s60, v215
  v_lshlrev_b32 v96, 16, v216
  v_lshlrev_b32 v97, 16, v218
  v_and_b32 v98, s60, v216
  v_and_b32 v99, s60, v218
  v_lshlrev_b32 v100, 16, v217
  v_lshlrev_b32 v101, 16, v219
  v_and_b32 v102, s60, v217
  v_and_b32 v103, s60, v219
  v_lshlrev_b32 v104, 16, v220
  v_lshlrev_b32 v105, 16, v222
  v_and_b32 v106, s60, v220
  v_and_b32 v107, s60, v222
  v_lshlrev_b32 v108, 16, v221
  v_lshlrev_b32 v109, 16, v223
  v_and_b32 v110, s60, v221
  v_and_b32 v111, s60, v223
  s_waitcnt vmcnt(10)
  v_lshlrev_b32 v114, 16, v16
  v_and_b32 v115, s60, v16
  v_lshlrev_b32 v122, 16, v17
  v_and_b32 v123, s60, v17
  v_lshlrev_b32 v130, 16, v18
  v_and_b32 v131, s60, v18
  v_lshlrev_b32 v138, 16, v19
  v_and_b32 v139, s60, v19
  v_lshlrev_b32 v116, 16, v20
  v_and_b32 v117, s60, v20
  v_lshlrev_b32 v124, 16, v21
  v_and_b32 v125, s60, v21
  v_lshlrev_b32 v132, 16, v22
  v_and_b32 v133, s60, v22
  v_lshlrev_b32 v140, 16, v23
  v_and_b32 v141, s60, v23
  v_lshlrev_b32 v118, 16, v24
  v_and_b32 v119, s60, v24
  v_lshlrev_b32 v126, 16, v25
  v_and_b32 v127, s60, v25
  v_lshlrev_b32 v134, 16, v26
  v_and_b32 v135, s60, v26
  v_lshlrev_b32 v142, 16, v27
  v_and_b32 v143, s60, v27
  buffer_load_dwordx4 v[16:19], v5, s[4:7], s26 offen offset:1152
  buffer_load_dwordx4 v[68:71], v5, s[8:11], s26 offen offset:1152
  buffer_load_dwordx4 v[20:23], v5, s[4:7], s26 offen offset:2304
  buffer_load_dwordx4 v[72:75], v5, s[8:11], s26 offen offset:2304
  s_waitcnt vmcnt(12)
  v_lshlrev_b32 v112, 16, v28
  v_pk_mul_f32 v[208:209], v[114:115], v[86:87]
  v_and_b32 v113, s60, v28
  v_pk_mul_f32 v[210:211], v[122:123], v[94:95]
  v_lshlrev_b32 v120, 16, v29
  v_pk_mul_f32 v[212:213], v[130:131], v[102:103]
  v_and_b32 v121, s60, v29
  v_pk_mul_f32 v[214:215], v[138:139], v[110:111]
  v_lshlrev_b32 v128, 16, v30
  v_pk_fma_f32 v[208:209], v[116:117], v[84:85], v[208:209]
  v_and_b32 v129, s60, v30
  v_pk_fma_f32 v[210:211], v[124:125], v[92:93], v[210:211]
  v_lshlrev_b32 v136, 16, v31
  v_pk_fma_f32 v[212:213], v[132:133], v[100:101], v[212:213]
  v_and_b32 v137, s60, v31
  v_pk_fma_f32 v[214:215], v[140:141], v[108:109], v[214:215]
  v_lshlrev_b32 v224, 16, v48
  v_pk_fma_f32 v[208:209], v[118:119], v[82:83], v[208:209]
  v_and_b32 v225, s60, v48
  v_pk_fma_f32 v[210:211], v[126:127], v[90:91], v[210:211]
  v_lshlrev_b32 v226, 16, v49
  v_pk_fma_f32 v[212:213], v[134:135], v[98:99], v[212:213]
  v_and_b32 v227, s60, v49
  v_pk_fma_f32 v[214:215], v[142:143], v[106:107], v[214:215]
  v_lshlrev_b32 v228, 16, v50
  v_pk_fma_f32 v[208:209], v[112:113], v[80:81], v[208:209]
  v_and_b32 v229, s60, v50
  v_pk_fma_f32 v[210:211], v[120:121], v[88:89], v[210:211]
  v_lshlrev_b32 v230, 16, v51
  v_pk_fma_f32 v[212:213], v[128:129], v[96:97], v[212:213]
  v_and_b32 v231, s60, v51
  v_pk_fma_f32 v[214:215], v[136:137], v[104:105], v[214:215]
  buffer_load_dwordx4 v[24:27], v5, s[4:7], s26 offen offset:3456
  buffer_load_dwordx4 v[76:79], v5, s[8:11], s26 offen offset:3456
  v_pk_mul_f32 v[208:209], v[208:209], v[224:225]
  v_pk_mul_f32 v[210:211], v[210:211], v[226:227]
  v_pk_mul_f32 v[212:213], v[212:213], v[228:229]
  v_pk_mul_f32 v[214:215], v[214:215], v[230:231]
  s_waitcnt vmcnt(12)
  v_lshlrev_b32 v114, 16, v32
  v_pk_mul_f32 v[216:217], v[116:117], v[86:87]
  v_and_b32 v115, s60, v32
  v_pk_mul_f32 v[218:219], v[124:125], v[94:95]
  v_lshlrev_b32 v122, 16, v33
  v_pk_mul_f32 v[220:221], v[132:133], v[102:103]
  v_and_b32 v123, s60, v33
  v_pk_mul_f32 v[222:223], v[140:141], v[110:111]
  v_lshlrev_b32 v130, 16, v34
  v_pk_fma_f32 v[216:217], v[118:119], v[84:85], v[216:217]
  v_and_b32 v131, s60, v34
  v_pk_fma_f32 v[218:219], v[126:127], v[92:93], v[218:219]
  v_lshlrev_b32 v138, 16, v35
  v_pk_fma_f32 v[220:221], v[134:135], v[100:101], v[220:221]
  v_and_b32 v139, s60, v35
  v_pk_fma_f32 v[222:223], v[142:143], v[108:109], v[222:223]
  v_lshlrev_b32 v224, 16, v52
  v_pk_fma_f32 v[216:217], v[112:113], v[82:83], v[216:217]
  v_and_b32 v225, s60, v52
  v_pk_fma_f32 v[218:219], v[120:121], v[90:91], v[218:219]
  v_lshlrev_b32 v226, 16, v53
  v_pk_fma_f32 v[220:221], v[128:129], v[98:99], v[220:221]
  v_and_b32 v227, s60, v53
  v_pk_fma_f32 v[222:223], v[136:137], v[106:107], v[222:223]
  v_lshlrev_b32 v228, 16, v54
  v_pk_fma_f32 v[216:217], v[114:115], v[80:81], v[216:217]
  v_and_b32 v229, s60, v54
  v_pk_fma_f32 v[218:219], v[122:123], v[88:89], v[218:219]
  v_lshlrev_b32 v230, 16, v55
  v_pk_fma_f32 v[220:221], v[130:131], v[96:97], v[220:221]
  v_and_b32 v231, s60, v55
  v_pk_fma_f32 v[222:223], v[138:139], v[104:105], v[222:223]
  buffer_load_dwordx4 v[28:31], v5, s[4:7], s27 offen offset:0
  buffer_load_dwordx4 v[48:51], v5, s[8:11], s27 offen offset:0
  v_pk_mul_f32 v[216:217], v[216:217], v[224:225]
  v_pk_mul_f32 v[218:219], v[218:219], v[226:227]
  v_pk_mul_f32 v[220:221], v[220:221], v[228:229]
  v_pk_mul_f32 v[222:223], v[222:223], v[230:231]
  v_cvt_pk_bf16_f32 v144, v208, v216
  v_cvt_pk_bf16_f32 v152, v209, v217
  v_cvt_pk_bf16_f32 v160, v210, v218
  v_cvt_pk_bf16_f32 v168, v211, v219
  v_cvt_pk_bf16_f32 v176, v212, v220
  v_cvt_pk_bf16_f32 v184, v213, v221
  v_cvt_pk_bf16_f32 v192, v214, v222
  v_cvt_pk_bf16_f32 v200, v215, v223
  s_waitcnt vmcnt(12)
  v_lshlrev_b32 v116, 16, v36
  v_pk_mul_f32 v[208:209], v[118:119], v[86:87]
  v_and_b32 v117, s60, v36
  v_pk_mul_f32 v[210:211], v[126:127], v[94:95]
  v_lshlrev_b32 v124, 16, v37
  v_pk_mul_f32 v[212:213], v[134:135], v[102:103]
  v_and_b32 v125, s60, v37
  v_pk_mul_f32 v[214:215], v[142:143], v[110:111]
  v_lshlrev_b32 v132, 16, v38
  v_pk_fma_f32 v[208:209], v[112:113], v[84:85], v[208:209]
  v_and_b32 v133, s60, v38
  v_pk_fma_f32 v[210:211], v[120:121], v[92:93], v[210:211]
  v_lshlrev_b32 v140, 16, v39
  v_pk_fma_f32 v[212:213], v[128:129], v[100:101], v[212:213]
  v_and_b32 v141, s60, v39
  v_pk_fma_f32 v[214:215], v[136:137], v[108:109], v[214:215]
  v_lshlrev_b32 v224, 16, v56
  v_pk_fma_f32 v[208:209], v[114:115], v[82:83], v[208:209]
  v_and_b32 v225, s60, v56
  v_pk_fma_f32 v[210:211], v[122:123], v[90:91], v[210:211]
  v_lshlrev_b32 v226, 16, v57
  v_pk_fma_f32 v[212:213], v[130:131], v[98:99], v[212:213]
  v_and_b32 v227, s60, v57
  v_pk_fma_f32 v[214:215], v[138:139], v[106:107], v[214:215]
  v_lshlrev_b32 v228, 16, v58
  v_pk_fma_f32 v[208:209], v[116:117], v[80:81], v[208:209]
  v_and_b32 v229, s60, v58
  v_pk_fma_f32 v[210:211], v[124:125], v[88:89], v[210:211]
  v_lshlrev_b32 v230, 16, v59
  v_pk_fma_f32 v[212:213], v[132:133], v[96:97], v[212:213]
  v_and_b32 v231, s60, v59
  v_pk_fma_f32 v[214:215], v[140:141], v[104:105], v[214:215]
  buffer_load_dwordx4 v[32:35], v5, s[4:7], s27 offen offset:1152
  buffer_load_dwordx4 v[52:55], v5, s[8:11], s27 offen offset:1152
  v_pk_mul_f32 v[208:209], v[208:209], v[224:225]
  v_pk_mul_f32 v[210:211], v[210:211], v[226:227]
  v_pk_mul_f32 v[212:213], v[212:213], v[228:229]
  v_pk_mul_f32 v[214:215], v[214:215], v[230:231]
  s_waitcnt vmcnt(12)
  v_lshlrev_b32 v118, 16, v40
  v_pk_mul_f32 v[216:217], v[112:113], v[86:87]
  v_and_b32 v119, s60, v40
  v_pk_mul_f32 v[218:219], v[120:121], v[94:95]
  v_lshlrev_b32 v126, 16, v41
  v_pk_mul_f32 v[220:221], v[128:129], v[102:103]
  v_and_b32 v127, s60, v41
  v_pk_mul_f32 v[222:223], v[136:137], v[110:111]
  v_lshlrev_b32 v134, 16, v42
  v_pk_fma_f32 v[216:217], v[114:115], v[84:85], v[216:217]
  v_and_b32 v135, s60, v42
  v_pk_fma_f32 v[218:219], v[122:123], v[92:93], v[218:219]
  v_lshlrev_b32 v142, 16, v43
  v_pk_fma_f32 v[220:221], v[130:131], v[100:101], v[220:221]
  v_and_b32 v143, s60, v43
  v_pk_fma_f32 v[222:223], v[138:139], v[108:109], v[222:223]
  v_lshlrev_b32 v224, 16, v60
  v_pk_fma_f32 v[216:217], v[116:117], v[82:83], v[216:217]
  v_and_b32 v225, s60, v60
  v_pk_fma_f32 v[218:219], v[124:125], v[90:91], v[218:219]
  v_lshlrev_b32 v226, 16, v61
  v_pk_fma_f32 v[220:221], v[132:133], v[98:99], v[220:221]
  v_and_b32 v227, s60, v61
  v_pk_fma_f32 v[222:223], v[140:141], v[106:107], v[222:223]
  v_lshlrev_b32 v228, 16, v62
  v_pk_fma_f32 v[216:217], v[118:119], v[80:81], v[216:217]
  v_and_b32 v229, s60, v62
  v_pk_fma_f32 v[218:219], v[126:127], v[88:89], v[218:219]
  v_lshlrev_b32 v230, 16, v63
  v_pk_fma_f32 v[220:221], v[134:135], v[96:97], v[220:221]
  v_and_b32 v231, s60, v63
  v_pk_fma_f32 v[222:223], v[142:143], v[104:105], v[222:223]
  buffer_load_dwordx4 v[36:39], v5, s[4:7], s27 offen offset:2304
  buffer_load_dwordx4 v[56:59], v5, s[8:11], s27 offen offset:2304
  v_pk_mul_f32 v[216:217], v[216:217], v[224:225]
  v_pk_mul_f32 v[218:219], v[218:219], v[226:227]
  v_pk_mul_f32 v[220:221], v[220:221], v[228:229]
  v_pk_mul_f32 v[222:223], v[222:223], v[230:231]
  v_cvt_pk_bf16_f32 v145, v208, v216
  v_cvt_pk_bf16_f32 v153, v209, v217
  v_cvt_pk_bf16_f32 v161, v210, v218
  v_cvt_pk_bf16_f32 v169, v211, v219
  v_cvt_pk_bf16_f32 v177, v212, v220
  v_cvt_pk_bf16_f32 v185, v213, v221
  v_cvt_pk_bf16_f32 v193, v214, v222
  v_cvt_pk_bf16_f32 v201, v215, v223
  s_waitcnt vmcnt(12)
  v_lshlrev_b32 v112, 16, v44
  v_pk_mul_f32 v[208:209], v[114:115], v[86:87]
  v_and_b32 v113, s60, v44
  v_pk_mul_f32 v[210:211], v[122:123], v[94:95]
  v_lshlrev_b32 v120, 16, v45
  v_pk_mul_f32 v[212:213], v[130:131], v[102:103]
  v_and_b32 v121, s60, v45
  v_pk_mul_f32 v[214:215], v[138:139], v[110:111]
  v_lshlrev_b32 v128, 16, v46
  v_pk_fma_f32 v[208:209], v[116:117], v[84:85], v[208:209]
  v_and_b32 v129, s60, v46
  v_pk_fma_f32 v[210:211], v[124:125], v[92:93], v[210:211]
  v_lshlrev_b32 v136, 16, v47
  v_pk_fma_f32 v[212:213], v[132:133], v[100:101], v[212:213]
  v_and_b32 v137, s60, v47
  v_pk_fma_f32 v[214:215], v[140:141], v[108:109], v[214:215]
  v_lshlrev_b32 v224, 16, v64
  v_pk_fma_f32 v[208:209], v[118:119], v[82:83], v[208:209]
  v_and_b32 v225, s60, v64
  v_pk_fma_f32 v[210:211], v[126:127], v[90:91], v[210:211]
  v_lshlrev_b32 v226, 16, v65
  v_pk_fma_f32 v[212:213], v[134:135], v[98:99], v[212:213]
  v_and_b32 v227, s60, v65
  v_pk_fma_f32 v[214:215], v[142:143], v[106:107], v[214:215]
  v_lshlrev_b32 v228, 16, v66
  v_pk_fma_f32 v[208:209], v[112:113], v[80:81], v[208:209]
  v_and_b32 v229, s60, v66
  v_pk_fma_f32 v[210:211], v[120:121], v[88:89], v[210:211]
  v_lshlrev_b32 v230, 16, v67
  v_pk_fma_f32 v[212:213], v[128:129], v[96:97], v[212:213]
  v_and_b32 v231, s60, v67
  v_pk_fma_f32 v[214:215], v[136:137], v[104:105], v[214:215]
  buffer_load_dwordx4 v[40:43], v5, s[4:7], s27 offen offset:3456
  buffer_load_dwordx4 v[60:63], v5, s[8:11], s27 offen offset:3456
  v_pk_mul_f32 v[208:209], v[208:209], v[224:225]
  v_pk_mul_f32 v[210:211], v[210:211], v[226:227]
  v_pk_mul_f32 v[212:213], v[212:213], v[228:229]
  v_pk_mul_f32 v[214:215], v[214:215], v[230:231]
  s_waitcnt vmcnt(12)
  v_lshlrev_b32 v114, 16, v16
  v_pk_mul_f32 v[216:217], v[116:117], v[86:87]
  v_and_b32 v115, s60, v16
  v_pk_mul_f32 v[218:219], v[124:125], v[94:95]
  v_lshlrev_b32 v122, 16, v17
  v_pk_mul_f32 v[220:221], v[132:133], v[102:103]
  v_and_b32 v123, s60, v17
  v_pk_mul_f32 v[222:223], v[140:141], v[110:111]
  v_lshlrev_b32 v130, 16, v18
  v_pk_fma_f32 v[216:217], v[118:119], v[84:85], v[216:217]
  v_and_b32 v131, s60, v18
  v_pk_fma_f32 v[218:219], v[126:127], v[92:93], v[218:219]
  v_lshlrev_b32 v138, 16, v19
  v_pk_fma_f32 v[220:221], v[134:135], v[100:101], v[220:221]
  v_and_b32 v139, s60, v19
  v_pk_fma_f32 v[222:223], v[142:143], v[108:109], v[222:223]
  v_lshlrev_b32 v224, 16, v68
  v_pk_fma_f32 v[216:217], v[112:113], v[82:83], v[216:217]
  v_and_b32 v225, s60, v68
  v_pk_fma_f32 v[218:219], v[120:121], v[90:91], v[218:219]
  v_lshlrev_b32 v226, 16, v69
  v_pk_fma_f32 v[220:221], v[128:129], v[98:99], v[220:221]
  v_and_b32 v227, s60, v69
  v_pk_fma_f32 v[222:223], v[136:137], v[106:107], v[222:223]
  v_lshlrev_b32 v228, 16, v70
  v_pk_fma_f32 v[216:217], v[114:115], v[80:81], v[216:217]
  v_and_b32 v229, s60, v70
  v_pk_fma_f32 v[218:219], v[122:123], v[88:89], v[218:219]
  v_lshlrev_b32 v230, 16, v71
  v_pk_fma_f32 v[220:221], v[130:131], v[96:97], v[220:221]
  v_and_b32 v231, s60, v71
  v_pk_fma_f32 v[222:223], v[138:139], v[104:105], v[222:223]
  buffer_load_dwordx4 v[44:47], v5, s[4:7], s28 offen offset:0
  buffer_load_dwordx4 v[64:67], v5, s[8:11], s28 offen offset:0
  v_pk_mul_f32 v[216:217], v[216:217], v[224:225]
  v_pk_mul_f32 v[218:219], v[218:219], v[226:227]
  v_pk_mul_f32 v[220:221], v[220:221], v[228:229]
  v_pk_mul_f32 v[222:223], v[222:223], v[230:231]
  v_cvt_pk_bf16_f32 v146, v208, v216
  v_cvt_pk_bf16_f32 v154, v209, v217
  v_cvt_pk_bf16_f32 v162, v210, v218
  v_cvt_pk_bf16_f32 v170, v211, v219
  v_cvt_pk_bf16_f32 v178, v212, v220
  v_cvt_pk_bf16_f32 v186, v213, v221
  v_cvt_pk_bf16_f32 v194, v214, v222
  v_cvt_pk_bf16_f32 v202, v215, v223
  s_waitcnt vmcnt(12)
  v_lshlrev_b32 v116, 16, v20
  v_pk_mul_f32 v[208:209], v[118:119], v[86:87]
  v_and_b32 v117, s60, v20
  v_pk_mul_f32 v[210:211], v[126:127], v[94:95]
  v_lshlrev_b32 v124, 16, v21
  v_pk_mul_f32 v[212:213], v[134:135], v[102:103]
  v_and_b32 v125, s60, v21
  v_pk_mul_f32 v[214:215], v[142:143], v[110:111]
  v_lshlrev_b32 v132, 16, v22
  v_pk_fma_f32 v[208:209], v[112:113], v[84:85], v[208:209]
  v_and_b32 v133, s60, v22
  v_pk_fma_f32 v[210:211], v[120:121], v[92:93], v[210:211]
  v_lshlrev_b32 v140, 16, v23
  v_pk_fma_f32 v[212:213], v[128:129], v[100:101], v[212:213]
  v_and_b32 v141, s60, v23
  v_pk_fma_f32 v[214:215], v[136:137], v[108:109], v[214:215]
  v_lshlrev_b32 v224, 16, v72
  v_pk_fma_f32 v[208:209], v[114:115], v[82:83], v[208:209]
  v_and_b32 v225, s60, v72
  v_pk_fma_f32 v[210:211], v[122:123], v[90:91], v[210:211]
  v_lshlrev_b32 v226, 16, v73
  v_pk_fma_f32 v[212:213], v[130:131], v[98:99], v[212:213]
  v_and_b32 v227, s60, v73
  v_pk_fma_f32 v[214:215], v[138:139], v[106:107], v[214:215]
  v_lshlrev_b32 v228, 16, v74
  v_pk_fma_f32 v[208:209], v[116:117], v[80:81], v[208:209]
  v_and_b32 v229, s60, v74
  v_pk_fma_f32 v[210:211], v[124:125], v[88:89], v[210:211]
  v_lshlrev_b32 v230, 16, v75
  v_pk_fma_f32 v[212:213], v[132:133], v[96:97], v[212:213]
  v_and_b32 v231, s60, v75
  v_pk_fma_f32 v[214:215], v[140:141], v[104:105], v[214:215]
  buffer_load_dwordx4 v[16:19], v5, s[4:7], s28 offen offset:1152
  buffer_load_dwordx4 v[68:71], v5, s[8:11], s28 offen offset:1152
  v_pk_mul_f32 v[208:209], v[208:209], v[224:225]
  v_pk_mul_f32 v[210:211], v[210:211], v[226:227]
  v_pk_mul_f32 v[212:213], v[212:213], v[228:229]
  v_pk_mul_f32 v[214:215], v[214:215], v[230:231]
  s_waitcnt vmcnt(12)
  v_lshlrev_b32 v118, 16, v24
  v_pk_mul_f32 v[216:217], v[112:113], v[86:87]
  v_and_b32 v119, s60, v24
  v_pk_mul_f32 v[218:219], v[120:121], v[94:95]
  v_lshlrev_b32 v126, 16, v25
  v_pk_mul_f32 v[220:221], v[128:129], v[102:103]
  v_and_b32 v127, s60, v25
  v_pk_mul_f32 v[222:223], v[136:137], v[110:111]
  v_lshlrev_b32 v134, 16, v26
  v_pk_fma_f32 v[216:217], v[114:115], v[84:85], v[216:217]
  v_and_b32 v135, s60, v26
  v_pk_fma_f32 v[218:219], v[122:123], v[92:93], v[218:219]
  v_lshlrev_b32 v142, 16, v27
  v_pk_fma_f32 v[220:221], v[130:131], v[100:101], v[220:221]
  v_and_b32 v143, s60, v27
  v_pk_fma_f32 v[222:223], v[138:139], v[108:109], v[222:223]
  v_lshlrev_b32 v224, 16, v76
  v_pk_fma_f32 v[216:217], v[116:117], v[82:83], v[216:217]
  v_and_b32 v225, s60, v76
  v_pk_fma_f32 v[218:219], v[124:125], v[90:91], v[218:219]
  v_lshlrev_b32 v226, 16, v77
  v_pk_fma_f32 v[220:221], v[132:133], v[98:99], v[220:221]
  v_and_b32 v227, s60, v77
  v_pk_fma_f32 v[222:223], v[140:141], v[106:107], v[222:223]
  v_lshlrev_b32 v228, 16, v78
  v_pk_fma_f32 v[216:217], v[118:119], v[80:81], v[216:217]
  v_and_b32 v229, s60, v78
  v_pk_fma_f32 v[218:219], v[126:127], v[88:89], v[218:219]
  v_lshlrev_b32 v230, 16, v79
  v_pk_fma_f32 v[220:221], v[134:135], v[96:97], v[220:221]
  v_and_b32 v231, s60, v79
  v_pk_fma_f32 v[222:223], v[142:143], v[104:105], v[222:223]
  buffer_load_dwordx4 v[20:23], v5, s[4:7], s28 offen offset:2304
  buffer_load_dwordx4 v[72:75], v5, s[8:11], s28 offen offset:2304
  v_pk_mul_f32 v[216:217], v[216:217], v[224:225]
  v_pk_mul_f32 v[218:219], v[218:219], v[226:227]
  v_pk_mul_f32 v[220:221], v[220:221], v[228:229]
  v_pk_mul_f32 v[222:223], v[222:223], v[230:231]
  v_cvt_pk_bf16_f32 v147, v208, v216
  v_cvt_pk_bf16_f32 v155, v209, v217
  v_cvt_pk_bf16_f32 v163, v210, v218
  v_cvt_pk_bf16_f32 v171, v211, v219
  v_cvt_pk_bf16_f32 v179, v212, v220
  v_cvt_pk_bf16_f32 v187, v213, v221
  v_cvt_pk_bf16_f32 v195, v214, v222
  v_cvt_pk_bf16_f32 v203, v215, v223
  ds_write_b128 v8, v[144:147] offset:0
  ds_write_b128 v8, v[152:155] offset:256
  ds_write_b128 v8, v[160:163] offset:512
  ds_write_b128 v8, v[168:171] offset:768
  ds_write_b128 v8, v[176:179] offset:1024
  ds_write_b128 v8, v[184:187] offset:1280
  ds_write_b128 v8, v[192:195] offset:1536
  ds_write_b128 v8, v[200:203] offset:1792
  s_waitcnt vmcnt(12)
  v_lshlrev_b32 v112, 16, v28
  v_pk_mul_f32 v[208:209], v[114:115], v[86:87]
  v_and_b32 v113, s60, v28
  v_pk_mul_f32 v[210:211], v[122:123], v[94:95]
  v_lshlrev_b32 v120, 16, v29
  v_pk_mul_f32 v[212:213], v[130:131], v[102:103]
  v_and_b32 v121, s60, v29
  v_pk_mul_f32 v[214:215], v[138:139], v[110:111]
  v_lshlrev_b32 v128, 16, v30
  v_pk_fma_f32 v[208:209], v[116:117], v[84:85], v[208:209]
  v_and_b32 v129, s60, v30
  v_pk_fma_f32 v[210:211], v[124:125], v[92:93], v[210:211]
  v_lshlrev_b32 v136, 16, v31
  v_pk_fma_f32 v[212:213], v[132:133], v[100:101], v[212:213]
  v_and_b32 v137, s60, v31
  v_pk_fma_f32 v[214:215], v[140:141], v[108:109], v[214:215]
  v_lshlrev_b32 v224, 16, v48
  v_pk_fma_f32 v[208:209], v[118:119], v[82:83], v[208:209]
  v_and_b32 v225, s60, v48
  v_pk_fma_f32 v[210:211], v[126:127], v[90:91], v[210:211]
  v_lshlrev_b32 v226, 16, v49
  v_pk_fma_f32 v[212:213], v[134:135], v[98:99], v[212:213]
  v_and_b32 v227, s60, v49
  v_pk_fma_f32 v[214:215], v[142:143], v[106:107], v[214:215]
  v_lshlrev_b32 v228, 16, v50
  v_pk_fma_f32 v[208:209], v[112:113], v[80:81], v[208:209]
  v_and_b32 v229, s60, v50
  v_pk_fma_f32 v[210:211], v[120:121], v[88:89], v[210:211]
  v_lshlrev_b32 v230, 16, v51
  v_pk_fma_f32 v[212:213], v[128:129], v[96:97], v[212:213]
  v_and_b32 v231, s60, v51
  v_pk_fma_f32 v[214:215], v[136:137], v[104:105], v[214:215]
  buffer_load_dwordx4 v[24:27], v5, s[4:7], s28 offen offset:3456
  buffer_load_dwordx4 v[76:79], v5, s[8:11], s28 offen offset:3456
  buffer_load_dword v13, v15, s[32:35], 0 offen offset:104 sc1
  s_barrier
  v_pk_mul_f32 v[208:209], v[208:209], v[224:225]
  v_pk_mul_f32 v[210:211], v[210:211], v[226:227]
  v_pk_mul_f32 v[212:213], v[212:213], v[228:229]
  v_pk_mul_f32 v[214:215], v[214:215], v[230:231]
  s_waitcnt vmcnt(13)
  v_lshlrev_b32 v114, 16, v32
  v_pk_mul_f32 v[216:217], v[116:117], v[86:87]
  v_and_b32 v115, s60, v32
  v_pk_mul_f32 v[218:219], v[124:125], v[94:95]
  v_lshlrev_b32 v122, 16, v33
  v_pk_mul_f32 v[220:221], v[132:133], v[102:103]
  v_and_b32 v123, s60, v33
  v_pk_mul_f32 v[222:223], v[140:141], v[110:111]
  v_lshlrev_b32 v130, 16, v34
  v_pk_fma_f32 v[216:217], v[118:119], v[84:85], v[216:217]
  v_and_b32 v131, s60, v34
  v_pk_fma_f32 v[218:219], v[126:127], v[92:93], v[218:219]
  v_lshlrev_b32 v138, 16, v35
  v_pk_fma_f32 v[220:221], v[134:135], v[100:101], v[220:221]
  v_and_b32 v139, s60, v35
  v_pk_fma_f32 v[222:223], v[142:143], v[108:109], v[222:223]
  v_lshlrev_b32 v224, 16, v52
  v_pk_fma_f32 v[216:217], v[112:113], v[82:83], v[216:217]
  v_and_b32 v225, s60, v52
  v_pk_fma_f32 v[218:219], v[120:121], v[90:91], v[218:219]
  v_lshlrev_b32 v226, 16, v53
  v_pk_fma_f32 v[220:221], v[128:129], v[98:99], v[220:221]
  v_and_b32 v227, s60, v53
  v_pk_fma_f32 v[222:223], v[136:137], v[106:107], v[222:223]
  v_lshlrev_b32 v228, 16, v54
  v_pk_fma_f32 v[216:217], v[114:115], v[80:81], v[216:217]
  v_and_b32 v229, s60, v54
  v_pk_fma_f32 v[218:219], v[122:123], v[88:89], v[218:219]
  v_lshlrev_b32 v230, 16, v55
  v_pk_fma_f32 v[220:221], v[130:131], v[96:97], v[220:221]
  v_and_b32 v231, s60, v55
  v_pk_fma_f32 v[222:223], v[138:139], v[104:105], v[222:223]
  v_pk_mul_f32 v[216:217], v[216:217], v[224:225]
  v_pk_mul_f32 v[218:219], v[218:219], v[226:227]
  v_pk_mul_f32 v[220:221], v[220:221], v[228:229]
  v_pk_mul_f32 v[222:223], v[222:223], v[230:231]
  v_cvt_pk_bf16_f32 v148, v208, v216
  v_cvt_pk_bf16_f32 v156, v209, v217
  v_cvt_pk_bf16_f32 v164, v210, v218
  v_cvt_pk_bf16_f32 v172, v211, v219
  v_cvt_pk_bf16_f32 v180, v212, v220
  v_cvt_pk_bf16_f32 v188, v213, v221
  v_cvt_pk_bf16_f32 v196, v214, v222
  v_cvt_pk_bf16_f32 v204, v215, v223
  s_waitcnt vmcnt(11)
  v_lshlrev_b32 v116, 16, v36
  v_pk_mul_f32 v[208:209], v[118:119], v[86:87]
  v_and_b32 v117, s60, v36
  v_pk_mul_f32 v[210:211], v[126:127], v[94:95]
  v_lshlrev_b32 v124, 16, v37
  v_pk_mul_f32 v[212:213], v[134:135], v[102:103]
  v_and_b32 v125, s60, v37
  v_pk_mul_f32 v[214:215], v[142:143], v[110:111]
  v_lshlrev_b32 v132, 16, v38
  v_pk_fma_f32 v[208:209], v[112:113], v[84:85], v[208:209]
  v_and_b32 v133, s60, v38
  v_pk_fma_f32 v[210:211], v[120:121], v[92:93], v[210:211]
  v_lshlrev_b32 v140, 16, v39
  v_pk_fma_f32 v[212:213], v[128:129], v[100:101], v[212:213]
  v_and_b32 v141, s60, v39
  v_pk_fma_f32 v[214:215], v[136:137], v[108:109], v[214:215]
  v_lshlrev_b32 v224, 16, v56
  v_pk_fma_f32 v[208:209], v[114:115], v[82:83], v[208:209]
  v_and_b32 v225, s60, v56
  v_pk_fma_f32 v[210:211], v[122:123], v[90:91], v[210:211]
  v_lshlrev_b32 v226, 16, v57
  v_pk_fma_f32 v[212:213], v[130:131], v[98:99], v[212:213]
  v_and_b32 v227, s60, v57
  v_pk_fma_f32 v[214:215], v[138:139], v[106:107], v[214:215]
  v_lshlrev_b32 v228, 16, v58
  v_pk_fma_f32 v[208:209], v[116:117], v[80:81], v[208:209]
  v_and_b32 v229, s60, v58
  v_pk_fma_f32 v[210:211], v[124:125], v[88:89], v[210:211]
  v_lshlrev_b32 v230, 16, v59
  v_pk_fma_f32 v[212:213], v[132:133], v[96:97], v[212:213]
  v_and_b32 v231, s60, v59
  v_pk_fma_f32 v[214:215], v[140:141], v[104:105], v[214:215]
  v_pk_mul_f32 v[208:209], v[208:209], v[224:225]
  v_pk_mul_f32 v[210:211], v[210:211], v[226:227]
  v_pk_mul_f32 v[212:213], v[212:213], v[228:229]
  v_pk_mul_f32 v[214:215], v[214:215], v[230:231]
  s_waitcnt vmcnt(9)
  v_lshlrev_b32 v118, 16, v40
  v_pk_mul_f32 v[216:217], v[112:113], v[86:87]
  v_and_b32 v119, s60, v40
  v_pk_mul_f32 v[218:219], v[120:121], v[94:95]
  v_lshlrev_b32 v126, 16, v41
  v_pk_mul_f32 v[220:221], v[128:129], v[102:103]
  v_and_b32 v127, s60, v41
  v_pk_mul_f32 v[222:223], v[136:137], v[110:111]
  v_lshlrev_b32 v134, 16, v42
  v_pk_fma_f32 v[216:217], v[114:115], v[84:85], v[216:217]
  v_and_b32 v135, s60, v42
  v_pk_fma_f32 v[218:219], v[122:123], v[92:93], v[218:219]
  v_lshlrev_b32 v142, 16, v43
  v_pk_fma_f32 v[220:221], v[130:131], v[100:101], v[220:221]
  v_and_b32 v143, s60, v43
  v_pk_fma_f32 v[222:223], v[138:139], v[108:109], v[222:223]
  v_lshlrev_b32 v224, 16, v60
  v_pk_fma_f32 v[216:217], v[116:117], v[82:83], v[216:217]
  v_and_b32 v225, s60, v60
  v_pk_fma_f32 v[218:219], v[124:125], v[90:91], v[218:219]
  v_lshlrev_b32 v226, 16, v61
  v_pk_fma_f32 v[220:221], v[132:133], v[98:99], v[220:221]
  v_and_b32 v227, s60, v61
  v_pk_fma_f32 v[222:223], v[140:141], v[106:107], v[222:223]
  v_lshlrev_b32 v228, 16, v62
  v_pk_fma_f32 v[216:217], v[118:119], v[80:81], v[216:217]
  v_and_b32 v229, s60, v62
  v_pk_fma_f32 v[218:219], v[126:127], v[88:89], v[218:219]
  v_lshlrev_b32 v230, 16, v63
  v_pk_fma_f32 v[220:221], v[134:135], v[96:97], v[220:221]
  v_and_b32 v231, s60, v63
  v_pk_fma_f32 v[222:223], v[142:143], v[104:105], v[222:223]
  v_pk_mul_f32 v[216:217], v[216:217], v[224:225]
  v_pk_mul_f32 v[218:219], v[218:219], v[226:227]
  v_pk_mul_f32 v[220:221], v[220:221], v[228:229]
  v_pk_mul_f32 v[222:223], v[222:223], v[230:231]
  v_cvt_pk_bf16_f32 v149, v208, v216
  v_cvt_pk_bf16_f32 v157, v209, v217
  v_cvt_pk_bf16_f32 v165, v210, v218
  v_cvt_pk_bf16_f32 v173, v211, v219
  v_cvt_pk_bf16_f32 v181, v212, v220
  v_cvt_pk_bf16_f32 v189, v213, v221
  v_cvt_pk_bf16_f32 v197, v214, v222
  v_cvt_pk_bf16_f32 v205, v215, v223
  s_waitcnt vmcnt(7)
  v_lshlrev_b32 v112, 16, v44
  v_pk_mul_f32 v[208:209], v[114:115], v[86:87]
  v_and_b32 v113, s60, v44
  v_pk_mul_f32 v[210:211], v[122:123], v[94:95]
  v_lshlrev_b32 v120, 16, v45
  v_pk_mul_f32 v[212:213], v[130:131], v[102:103]
  v_and_b32 v121, s60, v45
  v_pk_mul_f32 v[214:215], v[138:139], v[110:111]
  v_lshlrev_b32 v128, 16, v46
  v_pk_fma_f32 v[208:209], v[116:117], v[84:85], v[208:209]
  v_and_b32 v129, s60, v46
  v_pk_fma_f32 v[210:211], v[124:125], v[92:93], v[210:211]
  v_lshlrev_b32 v136, 16, v47
  v_pk_fma_f32 v[212:213], v[132:133], v[100:101], v[212:213]
  v_and_b32 v137, s60, v47
  v_pk_fma_f32 v[214:215], v[140:141], v[108:109], v[214:215]
  v_lshlrev_b32 v224, 16, v64
  v_pk_fma_f32 v[208:209], v[118:119], v[82:83], v[208:209]
  v_and_b32 v225, s60, v64
  v_pk_fma_f32 v[210:211], v[126:127], v[90:91], v[210:211]
  v_lshlrev_b32 v226, 16, v65
  v_pk_fma_f32 v[212:213], v[134:135], v[98:99], v[212:213]
  v_and_b32 v227, s60, v65
  v_pk_fma_f32 v[214:215], v[142:143], v[106:107], v[214:215]
  v_lshlrev_b32 v228, 16, v66
  v_pk_fma_f32 v[208:209], v[112:113], v[80:81], v[208:209]
  v_and_b32 v229, s60, v66
  v_pk_fma_f32 v[210:211], v[120:121], v[88:89], v[210:211]
  v_lshlrev_b32 v230, 16, v67
  v_pk_fma_f32 v[212:213], v[128:129], v[96:97], v[212:213]
  v_and_b32 v231, s60, v67
  v_pk_fma_f32 v[214:215], v[136:137], v[104:105], v[214:215]
  v_pk_mul_f32 v[208:209], v[208:209], v[224:225]
  v_pk_mul_f32 v[210:211], v[210:211], v[226:227]
  v_pk_mul_f32 v[212:213], v[212:213], v[228:229]
  v_pk_mul_f32 v[214:215], v[214:215], v[230:231]
  s_waitcnt vmcnt(5)
  v_lshlrev_b32 v114, 16, v16
  v_pk_mul_f32 v[216:217], v[116:117], v[86:87]
  v_and_b32 v115, s60, v16
  v_pk_mul_f32 v[218:219], v[124:125], v[94:95]
  v_lshlrev_b32 v122, 16, v17
  v_pk_mul_f32 v[220:221], v[132:133], v[102:103]
  v_and_b32 v123, s60, v17
  v_pk_mul_f32 v[222:223], v[140:141], v[110:111]
  v_lshlrev_b32 v130, 16, v18
  v_pk_fma_f32 v[216:217], v[118:119], v[84:85], v[216:217]
  v_and_b32 v131, s60, v18
  v_pk_fma_f32 v[218:219], v[126:127], v[92:93], v[218:219]
  v_lshlrev_b32 v138, 16, v19
  v_pk_fma_f32 v[220:221], v[134:135], v[100:101], v[220:221]
  v_and_b32 v139, s60, v19
  v_pk_fma_f32 v[222:223], v[142:143], v[108:109], v[222:223]
  v_lshlrev_b32 v224, 16, v68
  v_pk_fma_f32 v[216:217], v[112:113], v[82:83], v[216:217]
  v_and_b32 v225, s60, v68
  v_pk_fma_f32 v[218:219], v[120:121], v[90:91], v[218:219]
  v_lshlrev_b32 v226, 16, v69
  v_pk_fma_f32 v[220:221], v[128:129], v[98:99], v[220:221]
  v_and_b32 v227, s60, v69
  v_pk_fma_f32 v[222:223], v[136:137], v[106:107], v[222:223]
  v_lshlrev_b32 v228, 16, v70
L_cw0:
  s_cbranch_execz L_cw1
  v_pk_fma_f32 v[216:217], v[114:115], v[80:81], v[216:217]
  v_and_b32 v229, s60, v70
  v_pk_fma_f32 v[218:219], v[122:123], v[88:89], v[218:219]
  v_lshlrev_b32 v230, 16, v71
  v_pk_fma_f32 v[220:221], v[130:131], v[96:97], v[220:221]
  v_and_b32 v231, s60, v71
  v_pk_fma_f32 v[222:223], v[138:139], v[104:105], v[222:223]
  v_pk_mul_f32 v[216:217], v[216:217], v[224:225]
  v_pk_mul_f32 v[218:219], v[218:219], v[226:227]
  v_pk_mul_f32 v[220:221], v[220:221], v[228:229]
  v_pk_mul_f32 v[222:223], v[222:223], v[230:231]
  v_cvt_pk_bf16_f32 v150, v208, v216
  v_cvt_pk_bf16_f32 v158, v209, v217
  v_cvt_pk_bf16_f32 v166, v210, v218
  v_cvt_pk_bf16_f32 v174, v211, v219
  v_cvt_pk_bf16_f32 v182, v212, v220
  v_cvt_pk_bf16_f32 v190, v213, v221
  v_cvt_pk_bf16_f32 v198, v214, v222
  v_cvt_pk_bf16_f32 v206, v215, v223
  s_waitcnt vmcnt(3)
  v_lshlrev_b32 v116, 16, v20
  v_pk_mul_f32 v[208:209], v[118:119], v[86:87]
  v_and_b32 v117, s60, v20
  v_pk_mul_f32 v[210:211], v[126:127], v[94:95]
  v_lshlrev_b32 v124, 16, v21
  v_pk_mul_f32 v[212:213], v[134:135], v[102:103]
  v_and_b32 v125, s60, v21
  v_pk_mul_f32 v[214:215], v[142:143], v[110:111]
  v_lshlrev_b32 v132, 16, v22
  v_pk_fma_f32 v[208:209], v[112:113], v[84:85], v[208:209]
  v_and_b32 v133, s60, v22
  v_pk_fma_f32 v[210:211], v[120:121], v[92:93], v[210:211]
  v_lshlrev_b32 v140, 16, v23
  v_pk_fma_f32 v[212:213], v[128:129], v[100:101], v[212:213]
  v_and_b32 v141, s60, v23
  v_pk_fma_f32 v[214:215], v[136:137], v[108:109], v[214:215]
  v_lshlrev_b32 v224, 16, v72
  v_pk_fma_f32 v[208:209], v[114:115], v[82:83], v[208:209]
  v_and_b32 v225, s60, v72
  v_pk_fma_f32 v[210:211], v[122:123], v[90:91], v[210:211]
  v_lshlrev_b32 v226, 16, v73
  v_pk_fma_f32 v[212:213], v[130:131], v[98:99], v[212:213]
  v_and_b32 v227, s60, v73
  v_pk_fma_f32 v[214:215], v[138:139], v[106:107], v[214:215]
  v_lshlrev_b32 v228, 16, v74
  v_pk_fma_f32 v[208:209], v[116:117], v[80:81], v[208:209]
  v_and_b32 v229, s60, v74
  v_pk_fma_f32 v[210:211], v[124:125], v[88:89], v[210:211]
  v_lshlrev_b32 v230, 16, v75
  v_pk_fma_f32 v[212:213], v[132:133], v[96:97], v[212:213]
  v_and_b32 v231, s60, v75
  v_pk_fma_f32 v[214:215], v[140:141], v[104:105], v[214:215]
  v_pk_mul_f32 v[208:209], v[208:209], v[224:225]
  v_pk_mul_f32 v[210:211], v[210:211], v[226:227]
  v_pk_mul_f32 v[212:213], v[212:213], v[228:229]
  v_pk_mul_f32 v[214:215], v[214:215], v[230:231]
  s_waitcnt vmcnt(1)
  v_lshlrev_b32 v118, 16, v24
  v_pk_mul_f32 v[216:217], v[112:113], v[86:87]
  v_and_b32 v119, s60, v24
  v_pk_mul_f32 v[218:219], v[120:121], v[94:95]
  v_lshlrev_b32 v126, 16, v25
  v_pk_mul_f32 v[220:221], v[128:129], v[102:103]
  v_and_b32 v127, s60, v25
  v_pk_mul_f32 v[222:223], v[136:137], v[110:111]
  v_lshlrev_b32 v134, 16, v26
  v_pk_fma_f32 v[216:217], v[114:115], v[84:85], v[216:217]
  v_and_b32 v135, s60, v26
  v_pk_fma_f32 v[218:219], v[122:123], v[92:93], v[218:219]
  v_lshlrev_b32 v142, 16, v27
  v_pk_fma_f32 v[220:221], v[130:131], v[100:101], v[220:221]
  v_and_b32 v143, s60, v27
  v_pk_fma_f32 v[222:223], v[138:139], v[108:109], v[222:223]
  v_lshlrev_b32 v224, 16, v76
  v_pk_fma_f32 v[216:217], v[116:117], v[82:83], v[216:217]
  v_and_b32 v225, s60, v76
  v_pk_fma_f32 v[218:219], v[124:125], v[90:91], v[218:219]
  v_lshlrev_b32 v226, 16, v77
  v_pk_fma_f32 v[220:221], v[132:133], v[98:99], v[220:221]
  v_and_b32 v227, s60, v77
  v_pk_fma_f32 v[222:223], v[140:141], v[106:107], v[222:223]
  v_lshlrev_b32 v228, 16, v78
  v_pk_fma_f32 v[216:217], v[118:119], v[80:81], v[216:217]
  v_and_b32 v229, s60, v78
  v_pk_fma_f32 v[218:219], v[126:127], v[88:89], v[218:219]
  v_lshlrev_b32 v230, 16, v79
  v_pk_fma_f32 v[220:221], v[134:135], v[96:97], v[220:221]
  v_and_b32 v231, s60, v79
  v_pk_fma_f32 v[222:223], v[142:143], v[104:105], v[222:223]
  v_pk_mul_f32 v[216:217], v[216:217], v[224:225]
  v_pk_mul_f32 v[218:219], v[218:219], v[226:227]
  v_pk_mul_f32 v[220:221], v[220:221], v[228:229]
  v_pk_mul_f32 v[222:223], v[222:223], v[230:231]
  v_cvt_pk_bf16_f32 v151, v208, v216
  v_cvt_pk_bf16_f32 v159, v209, v217
  v_cvt_pk_bf16_f32 v167, v210, v218
  v_cvt_pk_bf16_f32 v175, v211, v219
  v_cvt_pk_bf16_f32 v183, v212, v220
  v_cvt_pk_bf16_f32 v191, v213, v221
  v_cvt_pk_bf16_f32 v199, v214, v222
  v_cvt_pk_bf16_f32 v207, v215, v223
  ds_write_b128 v9, v[148:151] offset:0
  ds_write_b128 v9, v[156:159] offset:256
  ds_write_b128 v9, v[164:167] offset:512
  ds_write_b128 v9, v[172:175] offset:768
  ds_write_b128 v9, v[180:183] offset:1024
  ds_write_b128 v9, v[188:191] offset:1280
  ds_write_b128 v9, v[196:199] offset:1536
  ds_write_b128 v9, v[204:207] offset:1792
  s_waitcnt lgkmcnt(0)
  ds_read_b128 v[16:19], v10 offset:0
  ds_read_b128 v[20:23], v10 offset:1024
  ds_read_b128 v[24:27], v10 offset:2048
  ds_read_b128 v[28:31], v10 offset:3072
  ds_read_b128 v[32:35], v10 offset:4096
  ds_read_b128 v[36:39], v10 offset:5120
  ds_read_b128 v[40:43], v10 offset:6144
  ds_read_b128 v[44:47], v10 offset:7168
  ds_read_b128 v[48:51], v10 offset:8192
  ds_read_b128 v[52:55], v10 offset:9216
  ds_read_b128 v[56:59], v10 offset:10240
  ds_read_b128 v[60:63], v10 offset:11264
  ds_read_b128 v[64:67], v10 offset:12288
  ds_read_b128 v[68:71], v10 offset:13312
  ds_read_b128 v[72:75], v10 offset:14336
  ds_read_b128 v[76:79], v10 offset:15360
  v_xor_b32 v12, 0, v11
  s_waitcnt lgkmcnt(15)
  buffer_store_dwordx4 v[16:19], v12, s[44:47], s68 offen sc1
  s_add_u32 s68, s68, 16384
  s_waitcnt lgkmcnt(14)
  buffer_store_dwordx4 v[20:23], v12, s[44:47], s68 offen sc1
  s_add_u32 s68, s68, 16384
  v_xor_b32 v12, 16, v11
  s_waitcnt lgkmcnt(13)
  buffer_store_dwordx4 v[24:27], v12, s[44:47], s68 offen sc1
  s_add_u32 s68, s68, 16384
  s_waitcnt lgkmcnt(12)
  buffer_store_dwordx4 v[28:31], v12, s[44:47], s68 offen sc1
  s_add_u32 s68, s68, 16384
  v_xor_b32 v12, 32, v11
  s_waitcnt lgkmcnt(11)
  buffer_store_dwordx4 v[32:35], v12, s[44:47], s68 offen sc1
  s_add_u32 s68, s68, 16384
  s_waitcnt lgkmcnt(10)
  buffer_store_dwordx4 v[36:39], v12, s[44:47], s68 offen sc1
  s_add_u32 s68, s68, 16384
  v_xor_b32 v12, 48, v11
  s_waitcnt lgkmcnt(9)
  buffer_store_dwordx4 v[40:43], v12, s[44:47], s68 offen sc1
  s_add_u32 s68, s68, 16384
  s_waitcnt lgkmcnt(8)
  buffer_store_dwordx4 v[44:47], v12, s[44:47], s68 offen sc1
  s_add_u32 s68, s68, 16384
  v_xor_b32 v12, 64, v11
  s_waitcnt lgkmcnt(7)
  buffer_store_dwordx4 v[48:51], v12, s[44:47], s68 offen sc1
  s_add_u32 s68, s68, 16384
  s_waitcnt lgkmcnt(6)
  buffer_store_dwordx4 v[52:55], v12, s[44:47], s68 offen sc1
  s_add_u32 s68, s68, 16384
  v_xor_b32 v12, 80, v11
  s_waitcnt lgkmcnt(5)
  buffer_store_dwordx4 v[56:59], v12, s[44:47], s68 offen sc1
  s_add_u32 s68, s68, 16384
  s_waitcnt lgkmcnt(4)
  buffer_store_dwordx4 v[60:63], v12, s[44:47], s68 offen sc1
  s_add_u32 s68, s68, 16384
  v_xor_b32 v12, 96, v11
  s_waitcnt lgkmcnt(3)
  buffer_store_dwordx4 v[64:67], v12, s[44:47], s68 offen sc1
  s_add_u32 s68, s68, 16384
  s_waitcnt lgkmcnt(2)
  buffer_store_dwordx4 v[68:71], v12, s[44:47], s68 offen sc1
  s_add_u32 s68, s68, 16384
  v_xor_b32 v12, 112, v11
  s_waitcnt lgkmcnt(1)
  buffer_store_dwordx4 v[72:75], v12, s[44:47], s68 offen sc1
  s_add_u32 s68, s68, 16384
  s_waitcnt lgkmcnt(0)
  buffer_store_dwordx4 v[76:79], v12, s[44:47], s68 offen sc1
  v_mov_b32 v14, 1
  s_waitcnt vmcnt(0)
  v_cmp_gt_u32 vcc, 1, v13
  s_cbranch_vccnz L_slow_c1rdy
L_poll_c1rdy_ok:
  s_mov_b64 exec, 1
  buffer_store_dword v14, off, s[44:47], s69 sc1
  s_mov_b64 exec, -1
  s_barrier
L_c_join:
  s_mul_i32 s66, s64, 12
  s_add_u32 s66, s66, s20
  s_lshl_b32 s68, s66, 1
  s_and_b32 s68, s68, 0xfffffffc
  s_add_u32 s54, s54, s68
  s_addc_u32 s55, s55, 0
  s_load_dword s56, s[54:55], 0
  s_load_dword s57, s[54:55], 8
  s_load_dword s21, s[54:55], 16
  s_mov_b32 s28, s52
  s_mov_b32 s29, s53
  s_mov_b32 s30, 2359296
  s_mov_b32 s31, 0x20000
  v_lshlrev_b32 v15, 4, v1
  s_lshl_b32 s65, s66, 12
  s_mul_i32 s69, s20, 4128
  s_add_u32 s69, s69, 52256
  s_mov_b32 m0, s69
  s_add_u32 s67, s65, 21565440
  buffer_load_dwordx4 v15, s[28:31], s65 offen offset:0 lds
  buffer_load_dwordx4 v15, s[28:31], s65 offen offset:1024 lds
  buffer_load_dwordx4 v15, s[28:31], s65 offen offset:2048 lds
  buffer_load_dwordx4 v15, s[28:31], s65 offen offset:3072 lds
  s_mul_i32 s68, s20, 4352
  s_add_u32 s68, s68, 256
  v_lshrrev_b32 v8, 4, v1
  v_bfe_u32 v9, v1, 2, 2
  v_and_b32 v10, 3, v1
  v_lshl_add_u32 v8, v8, 3, v9
  v_lshlrev_b32 v8, 3, v8
  v_lshlrev_b32 v11, 5, v10
  v_sub_u32 v11, v11, v8
  s_sub_u32 s70, s68, 8
  v_add_u32 v2, s70, v11
  s_sub_u32 s70, s69, 24
  v_lshl_add_u32 v11, v10, 3, v8
  v_add_u32 v3, s70, v11
  v_lshl_add_u32 v4, v1, 1, s68
  s_lshl_b32 s71, s20, 1
  s_add_u32 s71, s71, 101760
  v_lshl_add_u32 v5, v1, 3, s71
  s_lshl_b32 s62, s63, 2
  s_add_u32 s62, s62, s20
  s_mul_i32 s70, s62, 24
  v_lshrrev_b32 v8, 1, v1
  v_min_u32 v8, 23, v8
  v_add_u32 v8, s70, v8
  v_and_b32 v9, 1, v1
  s_and_b32 s70, s24, 3
  s_lshl_b32 s70, s70, 1
  v_lshlrev_b32 v18, 7, v9
  v_add_u32 v9, s70, v9
  v_mov_b32 v20, v9
  v_mul_u32_u24 v10, 9216, v8
  v_mul_u32_u24 v11, 1152, v9
  v_add_u32 v16, v10, v11
  v_mul_u32_u24 v9, 576, v9
  v_add_u32 v10, v9, v8
  v_mul_u32_u24 v17, 1152, v10
  s_mul_i32 s70, s62, 12
  v_lshrrev_b32 v8, 2, v1
  v_min_u32 v8, 11, v8
  v_add3_u32 v9, v9, v8, s70
  v_mul_u32_u24 v9, 1152, v9
  v_bfe_u32 v21, v1, 1, 1
  s_lshr_b32 s71, s24, 2
  s_mul_i32 s70, s71, 331776
  v_add_u32 v18, s70, v9
  s_sub_u32 s70, 331776, s70
  v_add_u32 v19, s70, v9
  v_add_u32 v200, 1024, v16
  v_add_u32 v201, 1024, v17
  v_add_u32 v8, 1, v21
  v_xor_b32 v8, v8, v20
  v_and_b32 v8, 7, v8
  v_lshl_add_u32 v202, v8, 7, v18
  v_add_u32 v8, 3, v21
  v_xor_b32 v8, v8, v20
  v_and_b32 v8, 7, v8
  v_lshl_add_u32 v203, v8, 7, v18
  v_add_u32 v8, 5, v21
  v_xor_b32 v8, v8, v20
  v_and_b32 v8, 7, v8
  v_lshl_add_u32 v204, v8, 7, v18
  v_add_u32 v8, 7, v21
  v_xor_b32 v8, v8, v20
  v_and_b32 v8, 7, v8
  v_lshl_add_u32 v205, v8, 7, v18
  v_add_u32 v8, 5, v21
  v_xor_b32 v8, v8, v20
  v_and_b32 v8, 7, v8
  v_lshl_add_u32 v206, v8, 7, v19
  v_add_u32 v8, 7, v21
  v_xor_b32 v8, v8, v20
  v_and_b32 v8, 7, v8
  v_lshl_add_u32 v207, v8, 7, v19
  v_mov_b32 v208, 2147483647
  s_mov_b32 s16, s48
  s_mov_b32 s17, s49
  s_mov_b32 s8, s50
  s_mov_b32 s9, s51
  s_mov_b32 s10, 5308416
  s_mov_b32 s11, 0x20000
  s_mul_i32 s70, s64, 384
  v_lshrrev_b32 v6, 3, v0
  v_and_b32 v7, 7, v1
  v_lshlrev_b32 v7, 4, v7
  v_add_u32 v8, 0, v6
  v_mul_u32_u24 v9, 0x5556, v8
  v_lshrrev_b32 v9, 16, v9
  v_mul_u32_u24 v10, 3, v9
  v_sub_u32 v10, v8, v10
  v_mul_u32_u24 v11, 16640, v10
  v_lshl_add_u32 v11, v9, 7, v11
  v_add_u32 v11, 101760, v11
  v_add_u32 v236, v11, v7
  v_mul_u32_u24 v9, 18432, v9
  v_lshl_add_u32 v9, v10, 7, v9
  v_add3_u32 v240, v9, v7, s70
  v_add_u32 v8, 32, v6
  v_mul_u32_u24 v9, 0x5556, v8
  v_lshrrev_b32 v9, 16, v9
  v_mul_u32_u24 v10, 3, v9
  v_sub_u32 v10, v8, v10
  v_mul_u32_u24 v11, 16640, v10
  v_lshl_add_u32 v11, v9, 7, v11
  v_add_u32 v11, 101760, v11
  v_add_u32 v237, v11, v7
  v_mul_u32_u24 v9, 18432, v9
  v_lshl_add_u32 v9, v10, 7, v9
  v_add3_u32 v241, v9, v7, s70
  v_add_u32 v8, 64, v6
  v_mul_u32_u24 v9, 0x5556, v8
  v_lshrrev_b32 v9, 16, v9
  v_mul_u32_u24 v10, 3, v9
  v_sub_u32 v10, v8, v10
  v_mul_u32_u24 v11, 16640, v10
  v_lshl_add_u32 v11, v9, 7, v11
  v_add_u32 v11, 101760, v11
  v_add_u32 v238, v11, v7
  v_mul_u32_u24 v9, 18432, v9
  v_lshl_add_u32 v9, v10, 7, v9
  v_add3_u32 v242, v9, v7, s70
  v_add_u32 v239, 2359296, v240
  v_bfe_u32 v8, v1, 4, 1
  v_mad_u32_u24 v8, v8, 11, s66
  v_lshrrev_b32 v8, 6, v8
  v_lshlrev_b32 v8, 7, v8
  v_and_b32 v9, 15, v1
  v_lshl_add_u32 v8, v9, 2, v8
  v_add_u32 v8, 23967744, v8
  s_cmp_lg_u32 s20, 0
  s_cbranch_scc1 L_poll_cu_ok
  s_mov_b32 s71, 0
L_poll_cu:
  buffer_load_dword v9, v8, s[44:47], 0 offen offset:0 sc1
  s_add_u32 s71, s71, 1
  s_cmp_gt_u32 s71, 0x200000
  s_cbranch_scc1 L_poll_cu_ok
  s_waitcnt vmcnt(0)
  v_cmp_gt_u32 vcc, 1, v9
  s_cbranch_vccz L_poll_cu_ok
  s_sleep 2
  s_branch L_poll_cu
L_poll_cu_ok:
  s_barrier
  s_mov_b32 m0, s68
  s_nop 0
  buffer_load_dwordx4 v15, s[44:47], s67 offen offset:0 sc1 lds
  buffer_load_dwordx4 v15, s[44:47], s67 offen offset:1024 sc1 lds
  buffer_load_dwordx4 v15, s[44:47], s67 offen offset:2048 sc1 lds
  buffer_load_dwordx4 v15, s[44:47], s67 offen offset:3072 sc1 lds
  s_and_b32 s70, s66, 1
  s_lshl_b32 s70, s70, 4
  s_mov_b32 s62, 0
  s_mov_b32 s63, 0x80000000
  s_mov_b32 s22, 3
  s_mov_b32 s12, s44
  s_mov_b32 s13, s45
  s_mov_b32 s14, 24182784
  s_mov_b32 s15, 0x20000
  s_add_u32 s4, s44, 19169280
  s_addc_u32 s5, s45, 0
  s_mov_b32 s6, 0
  s_mov_b32 s7, 0x20000
  v_lshrrev_b32 v8, 3, v0
  v_mul_u32_u24 v8, 18432, v8
  v_and_b32 v9, 7, v1
  v_lshl_add_u32 v8, v9, 4, v8
  s_mul_i32 s71, s64, 384
  v_add_u32 v13, s71, v8
  v_add_u32 v14, 2359296, v13
  v_lshlrev_b32 v8, 4, v0
  v_add_u32 v12, 85120, v8
  s_mov_b32 s38, 0
  s_mov_b32 s39, 589824
  s_mov_b32 s40, 1179648
  s_mov_b32 s41, 1769472
  s_mov_b32 s42, 0
  s_waitcnt lgkmcnt(0)
  s_lshr_b32 s56, s56, s70
  s_lshr_b32 s57, s57, s70
  s_lshr_b32 s21, s21, s70
  v_mov_b32 v76, 0
  v_mov_b32 v77, 0
  v_mov_b32 v78, 0
  v_mov_b32 v79, 0
  v_mov_b32 v80, 0
  v_mov_b32 v81, 0
  v_mov_b32 v82, 0
  v_mov_b32 v83, 0
  v_mov_b32 v84, 0
  v_mov_b32 v85, 0
  v_mov_b32 v86, 0
  v_mov_b32 v87, 0
  v_mov_b32 v72, 0
  v_add_u32 v93, 8, v5
  s_waitcnt vmcnt(0)
  s_barrier
  ds_read_b64_tr_b16 a[0:1], v2 offset:32
  ds_read_b64_tr_b16 a[2:3], v2 offset:0
  ds_read_b64_tr_b16 a[128:129], v3 offset:0
  ds_read_b64_tr_b16 a[130:131], v3 offset:32
  ds_read_b64_tr_b16 a[4:5], v2 offset:160
  ds_read_b64_tr_b16 a[6:7], v2 offset:128
  ds_read_b64_tr_b16 a[8:9], v2 offset:288
  ds_read_b64_tr_b16 a[10:11], v2 offset:256
  ds_read_b64_tr_b16 a[132:133], v3 offset:256
  ds_read_b64_tr_b16 a[134:135], v3 offset:288
  ds_read_b64_tr_b16 a[12:13], v2 offset:416
  ds_read_b64_tr_b16 a[14:15], v2 offset:384
L_cloop:
  s_waitcnt lgkmcnt(8)
  v_mfma_f32_16x16x32_bf16 v[16:19], a[0:3], a[128:131], 0
  s_waitcnt lgkmcnt(6)
  ds_read_b64_tr_b16 a[16:17], v2 offset:544
  v_mfma_f32_16x16x32_bf16 v[20:23], a[4:7], a[128:131], 0
  s_waitcnt lgkmcnt(3)
  ds_read_b64_tr_b16 a[18:19], v2 offset:512
  ds_read_b64_tr_b16 a[136:137], v3 offset:512
  v_mfma_f32_16x16x32_bf16 v[24:27], a[8:11], a[128:131], 0
  s_lshl_b32 s61, s56, 16
  buffer_load_dword v253, v200, s[16:19], 0 offen
  v_mfma_f32_16x16x32_bf16 v[24:27], a[0:3], a[132:135], v[24:27]
  s_waitcnt lgkmcnt(3)
  ds_read_b64_tr_b16 a[138:139], v3 offset:544
  ds_read_b64_tr_b16 a[20:21], v2 offset:672
  v_mfma_f32_16x16x32_bf16 v[28:31], a[12:15], a[128:131], 0
  s_mov_b32 s56, s57
  ds_read_b64_tr_b16 a[22:23], v2 offset:640
  ds_read_b64_tr_b16 a[24:25], v2 offset:800
  v_mfma_f32_16x16x32_bf16 v[28:31], a[4:7], a[132:135], v[28:31]
  s_waitcnt lgkmcnt(3)
  ds_read_b64_tr_b16 a[26:27], v2 offset:768
  ds_read_b64_tr_b16 a[140:141], v3 offset:768
  v_mfma_f32_16x16x32_bf16 v[32:35], a[16:19], a[128:131], 0
  s_mov_b32 s57, s21
  ds_read_b64_tr_b16 a[142:143], v3 offset:800
  ds_read_b64_tr_b16 a[28:29], v2 offset:928
  v_mfma_f32_16x16x32_bf16 v[32:35], a[8:11], a[132:135], v[32:35]
  s_add_u32 s65, s65, 16384
  ds_read_b64_tr_b16 a[30:31], v2 offset:896
  ds_read_b64_tr_b16 a[32:33], v2 offset:1056
  v_mfma_f32_16x16x32_bf16 v[32:35], a[0:3], a[136:139], v[32:35]
  s_waitcnt lgkmcnt(7)
  ds_read_b64_tr_b16 a[34:35], v2 offset:1024
  v_cndmask_b32 v68, v19, v72, s[62:63]
  v_mfma_f32_16x16x32_bf16 v[36:39], a[20:23], a[128:131], 0
  s_add_u32 s67, s67, 16384
  ds_read_b64_tr_b16 a[144:145], v3 offset:1024
  ds_read_b64_tr_b16 a[146:147], v3 offset:1056
  v_mfma_f32_16x16x32_bf16 v[36:39], a[12:15], a[132:135], v[36:39]
  s_cmp_eq_u32 s22, 1
  s_cselect_b32 s30, 0, s30
  ds_read_b64_tr_b16 a[36:37], v2 offset:1184
  v_add_f32_dpp v64, v68, v18 wave_ror:1 row_mask:0xf bank_mask:0xf
  v_mfma_f32_16x16x32_bf16 v[36:39], a[4:7], a[136:139], v[36:39]
  s_waitcnt lgkmcnt(7)
  ds_read_b64_tr_b16 a[38:39], v2 offset:1152
  v_cndmask_b32 v68, v64, v72, s[62:63]
  v_mfma_f32_16x16x32_bf16 v[40:43], a[24:27], a[128:131], 0
  s_cmp_eq_u32 s22, 1
  s_cselect_b32 s14, 0, s14
  ds_read_b64_tr_b16 a[40:41], v2 offset:1312
  v_add_f32_dpp v66, v68, v17 wave_ror:1 row_mask:0xf bank_mask:0xf
  v_mfma_f32_16x16x32_bf16 v[40:43], a[16:19], a[132:135], v[40:43]
  s_cmp_eq_u32 s22, 1
  s_cselect_b32 s70, -1, 1
  ds_read_b64_tr_b16 a[42:43], v2 offset:1280
  v_cndmask_b32 v68, v66, v72, s[62:63]
  v_mfma_f32_16x16x32_bf16 v[40:43], a[8:11], a[136:139], v[40:43]
  s_mul_i32 s71, s70, 16512
  ds_read_b64_tr_b16 a[148:149], v3 offset:1280
  v_add_f32_dpp v70, v68, v16 wave_ror:1 row_mask:0xf bank_mask:0xf
  v_mfma_f32_16x16x32_bf16 v[40:43], a[0:3], a[140:143], v[40:43]
  s_waitcnt lgkmcnt(9)
  ds_read_b64_tr_b16 a[150:151], v3 offset:1312
  v_cndmask_b32 v69, v23, v19, s[62:63]
  v_mfma_f32_16x16x32_bf16 v[44:47], a[28:31], a[128:131], 0
  s_add_u32 s69, s69, s71
  ds_read_b64_tr_b16 a[44:45], v2 offset:1440
  v_add_f32_dpp v65, v69, v22 wave_ror:1 row_mask:0xf bank_mask:0xf
  v_mfma_f32_16x16x32_bf16 v[44:47], a[20:23], a[132:135], v[44:47]
  s_mul_i32 s71, s70, 17408
  ds_read_b64_tr_b16 a[46:47], v2 offset:1408
  v_cndmask_b32 v69, v65, v64, s[62:63]
  v_mfma_f32_16x16x32_bf16 v[44:47], a[12:15], a[136:139], v[44:47]
  s_add_u32 s68, s68, s71
  ds_read_u16_d16_hi v76, v4 offset:0
  v_add_f32_dpp v67, v69, v21 wave_ror:1 row_mask:0xf bank_mask:0xf
  v_mfma_f32_16x16x32_bf16 v[44:47], a[4:7], a[140:143], v[44:47]
  s_waitcnt lgkmcnt(9)
  ds_read_u16_d16_hi v77, v4 offset:128
  v_cndmask_b32 v69, v67, v66, s[62:63]
  v_mfma_f32_16x16x32_bf16 v[48:51], a[32:35], a[128:131], 0
  s_lshl_b64 s[74:75], -1, 15
  ds_read_b64_tr_b16 a[48:49], v2 offset:1568
  v_mfma_f32_16x16x32_bf16 v[48:51], a[24:27], a[132:135], v[48:51]
  ds_read_b64_tr_b16 a[50:51], v2 offset:1536
  v_mfma_f32_16x16x32_bf16 v[48:51], a[16:19], a[136:139], v[48:51]
  ds_read_b64_tr_b16 a[152:153], v3 offset:1536
  v_mfma_f32_16x16x32_bf16 v[48:51], a[8:11], a[140:143], v[48:51]
  ds_read_b64_tr_b16 a[154:155], v3 offset:1568
  v_mfma_f32_16x16x32_bf16 v[48:51], a[0:3], a[144:147], v[48:51]
  s_waitcnt lgkmcnt(5)
  ds_read_u16_d16_hi v78, v4 offset:256
  v_fmac_f32 v70, s61, v76
  v_mfma_f32_16x16x32_bf16 v[52:55], a[36:39], a[128:131], 0
  ds_read_b64_tr_b16 a[52:53], v2 offset:1696
  v_cvt_pk_bf16_f32 v70, v70, v70
  v_mfma_f32_16x16x32_bf16 v[52:55], a[28:31], a[132:135], v[52:55]
  ds_write_b16 v5, v70 offset:0
  v_add_f32_dpp v71, v69, v20 wave_ror:1 row_mask:0xf bank_mask:0xf
  v_mfma_f32_16x16x32_bf16 v[52:55], a[20:23], a[136:139], v[52:55]
  s_lshl_b64 s[72:73], -1, 30
  ds_read_b64_tr_b16 a[54:55], v2 offset:1664
  v_cndmask_b32 v68, v27, v23, s[62:63]
  v_mfma_f32_16x16x32_bf16 v[52:55], a[12:15], a[140:143], v[52:55]
  ds_read_u16_d16_hi v79, v4 offset:384
  v_add_f32_dpp v64, v68, v26 wave_ror:1 row_mask:0xf bank_mask:0xf
  v_mfma_f32_16x16x32_bf16 v[52:55], a[4:7], a[144:147], v[52:55]
  s_waitcnt lgkmcnt(9)
  ds_read_u16_d16_hi v80, v4 offset:512
  v_fmac_f32 v71, s61, v77
  v_mfma_f32_16x16x32_bf16 v[56:59], a[40:43], a[128:131], 0
  ds_read_b64_tr_b16 a[56:57], v2 offset:1824
  v_cvt_pk_bf16_f32 v71, v71, v71
  v_mfma_f32_16x16x32_bf16 v[56:59], a[32:35], a[132:135], v[56:59]
  ds_read_b64_tr_b16 a[58:59], v2 offset:1792
  v_cndmask_b32 v75, v5, v93, s[74:75]
  v_mfma_f32_16x16x32_bf16 v[56:59], a[24:27], a[136:139], v[56:59]
  buffer_load_dwordx4 v[96:99], v15, s[28:31], s65 offen offset:0
  v_mfma_f32_16x16x32_bf16 v[56:59], a[16:19], a[140:143], v[56:59]
  ds_write_b16 v75, v71 offset:512
  v_cndmask_b32 v68, v64, v65, s[62:63]
  v_mfma_f32_16x16x32_bf16 v[56:59], a[8:11], a[144:147], v[56:59]
  s_lshl_b64 s[74:75], -1, 45
  ds_read_b64_tr_b16 a[156:157], v3 offset:1792
  v_add_f32_dpp v66, v68, v25 wave_ror:1 row_mask:0xf bank_mask:0xf
  v_mfma_f32_16x16x32_bf16 v[56:59], a[0:3], a[148:151], v[56:59]
  s_waitcnt lgkmcnt(5)
  ds_read_b64_tr_b16 a[158:159], v3 offset:1824
  v_cndmask_b32 v68, v66, v67, s[62:63]
  v_mfma_f32_16x16x32_bf16 v[60:63], a[44:47], a[128:131], 0
  ds_read_b64_tr_b16 a[60:61], v2 offset:1952
  v_add_f32_dpp v70, v68, v24 wave_ror:1 row_mask:0xf bank_mask:0xf
  v_mfma_f32_16x16x32_bf16 v[60:63], a[36:39], a[132:135], v[60:63]
  ds_read_b64_tr_b16 a[62:63], v2 offset:1920
  v_fmac_f32 v70, s61, v78
  v_mfma_f32_16x16x32_bf16 v[60:63], a[28:31], a[136:139], v[60:63]
  ds_read_u16_d16_hi v81, v4 offset:640
  v_cvt_pk_bf16_f32 v70, v70, v70
  v_mfma_f32_16x16x32_bf16 v[60:63], a[20:23], a[140:143], v[60:63]
  ds_read_u16_d16_hi v82, v4 offset:768
  v_cndmask_b32 v74, v5, v93, s[72:73]
  v_mfma_f32_16x16x32_bf16 v[60:63], a[12:15], a[144:147], v[60:63]
  ds_write_b16 v74, v70 offset:1032
  v_cndmask_b32 v69, v31, v27, s[62:63]
  v_mfma_f32_16x16x32_bf16 v[60:63], a[4:7], a[148:151], v[60:63]
  s_waitcnt lgkmcnt(10)
  ds_read_u16_d16_hi v83, v4 offset:896
  v_add_f32_dpp v65, v69, v30 wave_ror:1 row_mask:0xf bank_mask:0xf
  v_mfma_f32_16x16x32_bf16 v[16:19], a[48:51], a[128:131], 0
  s_lshl_b64 s[72:73], -1, 60
  ds_read_b64_tr_b16 a[64:65], v2 offset:2080
  v_cndmask_b32 v69, v65, v64, s[62:63]
  v_mfma_f32_16x16x32_bf16 v[16:19], a[40:43], a[132:135], v[16:19]
  ds_read_b64_tr_b16 a[66:67], v2 offset:2048
  v_add_f32_dpp v67, v69, v29 wave_ror:1 row_mask:0xf bank_mask:0xf
  v_mfma_f32_16x16x32_bf16 v[16:19], a[32:35], a[136:139], v[16:19]
  buffer_load_dwordx4 v[100:103], v15, s[28:31], s65 offen offset:1024
  v_mfma_f32_16x16x32_bf16 v[16:19], a[24:27], a[140:143], v[16:19]
  ds_read_b64_tr_b16 a[160:161], v3 offset:2048
  v_cndmask_b32 v69, v67, v66, s[62:63]
  v_mfma_f32_16x16x32_bf16 v[16:19], a[16:19], a[144:147], v[16:19]
  ds_read_b64_tr_b16 a[162:163], v3 offset:2080
  v_add_f32_dpp v71, v69, v28 wave_ror:1 row_mask:0xf bank_mask:0xf
  v_mfma_f32_16x16x32_bf16 v[16:19], a[8:11], a[148:151], v[16:19]
  ds_read_u16_d16_hi v84, v4 offset:1024
  v_fmac_f32 v71, s61, v79
  v_mfma_f32_16x16x32_bf16 v[16:19], a[0:3], a[152:155], v[16:19]
  s_waitcnt lgkmcnt(7)
  v_cvt_pk_bf16_f32 v71, v71, v71
  v_cndmask_b32 v75, v5, v93, s[74:75]
  v_mfma_f32_16x16x32_bf16 v[20:23], a[52:55], a[128:131], 0
  ds_write_b16 v75, v71 offset:1552
  v_cndmask_b32 v68, v35, v31, s[62:63]
  v_mfma_f32_16x16x32_bf16 v[20:23], a[44:47], a[132:135], v[20:23]
  ds_read_b64_tr_b16 a[68:69], v2 offset:2208
  v_add_f32_dpp v64, v68, v34 wave_ror:1 row_mask:0xf bank_mask:0xf
  v_mfma_f32_16x16x32_bf16 v[20:23], a[36:39], a[136:139], v[20:23]
  buffer_load_dwordx4 v[104:107], v15, s[28:31], s65 offen offset:2048
  v_mfma_f32_16x16x32_bf16 v[20:23], a[28:31], a[140:143], v[20:23]
  ds_read_b64_tr_b16 a[70:71], v2 offset:2176
  v_cndmask_b32 v68, v64, v65, s[62:63]
  v_mfma_f32_16x16x32_bf16 v[20:23], a[20:23], a[144:147], v[20:23]
  ds_read_u16_d16_hi v85, v4 offset:1152
  v_add_f32_dpp v66, v68, v33 wave_ror:1 row_mask:0xf bank_mask:0xf
  v_mfma_f32_16x16x32_bf16 v[20:23], a[12:15], a[148:151], v[20:23]
  v_cndmask_b32 v68, v66, v67, s[62:63]
  v_cndmask_b32 v69, v39, v35, s[62:63]
  v_mfma_f32_16x16x32_bf16 v[20:23], a[4:7], a[152:155], v[20:23]
  s_waitcnt lgkmcnt(4)
  v_add_f32_dpp v70, v68, v32 wave_ror:1 row_mask:0xf bank_mask:0xf
  v_fmac_f32 v70, s61, v80
  v_mfma_f32_16x16x32_bf16 v[24:27], a[56:59], a[128:131], 0
  ds_read_b64_tr_b16 a[72:73], v2 offset:2336
  v_cvt_pk_bf16_f32 v70, v70, v70
  v_mfma_f32_16x16x32_bf16 v[24:27], a[48:51], a[132:135], v[24:27]
  ds_read_b64_tr_b16 a[74:75], v2 offset:2304
  v_cndmask_b32 v74, v5, v93, s[72:73]
  v_mfma_f32_16x16x32_bf16 v[24:27], a[40:43], a[136:139], v[24:27]
  buffer_load_dwordx4 v[108:111], v15, s[28:31], s65 offen offset:3072
  v_mfma_f32_16x16x32_bf16 v[24:27], a[32:35], a[140:143], v[24:27]
  ds_write_b16 v74, v70 offset:2072
  v_add_f32_dpp v65, v69, v38 wave_ror:1 row_mask:0xf bank_mask:0xf
  v_mfma_f32_16x16x32_bf16 v[24:27], a[24:27], a[144:147], v[24:27]
  s_lshl_b64 s[72:73], -1, 11
  ds_read_b64_tr_b16 a[164:165], v3 offset:2304
  v_cndmask_b32 v69, v65, v64, s[62:63]
  v_mfma_f32_16x16x32_bf16 v[24:27], a[16:19], a[148:151], v[24:27]
  ds_read_b64_tr_b16 a[166:167], v3 offset:2336
  v_add_f32_dpp v67, v69, v37 wave_ror:1 row_mask:0xf bank_mask:0xf
  v_mfma_f32_16x16x32_bf16 v[24:27], a[8:11], a[152:155], v[24:27]
L_cw1:
  s_cbranch_execz L_cw2
  ds_read_u16_d16_hi v86, v4 offset:1280
  v_cndmask_b32 v69, v67, v66, s[62:63]
  v_mfma_f32_16x16x32_bf16 v[24:27], a[0:3], a[156:159], v[24:27]
  s_waitcnt lgkmcnt(6)
  v_cndmask_b32 v68, v43, v39, s[62:63]
  v_add_f32_dpp v71, v69, v36 wave_ror:1 row_mask:0xf bank_mask:0xf
  v_mfma_f32_16x16x32_bf16 v[28:31], a[60:63], a[128:131], 0
  ds_read_b64_tr_b16 a[76:77], v2 offset:2464
  v_fmac_f32 v71, s61, v81
  v_mfma_f32_16x16x32_bf16 v[28:31], a[52:55], a[132:135], v[28:31]
  ds_read_b64_tr_b16 a[78:79], v2 offset:2432
  v_cvt_pk_bf16_f32 v71, v71, v71
  v_mfma_f32_16x16x32_bf16 v[28:31], a[44:47], a[136:139], v[28:31]
  ds_write_b16 v5, v71 offset:2592
  v_add_f32_dpp v64, v68, v42 wave_ror:1 row_mask:0xf bank_mask:0xf
  v_mfma_f32_16x16x32_bf16 v[28:31], a[36:39], a[140:143], v[28:31]
  s_lshl_b64 s[74:75], -1, 26
  ds_read_u16_d16_hi v87, v4 offset:1408
  v_cndmask_b32 v68, v64, v65, s[62:63]
  v_mfma_f32_16x16x32_bf16 v[28:31], a[28:31], a[144:147], v[28:31]
  v_cndmask_b32 v69, v47, v43, s[62:63]
  v_add_f32_dpp v66, v68, v41 wave_ror:1 row_mask:0xf bank_mask:0xf
  v_mfma_f32_16x16x32_bf16 v[28:31], a[20:23], a[148:151], v[28:31]
  v_cndmask_b32 v68, v66, v67, s[62:63]
  v_add_f32_dpp v65, v69, v46 wave_ror:1 row_mask:0xf bank_mask:0xf
  v_mfma_f32_16x16x32_bf16 v[28:31], a[12:15], a[152:155], v[28:31]
  v_add_f32_dpp v70, v68, v40 wave_ror:1 row_mask:0xf bank_mask:0xf
  v_fmac_f32 v70, s61, v82
  v_mfma_f32_16x16x32_bf16 v[28:31], a[4:7], a[156:159], v[28:31]
  s_waitcnt lgkmcnt(4)
  v_cvt_pk_bf16_f32 v70, v70, v70
  v_cndmask_b32 v74, v5, v93, s[72:73]
  v_mfma_f32_16x16x32_bf16 v[32:35], a[64:67], a[128:131], 0
  ds_write_b16 v74, v70 offset:3104
  v_cndmask_b32 v69, v65, v64, s[62:63]
  v_mfma_f32_16x16x32_bf16 v[32:35], a[56:59], a[132:135], v[32:35]
  s_lshl_b64 s[72:73], -1, 41
  ds_read_b64_tr_b16 a[80:81], v2 offset:2592
  v_add_f32_dpp v67, v69, v45 wave_ror:1 row_mask:0xf bank_mask:0xf
  v_mfma_f32_16x16x32_bf16 v[32:35], a[48:51], a[136:139], v[32:35]
  ds_read_b64_tr_b16 a[82:83], v2 offset:2560
  v_cndmask_b32 v69, v67, v66, s[62:63]
  v_mfma_f32_16x16x32_bf16 v[32:35], a[40:43], a[140:143], v[32:35]
  ds_read_b64_tr_b16 a[168:169], v3 offset:2560
  v_add_f32_dpp v71, v69, v44 wave_ror:1 row_mask:0xf bank_mask:0xf
  v_mfma_f32_16x16x32_bf16 v[32:35], a[32:35], a[144:147], v[32:35]
  ds_read_b64_tr_b16 a[170:171], v3 offset:2592
  v_fmac_f32 v71, s61, v83
  v_mfma_f32_16x16x32_bf16 v[32:35], a[24:27], a[148:151], v[32:35]
  ds_read_u16_d16_hi v76, v4 offset:1536
  v_cvt_pk_bf16_f32 v71, v71, v71
  v_mfma_f32_16x16x32_bf16 v[32:35], a[16:19], a[152:155], v[32:35]
  v_cndmask_b32 v75, v5, v93, s[74:75]
  v_cndmask_b32 v68, v51, v47, s[62:63]
  v_mfma_f32_16x16x32_bf16 v[32:35], a[8:11], a[156:159], v[32:35]
  ds_write_b16 v75, v71 offset:3624
  v_add_f32_dpp v64, v68, v50 wave_ror:1 row_mask:0xf bank_mask:0xf
  v_mfma_f32_16x16x32_bf16 v[32:35], a[0:3], a[160:163], v[32:35]
  s_waitcnt lgkmcnt(7)
  ds_read_u16_d16_hi v77, v4 offset:1664
  v_cndmask_b32 v68, v64, v65, s[62:63]
  v_mfma_f32_16x16x32_bf16 v[36:39], a[68:71], a[128:131], 0
  s_lshl_b64 s[74:75], -1, 56
  buffer_load_dword v253, v201, s[8:11], 0 offen
  v_mfma_f32_16x16x32_bf16 v[36:39], a[60:63], a[132:135], v[36:39]
  ds_read_b64_tr_b16 a[84:85], v2 offset:2720
  v_add_f32_dpp v66, v68, v49 wave_ror:1 row_mask:0xf bank_mask:0xf
  v_mfma_f32_16x16x32_bf16 v[36:39], a[52:55], a[136:139], v[36:39]
  ds_read_b64_tr_b16 a[86:87], v2 offset:2688
  v_cndmask_b32 v68, v66, v67, s[62:63]
  v_mfma_f32_16x16x32_bf16 v[36:39], a[44:47], a[140:143], v[36:39]
  v_cndmask_b32 v69, v55, v51, s[62:63]
  v_add_f32_dpp v70, v68, v48 wave_ror:1 row_mask:0xf bank_mask:0xf
  v_mfma_f32_16x16x32_bf16 v[36:39], a[36:39], a[144:147], v[36:39]
  v_fmac_f32 v70, s61, v84
  v_cvt_pk_bf16_f32 v70, v70, v70
  v_mfma_f32_16x16x32_bf16 v[36:39], a[28:31], a[148:151], v[36:39]
  v_cndmask_b32 v74, v5, v93, s[72:73]
  v_add_f32_dpp v65, v69, v54 wave_ror:1 row_mask:0xf bank_mask:0xf
  v_mfma_f32_16x16x32_bf16 v[36:39], a[20:23], a[152:155], v[36:39]
  ds_write_b16 v74, v70 offset:4144
  v_cndmask_b32 v69, v65, v64, s[62:63]
  v_mfma_f32_16x16x32_bf16 v[36:39], a[12:15], a[156:159], v[36:39]
  ds_read_u16_d16_hi v78, v4 offset:1792
  v_add_f32_dpp v67, v69, v53 wave_ror:1 row_mask:0xf bank_mask:0xf
  v_mfma_f32_16x16x32_bf16 v[36:39], a[4:7], a[160:163], v[36:39]
  s_waitcnt lgkmcnt(6)
  v_cndmask_b32 v69, v67, v66, s[62:63]
  v_cndmask_b32 v68, v59, v55, s[62:63]
  v_mfma_f32_16x16x32_bf16 v[40:43], a[72:75], a[128:131], 0
  ds_read_b64_tr_b16 a[88:89], v2 offset:2848
  v_add_f32_dpp v71, v69, v52 wave_ror:1 row_mask:0xf bank_mask:0xf
  v_mfma_f32_16x16x32_bf16 v[40:43], a[64:67], a[132:135], v[40:43]
  ds_read_b64_tr_b16 a[90:91], v2 offset:2816
  v_fmac_f32 v71, s61, v85
  v_mfma_f32_16x16x32_bf16 v[40:43], a[56:59], a[136:139], v[40:43]
  ds_read_b64_tr_b16 a[172:173], v3 offset:2816
  v_cvt_pk_bf16_f32 v71, v71, v71
  v_mfma_f32_16x16x32_bf16 v[40:43], a[48:51], a[140:143], v[40:43]
  ds_read_b64_tr_b16 a[174:175], v3 offset:2848
  v_cndmask_b32 v75, v5, v93, s[74:75]
  v_mfma_f32_16x16x32_bf16 v[40:43], a[40:43], a[144:147], v[40:43]
  ds_write_b16 v75, v71 offset:4664
  v_add_f32_dpp v64, v68, v58 wave_ror:1 row_mask:0xf bank_mask:0xf
  v_mfma_f32_16x16x32_bf16 v[40:43], a[32:35], a[148:151], v[40:43]
  s_lshl_b64 s[74:75], -1, 7
  ds_read_u16_d16_hi v79, v4 offset:1920
  v_cndmask_b32 v68, v64, v65, s[62:63]
  v_mfma_f32_16x16x32_bf16 v[40:43], a[24:27], a[152:155], v[40:43]
  v_cndmask_b32 v69, v63, v59, s[62:63]
  v_add_f32_dpp v66, v68, v57 wave_ror:1 row_mask:0xf bank_mask:0xf
  v_mfma_f32_16x16x32_bf16 v[40:43], a[16:19], a[156:159], v[40:43]
  v_cndmask_b32 v68, v66, v67, s[62:63]
  v_add_f32_dpp v65, v69, v62 wave_ror:1 row_mask:0xf bank_mask:0xf
  v_mfma_f32_16x16x32_bf16 v[40:43], a[8:11], a[160:163], v[40:43]
  v_add_f32_dpp v70, v68, v56 wave_ror:1 row_mask:0xf bank_mask:0xf
  v_fmac_f32 v70, s61, v86
  v_mfma_f32_16x16x32_bf16 v[40:43], a[0:3], a[164:167], v[40:43]
  s_waitcnt lgkmcnt(6)
  v_cvt_pk_bf16_f32 v70, v70, v70
  v_cndmask_b32 v69, v65, v64, s[62:63]
  v_mfma_f32_16x16x32_bf16 v[44:47], a[76:79], a[128:131], 0
  ds_write_b16 v5, v70 offset:5184
  v_add_f32_dpp v67, v69, v61 wave_ror:1 row_mask:0xf bank_mask:0xf
  v_mfma_f32_16x16x32_bf16 v[44:47], a[68:71], a[132:135], v[44:47]
  s_lshl_b64 s[72:73], -1, 22
  ds_read_b64_tr_b16 a[92:93], v2 offset:2976
  v_cndmask_b32 v69, v67, v66, s[62:63]
  v_mfma_f32_16x16x32_bf16 v[44:47], a[60:63], a[136:139], v[44:47]
  ds_read_b64_tr_b16 a[94:95], v2 offset:2944
  v_add_f32_dpp v71, v69, v60 wave_ror:1 row_mask:0xf bank_mask:0xf
  v_mfma_f32_16x16x32_bf16 v[44:47], a[52:55], a[140:143], v[44:47]
  ds_read_u16_d16_hi v80, v4 offset:2048
  v_fmac_f32 v71, s61, v87
  v_mfma_f32_16x16x32_bf16 v[44:47], a[44:47], a[144:147], v[44:47]
  v_cvt_pk_bf16_f32 v71, v71, v71
  v_cndmask_b32 v75, v5, v93, s[74:75]
  v_mfma_f32_16x16x32_bf16 v[44:47], a[36:39], a[148:151], v[44:47]
  ds_write_b16 v75, v71 offset:5696
  v_cndmask_b32 v68, v19, v63, s[62:63]
  v_mfma_f32_16x16x32_bf16 v[44:47], a[28:31], a[152:155], v[44:47]
  s_lshl_b64 s[74:75], -1, 37
  ds_read_u16_d16_hi v81, v4 offset:2176
  v_add_f32_dpp v64, v68, v18 wave_ror:1 row_mask:0xf bank_mask:0xf
  v_mfma_f32_16x16x32_bf16 v[44:47], a[20:23], a[156:159], v[44:47]
  v_cndmask_b32 v68, v64, v65, s[62:63]
  v_cndmask_b32 v69, v23, v19, s[62:63]
  v_mfma_f32_16x16x32_bf16 v[44:47], a[12:15], a[160:163], v[44:47]
  v_add_f32_dpp v66, v68, v17 wave_ror:1 row_mask:0xf bank_mask:0xf
  v_cndmask_b32 v68, v66, v67, s[62:63]
  v_mfma_f32_16x16x32_bf16 v[44:47], a[4:7], a[164:167], v[44:47]
  s_waitcnt lgkmcnt(6)
  v_add_f32_dpp v65, v69, v22 wave_ror:1 row_mask:0xf bank_mask:0xf
  v_add_f32_dpp v70, v68, v16 wave_ror:1 row_mask:0xf bank_mask:0xf
  v_mfma_f32_16x16x32_bf16 v[48:51], a[80:83], a[128:131], 0
  ds_read_b64_tr_b16 a[96:97], v2 offset:3104
  v_fmac_f32 v70, s61, v76
  v_mfma_f32_16x16x32_bf16 v[48:51], a[72:75], a[132:135], v[48:51]
  ds_read_b64_tr_b16 a[98:99], v2 offset:3072
  v_cvt_pk_bf16_f32 v70, v70, v70
  v_mfma_f32_16x16x32_bf16 v[48:51], a[64:67], a[136:139], v[48:51]
  ds_read_b64_tr_b16 a[176:177], v3 offset:3072
  v_cndmask_b32 v74, v5, v93, s[72:73]
  v_mfma_f32_16x16x32_bf16 v[48:51], a[56:59], a[140:143], v[48:51]
  ds_write_b16 v74, v70 offset:6216
  v_cndmask_b32 v69, v65, v64, s[62:63]
  v_mfma_f32_16x16x32_bf16 v[48:51], a[48:51], a[144:147], v[48:51]
  s_lshl_b64 s[72:73], -1, 52
  ds_read_b64_tr_b16 a[178:179], v3 offset:3104
  v_add_f32_dpp v67, v69, v21 wave_ror:1 row_mask:0xf bank_mask:0xf
  v_mfma_f32_16x16x32_bf16 v[48:51], a[40:43], a[148:151], v[48:51]
  ds_read_u16_d16_hi v82, v4 offset:2304
  v_cndmask_b32 v69, v67, v66, s[62:63]
  v_mfma_f32_16x16x32_bf16 v[48:51], a[32:35], a[152:155], v[48:51]
  v_cndmask_b32 v68, v27, v23, s[62:63]
  v_add_f32_dpp v71, v69, v20 wave_ror:1 row_mask:0xf bank_mask:0xf
  v_mfma_f32_16x16x32_bf16 v[48:51], a[24:27], a[156:159], v[48:51]
  v_fmac_f32 v71, s61, v77
  v_cvt_pk_bf16_f32 v71, v71, v71
  v_mfma_f32_16x16x32_bf16 v[48:51], a[16:19], a[160:163], v[48:51]
  v_cndmask_b32 v75, v5, v93, s[74:75]
  v_add_f32_dpp v64, v68, v26 wave_ror:1 row_mask:0xf bank_mask:0xf
  v_mfma_f32_16x16x32_bf16 v[48:51], a[8:11], a[164:167], v[48:51]
  ds_write_b16 v75, v71 offset:6736
  v_cndmask_b32 v68, v64, v65, s[62:63]
  v_mfma_f32_16x16x32_bf16 v[48:51], a[0:3], a[168:171], v[48:51]
  s_waitcnt lgkmcnt(7)
  ds_read_u16_d16_hi v83, v4 offset:2432
  v_add_f32_dpp v66, v68, v25 wave_ror:1 row_mask:0xf bank_mask:0xf
  v_mfma_f32_16x16x32_bf16 v[52:55], a[84:87], a[128:131], 0
  ds_read_b64_tr_b16 a[100:101], v2 offset:3232
  v_cndmask_b32 v68, v66, v67, s[62:63]
  v_mfma_f32_16x16x32_bf16 v[52:55], a[76:79], a[132:135], v[52:55]
  ds_read_b64_tr_b16 a[102:103], v2 offset:3200
  v_add_f32_dpp v70, v68, v24 wave_ror:1 row_mask:0xf bank_mask:0xf
  v_mfma_f32_16x16x32_bf16 v[52:55], a[68:71], a[136:139], v[52:55]
  buffer_load_dwordx4 v[112:115], v15, s[12:15], s67 offen offset:0 sc1
  v_mfma_f32_16x16x32_bf16 v[52:55], a[60:63], a[140:143], v[52:55]
  v_fmac_f32 v70, s61, v78
  v_cvt_pk_bf16_f32 v70, v70, v70
  v_mfma_f32_16x16x32_bf16 v[52:55], a[52:55], a[144:147], v[52:55]
  v_cndmask_b32 v74, v5, v93, s[72:73]
  v_cndmask_b32 v69, v31, v27, s[62:63]
  v_mfma_f32_16x16x32_bf16 v[52:55], a[44:47], a[148:151], v[52:55]
  ds_write_b16 v74, v70 offset:7256
  v_add_f32_dpp v65, v69, v30 wave_ror:1 row_mask:0xf bank_mask:0xf
  v_mfma_f32_16x16x32_bf16 v[52:55], a[36:39], a[152:155], v[52:55]
  s_lshl_b64 s[72:73], -1, 3
  ds_read_u16_d16_hi v84, v4 offset:2560
  v_cndmask_b32 v69, v65, v64, s[62:63]
  v_mfma_f32_16x16x32_bf16 v[52:55], a[28:31], a[156:159], v[52:55]
  v_cndmask_b32 v68, v35, v31, s[62:63]
  v_add_f32_dpp v67, v69, v29 wave_ror:1 row_mask:0xf bank_mask:0xf
  v_mfma_f32_16x16x32_bf16 v[52:55], a[20:23], a[160:163], v[52:55]
  v_cndmask_b32 v69, v67, v66, s[62:63]
  v_add_f32_dpp v64, v68, v34 wave_ror:1 row_mask:0xf bank_mask:0xf
  v_mfma_f32_16x16x32_bf16 v[52:55], a[12:15], a[164:167], v[52:55]
  v_add_f32_dpp v71, v69, v28 wave_ror:1 row_mask:0xf bank_mask:0xf
  v_fmac_f32 v71, s61, v79
  v_mfma_f32_16x16x32_bf16 v[52:55], a[4:7], a[168:171], v[52:55]
  s_waitcnt lgkmcnt(6)
  v_cvt_pk_bf16_f32 v71, v71, v71
  v_cndmask_b32 v68, v64, v65, s[62:63]
  v_mfma_f32_16x16x32_bf16 v[56:59], a[88:91], a[128:131], 0
  ds_write_b16 v5, v71 offset:7776
  v_add_f32_dpp v66, v68, v33 wave_ror:1 row_mask:0xf bank_mask:0xf
  v_mfma_f32_16x16x32_bf16 v[56:59], a[80:83], a[132:135], v[56:59]
  s_lshl_b64 s[74:75], -1, 18
  ds_read_b64_tr_b16 a[104:105], v2 offset:3360
  v_cndmask_b32 v68, v66, v67, s[62:63]
  v_mfma_f32_16x16x32_bf16 v[56:59], a[72:75], a[136:139], v[56:59]
  buffer_load_dwordx4 v[116:119], v15, s[12:15], s67 offen offset:1024 sc1
  v_mfma_f32_16x16x32_bf16 v[56:59], a[64:67], a[140:143], v[56:59]
  ds_read_b64_tr_b16 a[106:107], v2 offset:3328
  v_add_f32_dpp v70, v68, v32 wave_ror:1 row_mask:0xf bank_mask:0xf
  v_mfma_f32_16x16x32_bf16 v[56:59], a[56:59], a[144:147], v[56:59]
  ds_read_b64_tr_b16 a[180:181], v3 offset:3328
  v_fmac_f32 v70, s61, v80
  v_mfma_f32_16x16x32_bf16 v[56:59], a[48:51], a[148:151], v[56:59]
  ds_read_b64_tr_b16 a[182:183], v3 offset:3360
  v_cvt_pk_bf16_f32 v70, v70, v70
  v_mfma_f32_16x16x32_bf16 v[56:59], a[40:43], a[152:155], v[56:59]
  ds_read_u16_d16_hi v85, v4 offset:2688
  v_cndmask_b32 v74, v5, v93, s[72:73]
  v_mfma_f32_16x16x32_bf16 v[56:59], a[32:35], a[156:159], v[56:59]
  ds_write_b16 v74, v70 offset:8288
  v_cndmask_b32 v69, v39, v35, s[62:63]
  v_mfma_f32_16x16x32_bf16 v[56:59], a[24:27], a[160:163], v[56:59]
  s_lshl_b64 s[72:73], -1, 33
  ds_read_u16_d16_hi v86, v4 offset:2816
  v_add_f32_dpp v65, v69, v38 wave_ror:1 row_mask:0xf bank_mask:0xf
  v_mfma_f32_16x16x32_bf16 v[56:59], a[16:19], a[164:167], v[56:59]
  v_cndmask_b32 v69, v65, v64, s[62:63]
  v_cndmask_b32 v68, v43, v39, s[62:63]
  v_mfma_f32_16x16x32_bf16 v[56:59], a[8:11], a[168:171], v[56:59]
  v_add_f32_dpp v67, v69, v37 wave_ror:1 row_mask:0xf bank_mask:0xf
  v_cndmask_b32 v69, v67, v66, s[62:63]
  v_mfma_f32_16x16x32_bf16 v[56:59], a[0:3], a[172:175], v[56:59]
  s_waitcnt lgkmcnt(8)
  v_add_f32_dpp v64, v68, v42 wave_ror:1 row_mask:0xf bank_mask:0xf
  v_add_f32_dpp v71, v69, v36 wave_ror:1 row_mask:0xf bank_mask:0xf
  v_mfma_f32_16x16x32_bf16 v[60:63], a[92:95], a[128:131], 0
  ds_read_b64_tr_b16 a[108:109], v2 offset:3488
  v_fmac_f32 v71, s61, v81
  v_mfma_f32_16x16x32_bf16 v[60:63], a[84:87], a[132:135], v[60:63]
  ds_read_b64_tr_b16 a[110:111], v2 offset:3456
  v_cvt_pk_bf16_f32 v71, v71, v71
  v_mfma_f32_16x16x32_bf16 v[60:63], a[76:79], a[136:139], v[60:63]
  buffer_load_dwordx4 v[120:123], v15, s[12:15], s67 offen offset:2048 sc1
  v_mfma_f32_16x16x32_bf16 v[60:63], a[68:71], a[140:143], v[60:63]
  v_cndmask_b32 v75, v5, v93, s[74:75]
  v_cndmask_b32 v68, v64, v65, s[62:63]
  v_mfma_f32_16x16x32_bf16 v[60:63], a[60:63], a[144:147], v[60:63]
  ds_write_b16 v75, v71 offset:8808
  v_add_f32_dpp v66, v68, v41 wave_ror:1 row_mask:0xf bank_mask:0xf
  v_mfma_f32_16x16x32_bf16 v[60:63], a[52:55], a[148:151], v[60:63]
  s_lshl_b64 s[74:75], -1, 48
  ds_read_u16_d16_hi v87, v4 offset:2944
  v_cndmask_b32 v68, v66, v67, s[62:63]
  v_mfma_f32_16x16x32_bf16 v[60:63], a[44:47], a[152:155], v[60:63]
  v_cndmask_b32 v69, v47, v43, s[62:63]
  v_add_f32_dpp v70, v68, v40 wave_ror:1 row_mask:0xf bank_mask:0xf
  v_mfma_f32_16x16x32_bf16 v[60:63], a[36:39], a[156:159], v[60:63]
  v_fmac_f32 v70, s61, v82
  v_cvt_pk_bf16_f32 v70, v70, v70
  v_mfma_f32_16x16x32_bf16 v[60:63], a[28:31], a[160:163], v[60:63]
  v_cndmask_b32 v74, v5, v93, s[72:73]
  v_add_f32_dpp v65, v69, v46 wave_ror:1 row_mask:0xf bank_mask:0xf
  v_mfma_f32_16x16x32_bf16 v[60:63], a[20:23], a[164:167], v[60:63]
  ds_write_b16 v74, v70 offset:9328
  v_cndmask_b32 v69, v65, v64, s[62:63]
  v_mfma_f32_16x16x32_bf16 v[60:63], a[12:15], a[168:171], v[60:63]
  s_lshl_b64 s[72:73], -1, 63
  ds_read_u16_d16_hi v76, v4 offset:3072
  v_add_f32_dpp v67, v69, v45 wave_ror:1 row_mask:0xf bank_mask:0xf
  v_mfma_f32_16x16x32_bf16 v[60:63], a[4:7], a[172:175], v[60:63]
  s_waitcnt lgkmcnt(6)
  v_cndmask_b32 v69, v67, v66, s[62:63]
  v_cndmask_b32 v68, v51, v47, s[62:63]
  v_mfma_f32_16x16x32_bf16 v[16:19], a[96:99], a[128:131], 0
  ds_read_b64_tr_b16 a[112:113], v2 offset:3616
  v_add_f32_dpp v71, v69, v44 wave_ror:1 row_mask:0xf bank_mask:0xf
  v_mfma_f32_16x16x32_bf16 v[16:19], a[88:91], a[132:135], v[16:19]
  ds_read_b64_tr_b16 a[114:115], v2 offset:3584
  v_fmac_f32 v71, s61, v83
  v_mfma_f32_16x16x32_bf16 v[16:19], a[80:83], a[136:139], v[16:19]
  buffer_load_dwordx4 v[124:127], v15, s[12:15], s67 offen offset:3072 sc1
  v_mfma_f32_16x16x32_bf16 v[16:19], a[72:75], a[140:143], v[16:19]
  ds_read_b64_tr_b16 a[184:185], v3 offset:3584
  v_cvt_pk_bf16_f32 v71, v71, v71
  v_mfma_f32_16x16x32_bf16 v[16:19], a[64:67], a[144:147], v[16:19]
  ds_read_b64_tr_b16 a[186:187], v3 offset:3616
  v_cndmask_b32 v75, v5, v93, s[74:75]
  v_mfma_f32_16x16x32_bf16 v[16:19], a[56:59], a[148:151], v[16:19]
  ds_write_b16 v75, v71 offset:9848
  v_add_f32_dpp v64, v68, v50 wave_ror:1 row_mask:0xf bank_mask:0xf
  v_mfma_f32_16x16x32_bf16 v[16:19], a[48:51], a[152:155], v[16:19]
  ds_read_u16_d16_hi v77, v4 offset:3200
  v_cndmask_b32 v68, v64, v65, s[62:63]
  v_mfma_f32_16x16x32_bf16 v[16:19], a[40:43], a[156:159], v[16:19]
  v_cndmask_b32 v69, v55, v51, s[62:63]
  v_add_f32_dpp v66, v68, v49 wave_ror:1 row_mask:0xf bank_mask:0xf
  v_mfma_f32_16x16x32_bf16 v[16:19], a[32:35], a[160:163], v[16:19]
  v_cndmask_b32 v68, v66, v67, s[62:63]
  v_add_f32_dpp v65, v69, v54 wave_ror:1 row_mask:0xf bank_mask:0xf
  v_mfma_f32_16x16x32_bf16 v[16:19], a[24:27], a[164:167], v[16:19]
  v_add_f32_dpp v70, v68, v48 wave_ror:1 row_mask:0xf bank_mask:0xf
  v_fmac_f32 v70, s61, v84
  v_mfma_f32_16x16x32_bf16 v[16:19], a[16:19], a[168:171], v[16:19]
  v_cvt_pk_bf16_f32 v70, v70, v70
  v_cndmask_b32 v74, v5, v93, s[72:73]
  v_mfma_f32_16x16x32_bf16 v[16:19], a[8:11], a[172:175], v[16:19]
  ds_write_b16 v74, v70 offset:10368
  v_cndmask_b32 v69, v65, v64, s[62:63]
  v_mfma_f32_16x16x32_bf16 v[16:19], a[0:3], a[176:179], v[16:19]
  s_waitcnt lgkmcnt(7)
  ds_read_u16_d16_hi v78, v4 offset:3328
  v_add_f32_dpp v67, v69, v53 wave_ror:1 row_mask:0xf bank_mask:0xf
  v_mfma_f32_16x16x32_bf16 v[20:23], a[100:103], a[128:131], 0
  s_lshl_b64 s[72:73], -1, 14
  ds_read_b64_tr_b16 a[116:117], v2 offset:3744
  v_cndmask_b32 v69, v67, v66, s[62:63]
  v_mfma_f32_16x16x32_bf16 v[20:23], a[92:95], a[132:135], v[20:23]
  ds_read_b64_tr_b16 a[118:119], v2 offset:3712
  v_add_f32_dpp v71, v69, v52 wave_ror:1 row_mask:0xf bank_mask:0xf
  v_mfma_f32_16x16x32_bf16 v[20:23], a[84:87], a[136:139], v[20:23]
  v_fmac_f32 v71, s61, v85
  v_cvt_pk_bf16_f32 v71, v71, v71
  v_mfma_f32_16x16x32_bf16 v[20:23], a[76:79], a[140:143], v[20:23]
  ds_write_b16 v5, v71 offset:10888
  v_cndmask_b32 v68, v59, v55, s[62:63]
  v_mfma_f32_16x16x32_bf16 v[20:23], a[68:71], a[144:147], v[20:23]
  s_lshl_b64 s[74:75], -1, 29
  ds_read_u16_d16_hi v79, v4 offset:3456
  v_add_f32_dpp v64, v68, v58 wave_ror:1 row_mask:0xf bank_mask:0xf
  v_mfma_f32_16x16x32_bf16 v[20:23], a[60:63], a[148:151], v[20:23]
  v_cndmask_b32 v68, v64, v65, s[62:63]
  v_cndmask_b32 v69, v63, v59, s[62:63]
  v_mfma_f32_16x16x32_bf16 v[20:23], a[52:55], a[152:155], v[20:23]
  v_add_f32_dpp v66, v68, v57 wave_ror:1 row_mask:0xf bank_mask:0xf
  v_cndmask_b32 v68, v66, v67, s[62:63]
  v_mfma_f32_16x16x32_bf16 v[20:23], a[44:47], a[156:159], v[20:23]
  v_add_f32_dpp v65, v69, v62 wave_ror:1 row_mask:0xf bank_mask:0xf
  v_add_f32_dpp v70, v68, v56 wave_ror:1 row_mask:0xf bank_mask:0xf
  v_mfma_f32_16x16x32_bf16 v[20:23], a[36:39], a[160:163], v[20:23]
  v_fmac_f32 v70, s61, v86
  v_cvt_pk_bf16_f32 v70, v70, v70
  v_mfma_f32_16x16x32_bf16 v[20:23], a[28:31], a[164:167], v[20:23]
  v_cndmask_b32 v74, v5, v93, s[72:73]
  v_cndmask_b32 v69, v65, v64, s[62:63]
  v_mfma_f32_16x16x32_bf16 v[20:23], a[20:23], a[168:171], v[20:23]
  ds_write_b16 v74, v70 offset:11400
  v_add_f32_dpp v67, v69, v61 wave_ror:1 row_mask:0xf bank_mask:0xf
  v_mfma_f32_16x16x32_bf16 v[20:23], a[12:15], a[172:175], v[20:23]
  s_lshl_b64 s[72:73], -1, 44
  ds_read_u16_d16_hi v80, v4 offset:3584
  v_cndmask_b32 v69, v67, v66, s[62:63]
  v_mfma_f32_16x16x32_bf16 v[20:23], a[4:7], a[176:179], v[20:23]
  s_waitcnt lgkmcnt(8)
  v_cndmask_b32 v68, v19, v63, s[62:63]
  v_add_f32_dpp v71, v69, v60 wave_ror:1 row_mask:0xf bank_mask:0xf
  v_mfma_f32_16x16x32_bf16 v[24:27], a[104:107], a[128:131], 0
  buffer_load_dword v253, v202, s[8:11], 0 offen
  v_mfma_f32_16x16x32_bf16 v[24:27], a[96:99], a[132:135], v[24:27]
  ds_read_b64_tr_b16 a[120:121], v2 offset:3872
  v_fmac_f32 v71, s61, v87
  v_mfma_f32_16x16x32_bf16 v[24:27], a[88:91], a[136:139], v[24:27]
  ds_read_b64_tr_b16 a[122:123], v2 offset:3840
  v_cvt_pk_bf16_f32 v71, v71, v71
  v_mfma_f32_16x16x32_bf16 v[24:27], a[80:83], a[140:143], v[24:27]
  ds_read_b64_tr_b16 a[188:189], v3 offset:3840
  v_cndmask_b32 v75, v5, v93, s[74:75]
  v_mfma_f32_16x16x32_bf16 v[24:27], a[72:75], a[144:147], v[24:27]
  ds_write_b16 v75, v71 offset:11920
  v_add_f32_dpp v64, v68, v18 wave_ror:1 row_mask:0xf bank_mask:0xf
  v_mfma_f32_16x16x32_bf16 v[24:27], a[64:67], a[148:151], v[24:27]
  s_lshl_b64 s[74:75], -1, 59
  ds_read_b64_tr_b16 a[190:191], v3 offset:3872
  v_cndmask_b32 v68, v64, v65, s[62:63]
  v_mfma_f32_16x16x32_bf16 v[24:27], a[56:59], a[152:155], v[24:27]
  ds_read_u16_d16_hi v81, v4 offset:3712
  v_add_f32_dpp v66, v68, v17 wave_ror:1 row_mask:0xf bank_mask:0xf
  v_mfma_f32_16x16x32_bf16 v[24:27], a[48:51], a[156:159], v[24:27]
  v_cndmask_b32 v68, v66, v67, s[62:63]
  v_cndmask_b32 v69, v23, v19, s[62:63]
  v_mfma_f32_16x16x32_bf16 v[24:27], a[40:43], a[160:163], v[24:27]
  v_add_f32_dpp v70, v68, v16 wave_ror:1 row_mask:0xf bank_mask:0xf
  v_fmac_f32 v70, s61, v76
  v_mfma_f32_16x16x32_bf16 v[24:27], a[32:35], a[164:167], v[24:27]
  v_cvt_pk_bf16_f32 v70, v70, v70
  v_cndmask_b32 v74, v5, v93, s[72:73]
  v_mfma_f32_16x16x32_bf16 v[24:27], a[24:27], a[168:171], v[24:27]
  ds_write_b16 v74, v70 offset:12440
  v_add_f32_dpp v65, v69, v22 wave_ror:1 row_mask:0xf bank_mask:0xf
  v_mfma_f32_16x16x32_bf16 v[24:27], a[16:19], a[172:175], v[24:27]
  ds_read_u16_d16_hi v82, v4 offset:3840
  v_cndmask_b32 v69, v65, v64, s[62:63]
  v_mfma_f32_16x16x32_bf16 v[24:27], a[8:11], a[176:179], v[24:27]
  v_add_u32 v10, s69, v15
  v_add_u32 v11, s68, v15
  v_mfma_f32_16x16x32_bf16 v[24:27], a[0:3], a[180:183], v[24:27]
  s_waitcnt lgkmcnt(8)
  v_add_f32_dpp v67, v69, v21 wave_ror:1 row_mask:0xf bank_mask:0xf
  v_cndmask_b32 v69, v67, v66, s[62:63]
  v_mfma_f32_16x16x32_bf16 v[28:31], a[108:111], a[128:131], 0
  ds_read_b64_tr_b16 a[124:125], v2 offset:4000
  v_add_f32_dpp v71, v69, v20 wave_ror:1 row_mask:0xf bank_mask:0xf
  v_mfma_f32_16x16x32_bf16 v[28:31], a[100:103], a[132:135], v[28:31]
  s_barrier
  v_mfma_f32_16x16x32_bf16 v[28:31], a[92:95], a[136:139], v[28:31]
  ds_read_b64_tr_b16 a[126:127], v2 offset:3968
  v_fmac_f32 v71, s61, v77
  v_mfma_f32_16x16x32_bf16 v[28:31], a[84:87], a[140:143], v[28:31]
  ds_read_b128 v[216:219], v12 offset:0
  v_cvt_pk_bf16_f32 v71, v71, v71
  v_mfma_f32_16x16x32_bf16 v[28:31], a[76:79], a[144:147], v[28:31]
  ds_read_b128 v[220:223], v12 offset:4096
  v_cndmask_b32 v75, v5, v93, s[74:75]
  v_mfma_f32_16x16x32_bf16 v[28:31], a[68:71], a[148:151], v[28:31]
  ds_read_b128 v[224:227], v12 offset:8192
  v_cndmask_b32 v68, v27, v23, s[62:63]
  v_mfma_f32_16x16x32_bf16 v[28:31], a[60:63], a[152:155], v[28:31]
  ds_read_b128 v[228:231], v12 offset:12288
  v_add_f32_dpp v64, v68, v26 wave_ror:1 row_mask:0xf bank_mask:0xf
  v_mfma_f32_16x16x32_bf16 v[28:31], a[52:55], a[156:159], v[28:31]
  ds_read_b128 v[232:235], v12 offset:16384
  v_cndmask_b32 v68, v64, v65, s[62:63]
  v_mfma_f32_16x16x32_bf16 v[28:31], a[44:47], a[160:163], v[28:31]
  ds_write_b16 v75, v71 offset:12960
  v_add_f32_dpp v66, v68, v25 wave_ror:1 row_mask:0xf bank_mask:0xf
  v_mfma_f32_16x16x32_bf16 v[28:31], a[36:39], a[164:167], v[28:31]
  s_lshl_b64 s[74:75], -1, 10
  ds_read_u16_d16_hi v83, v4 offset:3968
  v_cndmask_b32 v68, v66, v67, s[62:63]
  v_mfma_f32_16x16x32_bf16 v[28:31], a[28:31], a[168:171], v[28:31]
  v_mfma_f32_16x16x32_bf16 v[28:31], a[20:23], a[172:175], v[28:31]
  v_add_f32_dpp v70, v68, v24 wave_ror:1 row_mask:0xf bank_mask:0xf
  v_fmac_f32 v70, s61, v78
  v_mfma_f32_16x16x32_bf16 v[28:31], a[12:15], a[176:179], v[28:31]
  v_cvt_pk_bf16_f32 v70, v70, v70
  v_mfma_f32_16x16x32_bf16 v[28:31], a[4:7], a[180:183], v[28:31]
  s_waitcnt lgkmcnt(2)
  ds_write_b16 v5, v70 offset:13480
  v_mfma_f32_16x16x32_bf16 v[32:35], a[112:115], a[128:131], 0
  s_waitcnt vmcnt(1)
  v_mfma_f32_16x16x32_bf16 v[32:35], a[104:107], a[132:135], v[32:35]
  s_lshl_b64 s[72:73], -1, 25
  ds_write_b64 v10, v[96:97] offset:0
  v_mfma_f32_16x16x32_bf16 v[32:35], a[96:99], a[136:139], v[32:35]
  v_mfma_f32_16x16x32_bf16 v[32:35], a[88:91], a[140:143], v[32:35]
  ds_write_b64 v10, v[98:99] offset:8
  v_cndmask_b32 v69, v31, v27, s[62:63]
  v_mfma_f32_16x16x32_bf16 v[32:35], a[80:83], a[144:147], v[32:35]
  v_mfma_f32_16x16x32_bf16 v[32:35], a[72:75], a[148:151], v[32:35]
  ds_write_b64 v10, v[100:101] offset:1024
  v_add_f32_dpp v65, v69, v30 wave_ror:1 row_mask:0xf bank_mask:0xf
  v_mfma_f32_16x16x32_bf16 v[32:35], a[64:67], a[152:155], v[32:35]
  v_cndmask_b32 v69, v65, v64, s[62:63]
  v_mfma_f32_16x16x32_bf16 v[32:35], a[56:59], a[156:159], v[32:35]
  ds_write_b64 v10, v[102:103] offset:1032
  v_add_f32_dpp v67, v69, v29 wave_ror:1 row_mask:0xf bank_mask:0xf
  v_mfma_f32_16x16x32_bf16 v[32:35], a[48:51], a[160:163], v[32:35]
  v_cndmask_b32 v69, v67, v66, s[62:63]
  v_mfma_f32_16x16x32_bf16 v[32:35], a[40:43], a[164:167], v[32:35]
  ds_write_b64 v10, v[104:105] offset:2048
  v_add_f32_dpp v71, v69, v28 wave_ror:1 row_mask:0xf bank_mask:0xf
  v_mfma_f32_16x16x32_bf16 v[32:35], a[32:35], a[168:171], v[32:35]
  v_fmac_f32 v71, s61, v79
  v_cvt_pk_bf16_f32 v71, v71, v71
  v_mfma_f32_16x16x32_bf16 v[32:35], a[24:27], a[172:175], v[32:35]
  ds_write_b64 v10, v[106:107] offset:2056
  v_cndmask_b32 v75, v5, v93, s[74:75]
  v_mfma_f32_16x16x32_bf16 v[32:35], a[16:19], a[176:179], v[32:35]
  buffer_store_dwordx4 v[216:219], v13, s[4:7], s38 offen sc1
  v_mfma_f32_16x16x32_bf16 v[32:35], a[8:11], a[180:183], v[32:35]
  ds_write_b16 v75, v71 offset:13992
  v_mfma_f32_16x16x32_bf16 v[32:35], a[0:3], a[184:187], v[32:35]
  s_waitcnt lgkmcnt(8)
  v_mfma_f32_16x16x32_bf16 v[36:39], a[116:119], a[128:131], 0
  s_lshl_b64 s[74:75], -1, 40
  v_mfma_f32_16x16x32_bf16 v[36:39], a[108:111], a[132:135], v[36:39]
  ds_write_b64 v10, v[108:109] offset:3072
  v_mfma_f32_16x16x32_bf16 v[36:39], a[100:103], a[136:139], v[36:39]
  v_mfma_f32_16x16x32_bf16 v[36:39], a[92:95], a[140:143], v[36:39]
  ds_write_b64 v10, v[110:111] offset:3080
  v_mfma_f32_16x16x32_bf16 v[36:39], a[84:87], a[144:147], v[36:39]
  v_cndmask_b32 v68, v35, v31, s[62:63]
  v_mfma_f32_16x16x32_bf16 v[36:39], a[76:79], a[148:151], v[36:39]
  ds_write_b64 v11, v[112:113] offset:0
  v_add_f32_dpp v64, v68, v34 wave_ror:1 row_mask:0xf bank_mask:0xf
  v_mfma_f32_16x16x32_bf16 v[36:39], a[68:71], a[152:155], v[36:39]
  v_cndmask_b32 v68, v64, v65, s[62:63]
  v_mfma_f32_16x16x32_bf16 v[36:39], a[60:63], a[156:159], v[36:39]
  ds_write_b64 v11, v[114:115] offset:8
  v_add_f32_dpp v66, v68, v33 wave_ror:1 row_mask:0xf bank_mask:0xf
  v_mfma_f32_16x16x32_bf16 v[36:39], a[52:55], a[160:163], v[36:39]
  v_cndmask_b32 v68, v66, v67, s[62:63]
  v_mfma_f32_16x16x32_bf16 v[36:39], a[44:47], a[164:167], v[36:39]
  ds_write_b64 v11, v[116:117] offset:1024
  v_add_f32_dpp v70, v68, v32 wave_ror:1 row_mask:0xf bank_mask:0xf
  v_mfma_f32_16x16x32_bf16 v[36:39], a[36:39], a[168:171], v[36:39]
  v_fmac_f32 v70, s61, v80
  v_cvt_pk_bf16_f32 v70, v70, v70
  v_mfma_f32_16x16x32_bf16 v[36:39], a[28:31], a[172:175], v[36:39]
  ds_write_b64 v11, v[118:119] offset:1032
  v_cndmask_b32 v74, v5, v93, s[72:73]
  v_mfma_f32_16x16x32_bf16 v[36:39], a[20:23], a[176:179], v[36:39]
  buffer_store_dwordx4 v[220:223], v13, s[4:7], s39 offen sc1
  v_mfma_f32_16x16x32_bf16 v[36:39], a[12:15], a[180:183], v[36:39]
  ds_write_b16 v74, v70 offset:14512
  v_mfma_f32_16x16x32_bf16 v[36:39], a[4:7], a[184:187], v[36:39]
  v_mfma_f32_16x16x32_bf16 v[40:43], a[120:123], a[128:131], 0
  s_lshl_b64 s[72:73], -1, 55
  v_add_u32 v2, 17408, v2
  v_add_u32 v3, 16512, v3
  v_mfma_f32_16x16x32_bf16 v[40:43], a[112:115], a[132:135], v[40:43]
  ds_write_b64 v11, v[120:121] offset:2048
  v_mfma_f32_16x16x32_bf16 v[40:43], a[104:107], a[136:139], v[40:43]
  v_add_u32 v4, 17408, v4
  v_mov_b32 v200, v203
  v_mfma_f32_16x16x32_bf16 v[40:43], a[96:99], a[140:143], v[40:43]
  ds_write_b64 v11, v[122:123] offset:2056
  v_cndmask_b32 v69, v39, v35, s[62:63]
  v_mfma_f32_16x16x32_bf16 v[40:43], a[88:91], a[144:147], v[40:43]
L_cw2:
  s_cbranch_execz L_cw_ret
  v_mov_b32 v201, v204
  v_mov_b32 v202, v205
  v_mfma_f32_16x16x32_bf16 v[40:43], a[80:83], a[148:151], v[40:43]
  ds_write_b64 v11, v[124:125] offset:3072
  v_add_f32_dpp v65, v69, v38 wave_ror:1 row_mask:0xf bank_mask:0xf
  v_mfma_f32_16x16x32_bf16 v[40:43], a[72:75], a[152:155], v[40:43]
  v_cndmask_b32 v69, v65, v64, s[62:63]
  v_mov_b32 v203, v206
  v_mfma_f32_16x16x32_bf16 v[40:43], a[64:67], a[156:159], v[40:43]
  ds_write_b64 v11, v[126:127] offset:3080
  v_add_f32_dpp v67, v69, v37 wave_ror:1 row_mask:0xf bank_mask:0xf
  v_mfma_f32_16x16x32_bf16 v[40:43], a[56:59], a[160:163], v[40:43]
  v_cndmask_b32 v69, v67, v66, s[62:63]
  v_mov_b32 v204, v207
  v_mfma_f32_16x16x32_bf16 v[40:43], a[48:51], a[164:167], v[40:43]
  v_add_f32_dpp v71, v69, v36 wave_ror:1 row_mask:0xf bank_mask:0xf
  v_fmac_f32 v71, s61, v81
  v_mfma_f32_16x16x32_bf16 v[40:43], a[40:43], a[168:171], v[40:43]
  buffer_store_dwordx4 v[224:227], v13, s[4:7], s40 offen sc1
  v_mfma_f32_16x16x32_bf16 v[40:43], a[32:35], a[172:175], v[40:43]
  v_cvt_pk_bf16_f32 v71, v71, v71
  v_cndmask_b32 v75, v5, v93, s[74:75]
  v_mfma_f32_16x16x32_bf16 v[40:43], a[24:27], a[176:179], v[40:43]
  buffer_store_dwordx4 v[228:231], v13, s[4:7], s41 offen sc1
  v_mfma_f32_16x16x32_bf16 v[40:43], a[16:19], a[180:183], v[40:43]
  ds_write_b16 v75, v71 offset:15032
  v_mov_b32 v205, v208
  v_mfma_f32_16x16x32_bf16 v[40:43], a[8:11], a[184:187], v[40:43]
  v_mfma_f32_16x16x32_bf16 v[40:43], a[0:3], a[188:191], v[40:43]
  v_mfma_f32_16x16x32_bf16 v[44:47], a[124:127], a[128:131], 0
  v_mfma_f32_16x16x32_bf16 v[44:47], a[4:7], a[188:191], v[44:47]
  v_mfma_f32_16x16x32_bf16 v[44:47], a[116:119], a[132:135], v[44:47]
  buffer_store_dwordx4 v[232:235], v14, s[4:7], s38 offen sc1
  v_mfma_f32_16x16x32_bf16 v[44:47], a[12:15], a[184:187], v[44:47]
  v_mfma_f32_16x16x32_bf16 v[44:47], a[108:111], a[136:139], v[44:47]
  ds_read_b64_tr_b16 a[0:1], v2 offset:32
  v_mfma_f32_16x16x32_bf16 v[44:47], a[100:103], a[140:143], v[44:47]
  ds_read_b64_tr_b16 a[2:3], v2 offset:0
  v_cndmask_b32 v68, v43, v39, s[62:63]
  v_mfma_f32_16x16x32_bf16 v[44:47], a[92:95], a[144:147], v[44:47]
  ds_read_b64_tr_b16 a[128:129], v3 offset:0
  v_add_f32_dpp v64, v68, v42 wave_ror:1 row_mask:0xf bank_mask:0xf
  v_mfma_f32_16x16x32_bf16 v[44:47], a[84:87], a[148:151], v[44:47]
  ds_read_b64_tr_b16 a[130:131], v3 offset:32
  v_cndmask_b32 v68, v64, v65, s[62:63]
  v_mfma_f32_16x16x32_bf16 v[44:47], a[76:79], a[152:155], v[44:47]
  ds_read_b64_tr_b16 a[4:5], v2 offset:160
  v_add_f32_dpp v66, v68, v41 wave_ror:1 row_mask:0xf bank_mask:0xf
  v_mfma_f32_16x16x32_bf16 v[44:47], a[68:71], a[156:159], v[44:47]
  ds_read_b64_tr_b16 a[6:7], v2 offset:128
  v_cndmask_b32 v68, v66, v67, s[62:63]
  v_mfma_f32_16x16x32_bf16 v[44:47], a[60:63], a[160:163], v[44:47]
  ds_read_b64_tr_b16 a[8:9], v2 offset:288
  v_add_f32_dpp v70, v68, v40 wave_ror:1 row_mask:0xf bank_mask:0xf
  v_mfma_f32_16x16x32_bf16 v[44:47], a[52:55], a[164:167], v[44:47]
  ds_read_b64_tr_b16 a[10:11], v2 offset:256
  v_fmac_f32 v70, s61, v82
  v_mfma_f32_16x16x32_bf16 v[44:47], a[44:47], a[168:171], v[44:47]
  ds_read_b64_tr_b16 a[132:133], v3 offset:256
  v_cvt_pk_bf16_f32 v70, v70, v70
  v_mfma_f32_16x16x32_bf16 v[44:47], a[36:39], a[172:175], v[44:47]
  ds_read_b64_tr_b16 a[134:135], v3 offset:288
  v_cndmask_b32 v74, v5, v93, s[72:73]
  v_mfma_f32_16x16x32_bf16 v[44:47], a[28:31], a[176:179], v[44:47]
  ds_read_b64_tr_b16 a[12:13], v2 offset:416
  v_mfma_f32_16x16x32_bf16 v[44:47], a[20:23], a[180:183], v[44:47]
  ds_read_b64_tr_b16 a[14:15], v2 offset:384
  ds_write_b16 v74, v70 offset:15552
  s_mov_b32 s16, s50
  s_mov_b32 s17, s51
  s_sub_u32 s22, s22, 1
  v_add_u32 v12, 16640, v12
  s_mov_b32 s6, 2396160
  s_add_u32 s38, s38, s42
  v_cndmask_b32 v69, v47, v43, s[62:63]
  s_add_u32 s39, s39, s42
  s_add_u32 s40, s40, s42
  v_add_f32_dpp v65, v69, v46 wave_ror:1 row_mask:0xf bank_mask:0xf
  v_cndmask_b32 v69, v65, v64, s[62:63]
  s_add_u32 s41, s41, s42
  s_mov_b32 s42, 128
  v_add_f32_dpp v67, v69, v45 wave_ror:1 row_mask:0xf bank_mask:0xf
  v_cndmask_b32 v69, v67, v66, s[62:63]
  s_nop 0
  s_nop 0
  v_add_f32_dpp v71, v69, v44 wave_ror:1 row_mask:0xf bank_mask:0xf
  v_fmac_f32 v71, s61, v83
  v_cvt_pk_bf16_f32 v71, v71, v71
  ds_write_b16 v5, v71 offset:16072
  v_add_u32 v5, 16640, v5
  v_add_u32 v93, 16640, v93
  s_cmp_lg_u32 s22, 0
  s_cbranch_scc1 L_cloop
  s_waitcnt lgkmcnt(0)
  s_barrier
  ds_read_b128 v[216:219], v12 offset:0
  ds_read_b128 v[220:223], v12 offset:4096
  ds_read_b128 v[224:227], v12 offset:8192
  ds_read_b128 v[228:231], v12 offset:12288
  ds_read_b128 v[232:235], v12 offset:16384
  s_waitcnt lgkmcnt(4)
  buffer_store_dwordx4 v[216:219], v13, s[4:7], s38 offen sc1
  s_waitcnt lgkmcnt(3)
  buffer_store_dwordx4 v[220:223], v13, s[4:7], s39 offen sc1
  s_waitcnt lgkmcnt(2)
  buffer_store_dwordx4 v[224:227], v13, s[4:7], s40 offen sc1
  s_waitcnt lgkmcnt(1)
  buffer_store_dwordx4 v[228:231], v13, s[4:7], s41 offen sc1
  s_waitcnt lgkmcnt(0)
  buffer_store_dwordx4 v[232:235], v14, s[4:7], s38 offen sc1
  v_mov_b32 v9, 47
  v_mov_b32 v10, 1
  v_lshlrev_b32 v11, 10, v1
  s_mov_b32 s66, 23941504
  s_waitcnt vmcnt(0)
  s_barrier
  s_cmp_lg_u32 s20, 0
  s_cbranch_scc1 L_c_done
  s_mov_b64 exec, 1
  global_atomic_inc v9, v11, v9, s[58:59] offset:128 sc0
  s_waitcnt vmcnt(0)
  v_readfirstlane_b32 s67, v9
  s_mov_b64 exec, -1
  s_cmp_lg_u32 s67, 47
  s_cbranch_scc1 L_c_done
  s_mov_b64 exec, 0x3ffffff
  buffer_store_dword v10, v11, s[44:47], s66 offen sc1
  s_mov_b64 exec, -1
L_c_done:
  s_endpgm
L_slow_c1rdy:
  s_mov_b32 s71, 0
L_poll_c1rdy:
  buffer_load_dword v13, v15, s[32:35], 0 offen offset:104 sc1
  s_add_u32 s71, s71, 1
  s_cmp_gt_u32 s71, 0x200000
  s_cbranch_scc1 L_poll_c1rdy_ok
  s_waitcnt vmcnt(0)
  v_cmp_gt_u32 vcc, 1, v13
  s_cbranch_vccz L_poll_c1rdy_ok
  s_sleep 4
  s_branch L_poll_c1rdy
  s_branch L_poll_c1rdy_ok
L_end:
  s_endpgm
.section .rodata,"a"
.p2align 6
.amdhsa_kernel parallel_sum__ssm_conv_h3__dense_activation_relu__prompt_kernel
  .amdhsa_next_free_vgpr 512
  .amdhsa_next_free_sgpr 102
  .amdhsa_accum_offset 256
  .amdhsa_group_segment_fixed_size 0
  .amdhsa_kernarg_size 96
  .amdhsa_user_sgpr_count 2
  .amdhsa_user_sgpr_kernarg_segment_ptr 1
  .amdhsa_system_sgpr_workgroup_id_x 1
  .amdhsa_float_denorm_mode_32 3
  .amdhsa_float_denorm_mode_16_64 3
.end_amdhsa_kernel
```
